```python
import torch

def _softmax(x, axis=-1):
    return torch.softmax(x, dim=axis)

def _gelu(x):
    return torch.nn.functional.gelu(x, approximate='tanh')

def _silu(x):
    return torch.nn.functional.silu(x)

def _sigmoid(x):
    return torch.sigmoid(x)

def _layernorm(x, axis=-1, eps=1e-05):
    m = x.mean(dim=axis, keepdim=True)
    v = x.var(dim=axis, keepdim=True, unbiased=False)
    return (x - m) / torch.sqrt(v + eps)

def _scatter_add(tgt, idx, src, axis=0):
    return tgt.clone().index_add_(axis, idx, src)

def _segment_sum(src, seg, n):
    out = torch.zeros((n,) + src.shape[1:], dtype=src.dtype)
    return out.index_add_(0, seg, src)

def _pad(x, pw):
    flat = tuple((v for pair in reversed(pw) for v in pair))
    return torch.nn.functional.pad(x, flat)
kernel_name = 'adaLN_cond__ssm_conv_h3__mixer_gmlp__prompt'

def setup_inputs():

    _w = lambda a: (lambda t: t.to(torch.bfloat16) if t.is_floating_point() else t)(torch.as_tensor(a))

    def _A_setup():
        B, S, D = (1, 2048, 512)
        ks = 4
        return {'q': _w((lambda *s: torch.randn(*s, dtype=torch.bfloat16) * 0.05)(B, S, D)), 'k': _w((lambda *s: torch.randn(*s, dtype=torch.bfloat16) * 0.8)(B, S, D)), 'v': _w((lambda *s: torch.randn(*s, dtype=torch.bfloat16) * 0.4)(B, S, D)), 'shift_k': _w((lambda *s: torch.randn(*s, dtype=torch.bfloat16) * 0.8)(D, ks) * 0.5), 'ssm_k': _w((lambda *s: torch.randn(*s, dtype=torch.bfloat16) * 0.8)(D, S) * (1.0 / S ** 0.5)), 'ssm_D': _w((lambda *s: torch.randn(*s, dtype=torch.bfloat16) * 0.4)(D))}
    _A_in = _A_setup()

    def _B_setup():
        B, S, D, F = (1, 2048, 512, 1792)
        Fh = F // 2
        return {'x': _w((lambda *s: torch.randn(*s, dtype=torch.bfloat16) * 0.05)(B, S, D)), 'w_in': _w((lambda *s: torch.randn(*s, dtype=torch.bfloat16) * 0.4)(D, 2 * Fh)), 'w_sp': _w(0.01 * (lambda *s: torch.randn(*s, dtype=torch.bfloat16) * 0.4)(S, S)), 'b_sp': _w(1.0 + 0.01 * (lambda *s: torch.randn(*s, dtype=torch.bfloat16) * 0.05)(S)), 'w_out': _w((lambda *s: torch.randn(*s, dtype=torch.bfloat16) * 0.05)(Fh, D))}
    _B_in = _B_setup()
    return {'A_q': _A_in['q'], 'A_k': _A_in['k'], 'A_v': _A_in['v'], 'A_shift_k': _A_in['shift_k'], 'A_ssm_k': _A_in['ssm_k'], 'A_ssm_D': _A_in['ssm_D'], 'B_x': _B_in['x'], 'B_w_in': _B_in['w_in'], 'B_w_sp': _B_in['w_sp'], 'B_b_sp': _B_in['b_sp'], 'B_w_out': _B_in['w_out'], 'c': _w((lambda *s: torch.randn(*s, dtype=torch.bfloat16) * 0.1)(1, 512) * 8.0), 'w_mod': _w((lambda *s: torch.randn(*s, dtype=torch.bfloat16) * 0.1)(512, 6 * 512) * 512 ** (-0.5) * 8.0)}

def reference(A_q, A_k, A_v, A_shift_k, A_ssm_k, A_ssm_D, B_x, B_w_in, B_w_sp, B_b_sp, B_w_out, c, w_mod):

    def _A_ref(q, k, v, shift_k, ssm_k, ssm_D):
        B, S, D = q.shape
        ks = shift_k.shape[-1]
        k_pad = _pad(k, ((0, 0), (ks - 1, 0), (0, 0)))
        k_shift = torch.zeros_like(k)
        for t in range(ks):
            k_shift = k_shift + k_pad[:, t:t + S, :] * shift_k[:, ks - 1 - t][None, None, :]
        kv = k_shift * v
        L = 2 * S
        kv_pad = _pad(kv, ((0, 0), (0, S), (0, 0)))
        kf_pad = _pad(ssm_k, ((0, 0), (0, S)))
        kv_f = (lambda x, axes=(-2, -1): torch.fft.rfft2(x.float(), dim=axes))(kv_pad[:, None, :, :], axes=(1, 2))
        kf_f = (lambda x, axes=(-2, -1): torch.fft.rfft2(x.float(), dim=axes))(kf_pad[:, None, :], axes=(1, 2))
        kf_f = (lambda x, *d: x.permute(*d))(kf_f, 1, 2, 0)
        y_f = kv_f * kf_f[None, :, :, :]
        y = (lambda x, s, axes=(-2, -1): torch.fft.irfft2(x, s=s, dim=axes).to(torch.bfloat16))(y_f, (1, L), axes=(1, 2))[:, 0, :S, :]
        y = y + kv * ssm_D[None, None, :]
        return q * y

    def _B_ref(x, w_in, w_sp, b_sp, w_out):
        B, S, D = x.shape
        F = w_in.shape[-1]
        Fh = F // 2
        z = _gelu(torch.einsum('bsd,df->bsf', x, w_in))
        z1 = z[..., :Fh].clone()
        z2 = _layernorm(z[..., Fh:], axis=-1)
        g = torch.einsum('ts,bsf->btf', w_sp, z2) + b_sp[None, :, None]
        return torch.einsum('bsf,fd->bsd', z1 * g, w_out)
    x = A_q
    mod = (_silu(c) @ w_mod).reshape(c.shape[0], 6, 1, -1)
    sa, ca, ga, sb, cb, gb = (mod[:, 0].clone(), mod[:, 1].clone(), mod[:, 2].clone(), mod[:, 3].clone(), mod[:, 4].clone(), mod[:, 5].clone())
    h = _layernorm(x, axis=-1) * (1 + ca) + sa
    x = x + ga * _A_ref(h, A_k, A_v, A_shift_k, A_ssm_k, A_ssm_D)
    h = _layernorm(x, axis=-1) * (1 + cb) + sb
    x = x + gb * _B_ref(h, B_w_in, B_w_sp, B_b_sp, B_w_out)
    return x
```

```asm
; @launch kernel=adaLN_cond__ssm_conv_h3__mixer_gmlp__prompt_kernel grid=(256,1,1) block=(256,1,1) lds=162880
.amdgcn_target "amdgcn-amd-amdhsa--gfx950"
.text
.globl adaLN_cond__ssm_conv_h3__mixer_gmlp__prompt_kernel
.p2align 8
.type adaLN_cond__ssm_conv_h3__mixer_gmlp__prompt_kernel,@function
adaLN_cond__ssm_conv_h3__mixer_gmlp__prompt_kernel:
L_start:
    s_cmp_ge_u32 s2, 256
    s_cbranch_scc1 L_end
    s_load_dwordx16 s[4:19], s[0:1], 0
    s_load_dwordx16 s[20:35], s[0:1], 64
    v_and_b32 v1, 63, v0
    v_lshrrev_b32 v2, 6, v0
    s_nop 0
    v_readfirstlane_b32 s56, v2
    v_mov_b32 v4, 0
    v_lshlrev_b32 v5, 4, v1
    v_and_b32 v6, 15, v1
    v_lshrrev_b32 v7, 4, v1
    s_mov_b32 s86, 4096
    s_lshr_b32 s60, s2, 3
    s_lshl_b32 s60, s60, 16
    s_and_b32 s61, s2, 7
    s_lshl_b32 s62, s61, 7
    s_add_u32 s60, s60, s62
    s_and_b32 s62, s56, 1
    s_lshl_b32 s62, s62, 6
    s_add_u32 s60, s60, s62
    v_lshrrev_b32 v2, 3, v1
    v_and_b32 v3, 7, v1
    v_lshlrev_b32 v10, 13, v2
    v_lshl_add_u32 v10, v3, 3, v10
    v_add_u32 v10, s60, v10
    s_cmp_ge_u32 s56, 2
    s_cbranch_scc1 L_xrole_1
    v_subrev_u32 v11, 3072, v10
    v_cmp_gt_u32 vcc, 1024, v10
    v_mov_b32 v2, 1073741824
    s_nop 0
    v_cndmask_b32 v11, v11, v2, vcc
    v_lshlrev_b32 v3, 5, v3
    s_and_b32 s62, s2, 7
    s_lshl_b32 s62, s62, 9
    s_lshl_b32 s63, s56, 8
    s_add_u32 s62, s62, s63
    v_subrev_u32 v90, 16, v5
    v_cmp_eq_u32 vcc, 0, v1
    s_nop 1
    v_cndmask_b32 v90, v90, v2, vcc
    s_waitcnt lgkmcnt(0)
    s_mov_b32 s40, s6
    s_mov_b32 s41, s7
    s_mov_b32 s42, 2097152
    s_mov_b32 s43, 0x20000
    buffer_load_dwordx2 v[18:19], v10, s[40:43], 0 offen offset:0 nt
    s_mov_b32 s44, s8
    s_mov_b32 s45, s9
    s_mov_b32 s46, 2097152
    s_mov_b32 s47, 0x20000
    buffer_load_dwordx2 v[34:35], v10, s[44:47], 0 offen offset:0 nt
    s_mov_b32 s52, s10
    s_mov_b32 s53, s11
    s_mov_b32 s54, 4096
    s_mov_b32 s55, 0x20000
    buffer_load_dwordx4 v[50:53], v3, s[52:55], s62 offen offset:0
    buffer_load_dwordx4 v[54:57], v3, s[52:55], s62 offen offset:16
    buffer_load_dwordx2 v[20:21], v10, s[40:43], 0 offen offset:1024 nt
    buffer_load_dwordx2 v[36:37], v10, s[44:47], 0 offen offset:1024 nt
    buffer_load_dwordx2 v[22:23], v10, s[40:43], 0 offen offset:2048 nt
    buffer_load_dwordx2 v[38:39], v10, s[44:47], 0 offen offset:2048 nt
    buffer_load_dwordx2 v[24:25], v10, s[40:43], 0 offen offset:3072 nt
    buffer_load_dwordx2 v[40:41], v10, s[44:47], 0 offen offset:3072 nt
    buffer_load_dwordx2 v[26:27], v10, s[40:43], s86 offen offset:0 nt
    buffer_load_dwordx2 v[42:43], v10, s[44:47], s86 offen offset:0 nt
    buffer_load_dwordx2 v[28:29], v10, s[40:43], s86 offen offset:1024 nt
    buffer_load_dwordx2 v[44:45], v10, s[44:47], s86 offen offset:1024 nt
    buffer_load_dwordx2 v[30:31], v10, s[40:43], s86 offen offset:2048 nt
    buffer_load_dwordx2 v[46:47], v10, s[44:47], s86 offen offset:2048 nt
    buffer_load_dwordx2 v[32:33], v10, s[40:43], s86 offen offset:3072 nt
    buffer_load_dwordx2 v[48:49], v10, s[44:47], s86 offen offset:3072 nt
    buffer_load_dwordx2 v[12:13], v11, s[40:43], 0 offen offset:0 nt
    buffer_load_dwordx2 v[14:15], v11, s[40:43], 0 offen offset:1024 nt
    buffer_load_dwordx2 v[16:17], v11, s[40:43], 0 offen offset:2048 nt
    v_lshlrev_b32 v8, 3, v1
    v_lshlrev_b32 v9, 2, v1
    s_and_b32 s60, s2, 7
    s_lshr_b32 s61, s2, 3
    s_lshr_b32 s62, s60, 1
    s_lshl_b32 s62, s62, 3
    s_and_b32 s63, s61, 7
    s_add_u32 s58, s62, s63
    s_and_b32 s62, s60, 1
    s_lshl_b32 s62, s62, 2
    s_lshr_b32 s63, s61, 3
    s_add_u32 s59, s62, s63
    s_mov_b32 s100, 0
    s_lshl_b32 s87, s60, 6
    s_lshl_b32 s61, s61, 1
    s_add_u32 s87, s87, s61
    s_mov_b32 s36, s34
    s_mov_b32 s37, s35
    s_mov_b32 s38, 20971520
    s_mov_b32 s39, 0x20000
    s_load_dword s57, s[34:35], 0
    s_mov_b32 s48, s12
    s_mov_b32 s49, s13
    s_mov_b32 s50, 2097152
    s_mov_b32 s51, 0x20000
    s_add_u32 s72, s87, s56
    s_lshl_b32 s72, s72, 12
    buffer_load_dwordx4 v[58:61], v90, s[48:51], s72 offen nt
    buffer_load_dwordx4 v[62:65], v5, s[48:51], s72 offen offset:0 nt
    buffer_load_dwordx4 v[66:69], v5, s[48:51], s72 offen offset:1008 nt
    buffer_load_dwordx4 v[70:73], v5, s[48:51], s72 offen offset:1024 nt
    buffer_load_dwordx4 v[74:77], v5, s[48:51], s72 offen offset:2032 nt
    buffer_load_dwordx4 v[78:81], v5, s[48:51], s72 offen offset:2048 nt
    buffer_load_dwordx4 v[82:85], v5, s[48:51], s72 offen offset:3056 nt
    buffer_load_dwordx4 v[86:89], v5, s[48:51], s72 offen offset:3072 nt
    s_lshl_b32 s73, s56, 12
    s_add_u32 s73, s73, 100352
    v_lshrrev_b32 v2, 3, v1
    v_and_b32 v3, 7, v1
    v_lshlrev_b32 v92, 12, v2
    v_lshl_add_u32 v92, v3, 4, v92
    v_lshrrev_b32 v94, 5, v1
    v_xor_b32 v94, v94, v3
    v_lshlrev_b32 v94, 4, v94
    v_lshl_add_u32 v94, v2, 7, v94
    v_add_u32 v94, s73, v94
    v_xor_b32 v95, 32, v94
    v_xor_b32 v96, 64, v94
    v_xor_b32 v97, 96, v94
    v_xor_b32 v2, 7, v2
    v_xor_b32 v2, v2, v3
    v_lshlrev_b32 v91, 9, v3
    v_lshl_add_u32 v91, v2, 4, v91
    v_add_u32 v91, s73, v91
    s_and_b32 s74, s2, 7
    s_lshl_b32 s74, s74, 18
    s_and_b32 s76, s56, 1
    s_lshl_b32 s76, s76, 17
    s_add_u32 s74, s74, s76
    s_lshr_b32 s75, s2, 3
    s_lshl_b32 s75, s75, 7
    s_sub_u32 s74, s74, s75
    s_add_u32 s74, s74, 1052544
    s_add_u32 s75, s74, 32768
    s_add_u32 s76, s74, 65536
    s_add_u32 s77, s74, 98304
    s_waitcnt vmcnt(8)
    v_lshlrev_b32 v98, 16, v12
    v_and_b32 v99, 0xffff0000, v12
    v_lshlrev_b32 v100, 16, v14
    v_and_b32 v101, 0xffff0000, v14
    v_lshlrev_b32 v102, 16, v16
    v_and_b32 v103, 0xffff0000, v16
    v_lshlrev_b32 v104, 16, v18
    v_and_b32 v105, 0xffff0000, v18
    v_lshlrev_b32 v106, 16, v20
    v_and_b32 v107, 0xffff0000, v20
    v_lshlrev_b32 v108, 16, v22
    v_and_b32 v109, 0xffff0000, v22
    v_lshlrev_b32 v110, 16, v24
    v_and_b32 v111, 0xffff0000, v24
    v_lshlrev_b32 v112, 16, v26
    v_and_b32 v113, 0xffff0000, v26
    v_lshlrev_b32 v114, 16, v28
    v_and_b32 v115, 0xffff0000, v28
    v_lshlrev_b32 v116, 16, v30
    v_and_b32 v117, 0xffff0000, v30
    v_lshlrev_b32 v118, 16, v32
    v_and_b32 v119, 0xffff0000, v32
    v_lshlrev_b32 v120, 16, v34
    v_and_b32 v121, 0xffff0000, v34
    v_lshlrev_b32 v122, 16, v36
    v_and_b32 v123, 0xffff0000, v36
    v_lshlrev_b32 v124, 16, v38
    v_and_b32 v125, 0xffff0000, v38
    v_lshlrev_b32 v126, 16, v40
    v_and_b32 v127, 0xffff0000, v40
    v_lshlrev_b32 v128, 16, v42
    v_and_b32 v129, 0xffff0000, v42
    v_lshlrev_b32 v130, 16, v44
    v_and_b32 v131, 0xffff0000, v44
    v_lshlrev_b32 v132, 16, v46
    v_and_b32 v133, 0xffff0000, v46
    v_lshlrev_b32 v134, 16, v48
    v_and_b32 v135, 0xffff0000, v48
    v_lshlrev_b32 v136, 16, v50
    v_and_b32 v138, 0xffff0000, v50
    v_lshlrev_b32 v140, 16, v51
    v_and_b32 v142, 0xffff0000, v51
    v_lshlrev_b32 v137, 16, v52
    v_and_b32 v139, 0xffff0000, v52
    v_lshlrev_b32 v141, 16, v53
    v_and_b32 v143, 0xffff0000, v53
    v_pk_mul_f32 v[144:145], v[98:99], v[142:143]
    v_pk_mul_f32 v[146:147], v[100:101], v[142:143]
    v_pk_mul_f32 v[148:149], v[102:103], v[142:143]
    v_pk_mul_f32 v[150:151], v[104:105], v[142:143]
    v_pk_mul_f32 v[152:153], v[106:107], v[142:143]
    v_pk_mul_f32 v[154:155], v[108:109], v[142:143]
    v_pk_mul_f32 v[156:157], v[110:111], v[142:143]
    v_pk_mul_f32 v[158:159], v[112:113], v[142:143]
    v_pk_fma_f32 v[144:145], v[100:101], v[140:141], v[144:145]
    v_pk_fma_f32 v[146:147], v[102:103], v[140:141], v[146:147]
    v_pk_fma_f32 v[148:149], v[104:105], v[140:141], v[148:149]
    v_pk_fma_f32 v[150:151], v[106:107], v[140:141], v[150:151]
    v_pk_fma_f32 v[152:153], v[108:109], v[140:141], v[152:153]
    v_pk_fma_f32 v[154:155], v[110:111], v[140:141], v[154:155]
    v_pk_fma_f32 v[156:157], v[112:113], v[140:141], v[156:157]
    v_pk_fma_f32 v[158:159], v[114:115], v[140:141], v[158:159]
    v_pk_fma_f32 v[144:145], v[102:103], v[138:139], v[144:145]
    v_pk_fma_f32 v[146:147], v[104:105], v[138:139], v[146:147]
    v_pk_fma_f32 v[148:149], v[106:107], v[138:139], v[148:149]
    v_pk_fma_f32 v[150:151], v[108:109], v[138:139], v[150:151]
    v_pk_fma_f32 v[152:153], v[110:111], v[138:139], v[152:153]
    v_pk_fma_f32 v[154:155], v[112:113], v[138:139], v[154:155]
    v_pk_fma_f32 v[156:157], v[114:115], v[138:139], v[156:157]
    v_pk_fma_f32 v[158:159], v[116:117], v[138:139], v[158:159]
    v_pk_fma_f32 v[144:145], v[104:105], v[136:137], v[144:145]
    v_pk_fma_f32 v[146:147], v[106:107], v[136:137], v[146:147]
    v_pk_fma_f32 v[148:149], v[108:109], v[136:137], v[148:149]
    v_pk_fma_f32 v[150:151], v[110:111], v[136:137], v[150:151]
    v_pk_fma_f32 v[152:153], v[112:113], v[136:137], v[152:153]
    v_pk_fma_f32 v[154:155], v[114:115], v[136:137], v[154:155]
    v_pk_fma_f32 v[156:157], v[116:117], v[136:137], v[156:157]
    v_pk_fma_f32 v[158:159], v[118:119], v[136:137], v[158:159]
    v_pk_mul_f32 v[144:145], v[144:145], v[120:121]
    v_pk_mul_f32 v[146:147], v[146:147], v[122:123]
    v_pk_mul_f32 v[148:149], v[148:149], v[124:125]
    v_pk_mul_f32 v[150:151], v[150:151], v[126:127]
    v_pk_mul_f32 v[152:153], v[152:153], v[128:129]
    v_pk_mul_f32 v[154:155], v[154:155], v[130:131]
    v_pk_mul_f32 v[156:157], v[156:157], v[132:133]
    v_pk_mul_f32 v[158:159], v[158:159], v[134:135]
    v_cvt_pk_bf16_f32 v160, v158, v156
    v_cvt_pk_bf16_f32 v161, v154, v152
    v_cvt_pk_bf16_f32 v162, v150, v148
    v_cvt_pk_bf16_f32 v163, v146, v144
    ds_write_b128 v91, v[160:163] offset:0
    v_cvt_pk_bf16_f32 v164, v159, v157
    v_cvt_pk_bf16_f32 v165, v155, v153
    v_cvt_pk_bf16_f32 v166, v151, v149
    v_cvt_pk_bf16_f32 v167, v147, v145
    ds_write_b128 v91, v[164:167] offset:128
    v_lshlrev_b32 v98, 16, v13
    v_and_b32 v99, 0xffff0000, v13
    v_lshlrev_b32 v100, 16, v15
    v_and_b32 v101, 0xffff0000, v15
    v_lshlrev_b32 v102, 16, v17
    v_and_b32 v103, 0xffff0000, v17
    v_lshlrev_b32 v104, 16, v19
    v_and_b32 v105, 0xffff0000, v19
    v_lshlrev_b32 v106, 16, v21
    v_and_b32 v107, 0xffff0000, v21
    v_lshlrev_b32 v108, 16, v23
    v_and_b32 v109, 0xffff0000, v23
    v_lshlrev_b32 v110, 16, v25
    v_and_b32 v111, 0xffff0000, v25
    v_lshlrev_b32 v112, 16, v27
    v_and_b32 v113, 0xffff0000, v27
    v_lshlrev_b32 v114, 16, v29
    v_and_b32 v115, 0xffff0000, v29
    v_lshlrev_b32 v116, 16, v31
    v_and_b32 v117, 0xffff0000, v31
    v_lshlrev_b32 v118, 16, v33
    v_and_b32 v119, 0xffff0000, v33
    v_lshlrev_b32 v120, 16, v35
    v_and_b32 v121, 0xffff0000, v35
    v_lshlrev_b32 v122, 16, v37
    v_and_b32 v123, 0xffff0000, v37
    v_lshlrev_b32 v124, 16, v39
    v_and_b32 v125, 0xffff0000, v39
    v_lshlrev_b32 v126, 16, v41
    v_and_b32 v127, 0xffff0000, v41
    v_lshlrev_b32 v128, 16, v43
    v_and_b32 v129, 0xffff0000, v43
    v_lshlrev_b32 v130, 16, v45
    v_and_b32 v131, 0xffff0000, v45
    v_lshlrev_b32 v132, 16, v47
    v_and_b32 v133, 0xffff0000, v47
    v_lshlrev_b32 v134, 16, v49
    v_and_b32 v135, 0xffff0000, v49
    v_lshlrev_b32 v136, 16, v54
    v_and_b32 v138, 0xffff0000, v54
    v_lshlrev_b32 v140, 16, v55
    v_and_b32 v142, 0xffff0000, v55
    v_lshlrev_b32 v137, 16, v56
    v_and_b32 v139, 0xffff0000, v56
    v_lshlrev_b32 v141, 16, v57
    v_and_b32 v143, 0xffff0000, v57
    v_pk_mul_f32 v[144:145], v[98:99], v[142:143]
    v_pk_mul_f32 v[146:147], v[100:101], v[142:143]
    v_pk_mul_f32 v[148:149], v[102:103], v[142:143]
    v_pk_mul_f32 v[150:151], v[104:105], v[142:143]
    v_pk_mul_f32 v[152:153], v[106:107], v[142:143]
    v_pk_mul_f32 v[154:155], v[108:109], v[142:143]
    v_pk_mul_f32 v[156:157], v[110:111], v[142:143]
    v_pk_mul_f32 v[158:159], v[112:113], v[142:143]
    v_pk_fma_f32 v[144:145], v[100:101], v[140:141], v[144:145]
    v_pk_fma_f32 v[146:147], v[102:103], v[140:141], v[146:147]
    v_pk_fma_f32 v[148:149], v[104:105], v[140:141], v[148:149]
    v_pk_fma_f32 v[150:151], v[106:107], v[140:141], v[150:151]
    v_pk_fma_f32 v[152:153], v[108:109], v[140:141], v[152:153]
    v_pk_fma_f32 v[154:155], v[110:111], v[140:141], v[154:155]
    v_pk_fma_f32 v[156:157], v[112:113], v[140:141], v[156:157]
    v_pk_fma_f32 v[158:159], v[114:115], v[140:141], v[158:159]
    v_pk_fma_f32 v[144:145], v[102:103], v[138:139], v[144:145]
    v_pk_fma_f32 v[146:147], v[104:105], v[138:139], v[146:147]
    v_pk_fma_f32 v[148:149], v[106:107], v[138:139], v[148:149]
    v_pk_fma_f32 v[150:151], v[108:109], v[138:139], v[150:151]
    v_pk_fma_f32 v[152:153], v[110:111], v[138:139], v[152:153]
    v_pk_fma_f32 v[154:155], v[112:113], v[138:139], v[154:155]
    v_pk_fma_f32 v[156:157], v[114:115], v[138:139], v[156:157]
    v_pk_fma_f32 v[158:159], v[116:117], v[138:139], v[158:159]
    v_pk_fma_f32 v[144:145], v[104:105], v[136:137], v[144:145]
    v_pk_fma_f32 v[146:147], v[106:107], v[136:137], v[146:147]
    v_pk_fma_f32 v[148:149], v[108:109], v[136:137], v[148:149]
    v_pk_fma_f32 v[150:151], v[110:111], v[136:137], v[150:151]
    v_pk_fma_f32 v[152:153], v[112:113], v[136:137], v[152:153]
    v_pk_fma_f32 v[154:155], v[114:115], v[136:137], v[154:155]
    v_pk_fma_f32 v[156:157], v[116:117], v[136:137], v[156:157]
    v_pk_fma_f32 v[158:159], v[118:119], v[136:137], v[158:159]
    v_pk_mul_f32 v[144:145], v[144:145], v[120:121]
    v_pk_mul_f32 v[146:147], v[146:147], v[122:123]
    v_pk_mul_f32 v[148:149], v[148:149], v[124:125]
    v_pk_mul_f32 v[150:151], v[150:151], v[126:127]
    v_pk_mul_f32 v[152:153], v[152:153], v[128:129]
    v_pk_mul_f32 v[154:155], v[154:155], v[130:131]
    v_pk_mul_f32 v[156:157], v[156:157], v[132:133]
    v_pk_mul_f32 v[158:159], v[158:159], v[134:135]
    v_cvt_pk_bf16_f32 v168, v158, v156
    v_cvt_pk_bf16_f32 v169, v154, v152
    v_cvt_pk_bf16_f32 v170, v150, v148
    v_cvt_pk_bf16_f32 v171, v146, v144
    ds_write_b128 v91, v[168:171] offset:256
    v_cvt_pk_bf16_f32 v172, v159, v157
    v_cvt_pk_bf16_f32 v173, v155, v153
    v_cvt_pk_bf16_f32 v174, v151, v149
    v_cvt_pk_bf16_f32 v175, v147, v145
    ds_write_b128 v91, v[172:175] offset:384
    s_waitcnt lgkmcnt(0)
    ds_read_b128 v[160:163], v94 offset:0
    ds_read_b128 v[164:167], v95 offset:1024
    ds_read_b128 v[168:171], v96 offset:2048
    ds_read_b128 v[172:175], v97 offset:3072
    s_waitcnt lgkmcnt(3)
    buffer_store_dwordx4 v[160:163], v92, s[36:39], s74 offen sc1
    s_waitcnt lgkmcnt(2)
    buffer_store_dwordx4 v[164:167], v92, s[36:39], s75 offen sc1
    s_waitcnt lgkmcnt(1)
    buffer_store_dwordx4 v[168:171], v92, s[36:39], s76 offen sc1
    s_waitcnt lgkmcnt(0)
    buffer_store_dwordx4 v[172:175], v92, s[36:39], s77 offen sc1
    s_waitcnt lgkmcnt(0)
    s_mul_i32 s57, s57, 0x9E3779B1
    s_add_u32 s57, s57, 0x7F4A7C15
    s_lshl_b32 s63, s2, 8
    s_lshl_b32 s64, s56, 7
    s_add_u32 s63, s63, s64
    s_add_u32 s63, s63, 131072
    s_mul_i32 s65, s56, 35072
    s_add_u32 s65, s65, 48
    v_add_u32 v176, s65, v5
    s_waitcnt vmcnt(4)
    v_alignbit_b32 v106, v59, v58, 16
    v_alignbit_b32 v107, v60, v59, 16
    v_alignbit_b32 v108, v61, v60, 16
    v_alignbit_b32 v109, v62, v61, 16
    v_alignbit_b32 v110, v63, v62, 16
    v_alignbit_b32 v111, v64, v63, 16
    v_alignbit_b32 v112, v65, v64, 16
    v_alignbit_b32 v120, v60, v59, 16
    v_alignbit_b32 v121, v61, v60, 16
    v_alignbit_b32 v122, v62, v61, 16
    v_alignbit_b32 v123, v63, v62, 16
    v_alignbit_b32 v124, v64, v63, 16
    v_alignbit_b32 v125, v65, v64, 16
    v_mov_b32 v98, v59
    v_mov_b32 v99, v60
    v_mov_b32 v100, v61
    v_mov_b32 v101, v62
    v_mov_b32 v102, v63
    v_mov_b32 v103, v64
    ds_write_b128 v176, v[106:109] offset:0
    ds_write_b128 v176, v[98:101] offset:4384
    ds_write_b128 v176, v[120:123] offset:8768
    ds_write_b128 v176, v[60:63] offset:13152
    ds_write_b128 v176, v[108:111] offset:17536
    ds_write_b128 v176, v[100:103] offset:21920
    ds_write_b128 v176, v[122:125] offset:26304
    ds_write_b128 v176, v[62:65] offset:30688
    v_alignbit_b32 v106, v67, v66, 16
    v_alignbit_b32 v107, v68, v67, 16
    v_alignbit_b32 v108, v69, v68, 16
    v_alignbit_b32 v109, v70, v69, 16
    v_alignbit_b32 v110, v71, v70, 16
    v_alignbit_b32 v111, v72, v71, 16
    v_alignbit_b32 v112, v73, v72, 16
    v_alignbit_b32 v120, v68, v67, 16
    v_alignbit_b32 v121, v69, v68, 16
    v_alignbit_b32 v122, v70, v69, 16
    v_alignbit_b32 v123, v71, v70, 16
    v_alignbit_b32 v124, v72, v71, 16
    v_alignbit_b32 v125, v73, v72, 16
    v_mov_b32 v98, v67
    v_mov_b32 v99, v68
    v_mov_b32 v100, v69
    v_mov_b32 v101, v70
    v_mov_b32 v102, v71
    v_mov_b32 v103, v72
    ds_write_b128 v176, v[106:109] offset:1024
    ds_write_b128 v176, v[98:101] offset:5408
    ds_write_b128 v176, v[120:123] offset:9792
    ds_write_b128 v176, v[68:71] offset:14176
    ds_write_b128 v176, v[108:111] offset:18560
    ds_write_b128 v176, v[100:103] offset:22944
    ds_write_b128 v176, v[122:125] offset:27328
    ds_write_b128 v176, v[70:73] offset:31712
    s_waitcnt vmcnt(0)
    v_mov_b32 v2, s57
    s_mov_b64 exec, 1
    buffer_store_dword v2, v4, s[36:39], s63 offen sc1
    s_mov_b64 exec, -1
    v_alignbit_b32 v106, v75, v74, 16
    v_alignbit_b32 v107, v76, v75, 16
    v_alignbit_b32 v108, v77, v76, 16
    v_alignbit_b32 v109, v78, v77, 16
    v_alignbit_b32 v110, v79, v78, 16
    v_alignbit_b32 v111, v80, v79, 16
    v_alignbit_b32 v112, v81, v80, 16
    v_alignbit_b32 v120, v76, v75, 16
    v_alignbit_b32 v121, v77, v76, 16
    v_alignbit_b32 v122, v78, v77, 16
    v_alignbit_b32 v123, v79, v78, 16
    v_alignbit_b32 v124, v80, v79, 16
    v_alignbit_b32 v125, v81, v80, 16
    v_mov_b32 v98, v75
    v_mov_b32 v99, v76
    v_mov_b32 v100, v77
    v_mov_b32 v101, v78
    v_mov_b32 v102, v79
    v_mov_b32 v103, v80
    ds_write_b128 v176, v[106:109] offset:2048
    ds_write_b128 v176, v[98:101] offset:6432
    ds_write_b128 v176, v[120:123] offset:10816
    ds_write_b128 v176, v[76:79] offset:15200
    ds_write_b128 v176, v[108:111] offset:19584
    ds_write_b128 v176, v[100:103] offset:23968
    ds_write_b128 v176, v[122:125] offset:28352
    ds_write_b128 v176, v[78:81] offset:32736
    v_alignbit_b32 v106, v83, v82, 16
    v_alignbit_b32 v107, v84, v83, 16
    v_alignbit_b32 v108, v85, v84, 16
    v_alignbit_b32 v109, v86, v85, 16
    v_alignbit_b32 v110, v87, v86, 16
    v_alignbit_b32 v111, v88, v87, 16
    v_alignbit_b32 v112, v89, v88, 16
    v_alignbit_b32 v120, v84, v83, 16
    v_alignbit_b32 v121, v85, v84, 16
    v_alignbit_b32 v122, v86, v85, 16
    v_alignbit_b32 v123, v87, v86, 16
    v_alignbit_b32 v124, v88, v87, 16
    v_alignbit_b32 v125, v89, v88, 16
    v_mov_b32 v98, v83
    v_mov_b32 v99, v84
    v_mov_b32 v100, v85
    v_mov_b32 v101, v86
    v_mov_b32 v102, v87
    v_mov_b32 v103, v88
    ds_write_b128 v176, v[106:109] offset:3072
    ds_write_b128 v176, v[98:101] offset:7456
    ds_write_b128 v176, v[120:123] offset:11840
    ds_write_b128 v176, v[84:87] offset:16224
    ds_write_b128 v176, v[108:111] offset:20608
    ds_write_b128 v176, v[100:103] offset:24992
    ds_write_b128 v176, v[122:125] offset:29376
    ds_write_b128 v176, v[86:89] offset:33760
    v_mov_b32 v144, 0
    v_mov_b32 v145, 0
    v_mov_b32 v146, 0
    v_mov_b32 v147, 0
    v_lshrrev_b32 v2, 2, v1
    v_and_b32 v2, 7, v2
    v_mul_u32_u24 v2, 4384, v2
    v_and_b32 v3, 3, v1
    v_min_u32 v3, 2, v3
    v_lshl_add_u32 v2, v3, 4, v2
    s_sub_u32 s65, s65, 48
    v_add_u32 v2, s65, v2
    ds_write_b128 v2, v[144:147]
    s_mul_i32 s65, s56, 6400
    s_add_u32 s65, s65, 70144
    v_add_u32 v3, s65, v5
    ds_write_b128 v3, v[144:147] offset:5120
    ds_write_b128 v3, v[144:147] offset:5376
    v_lshrrev_b32 v177, 2, v1
    v_add_u32 v177, v177, v1
    v_lshlrev_b32 v177, 4, v177
    v_add_u32 v177, s65, v177
    v_lshrrev_b32 v178, 1, v1
    v_lshlrev_b32 v178, 11, v178
    v_and_b32 v2, 1, v1
    v_lshl_add_u32 v178, v2, 7, v178
    s_and_b32 s60, s2, 7
    s_lshl_b32 s60, s60, 8
    s_add_u32 s60, s60, 131072
    s_add_u32 s61, s72, 1048576
    s_cmp_eq_u32 s56, 0
    s_cbranch_scc0 L_p0join_2
    s_mov_b32 s78, 0
L_polls1_3:
    buffer_load_dword v179, v178, s[36:39], s60 offen sc1
    s_waitcnt vmcnt(0)
L_pcs1_4:
    v_xor_b32 v2, s57, v179
    v_cmp_ne_u32 vcc, 0, v2
    s_cbranch_vccz L_pds1_5
    s_add_u32 s78, s78, 1
    s_cmp_gt_u32 s78, 200000
    s_cbranch_scc1 L_pds1_5
    s_sleep 2
    s_branch L_polls1_3
L_pds1_5:
    s_waitcnt lgkmcnt(0)
    s_add_u32 s62, s61, 4096
    buffer_load_dwordx4 v[58:61], v5, s[36:39], s61 offen offset:0 sc1
    buffer_load_dwordx4 v[62:65], v5, s[36:39], s61 offen offset:1024 sc1
    buffer_load_dwordx4 v[66:69], v5, s[36:39], s61 offen offset:2048 sc1
    buffer_load_dwordx4 v[70:73], v5, s[36:39], s61 offen offset:3072 sc1
    buffer_load_dwordx4 v[74:77], v5, s[36:39], s62 offen offset:0 sc1
    buffer_load_dwordx4 v[78:81], v5, s[36:39], s62 offen offset:1024 sc1
    buffer_load_dwordx4 v[82:85], v5, s[36:39], s62 offen offset:2048 sc1
    buffer_load_dwordx4 v[86:89], v5, s[36:39], s62 offen offset:3072 sc1
    s_waitcnt vmcnt(7)
    ds_write_b128 v177, v[58:61] offset:0
    s_waitcnt vmcnt(6)
    ds_write_b128 v177, v[62:65] offset:1280
    s_waitcnt vmcnt(5)
    ds_write_b128 v177, v[66:69] offset:2560
    s_waitcnt vmcnt(4)
    ds_write_b128 v177, v[70:73] offset:3840
    s_waitcnt vmcnt(3)
    ds_write_b128 v177, v[74:77] offset:6400
    s_waitcnt vmcnt(2)
    ds_write_b128 v177, v[78:81] offset:7680
    s_waitcnt vmcnt(1)
    ds_write_b128 v177, v[82:85] offset:8960
    s_waitcnt vmcnt(0)
    ds_write_b128 v177, v[86:89] offset:10240
    s_branch L_p0join_2
L_xrole_1:
    s_and_b32 s88, s56, 1
    s_getpc_b64 s[84:85]
L_pc:
    s_sub_u32 s84, s84, L_pc-L_start
    s_subb_u32 s85, s85, 0
    s_lshr_b32 s62, s2, 3
    s_lshl_b32 s62, s62, 1
    s_add_u32 s62, s62, s88
    s_and_b32 s62, s62, 31
    s_mul_i32 s62, s62, 2048
    v_lshlrev_b32 v11, 7, v1
    v_add_u32 v11, s62, v11
    v_min_u32 v11, L_end-L_start, v11
    s_mov_b64 exec, 0xffff
    global_load_dword v11, v11, s[84:85]
    s_mov_b64 exec, -1
    s_lshl_b32 s63, s2, 13
    s_lshl_b32 s64, s88, 12
    s_add_u32 s63, s63, s64
    s_lshl_b32 s66, s2, 1
    s_add_u32 s66, s66, s88
    s_lshr_b32 s89, s66, 3
    s_and_b32 s90, s66, 7
    v_lshrrev_b32 v2, 3, v1
    v_lshlrev_b32 v81, 4, v2
    v_mul_u32_u24 v80, 49152, v2
    v_and_b32 v2, 7, v1
    v_lshl_add_u32 v80, v2, 4, v80
    s_mul_i32 s93, s90, 393216
    s_lshl_b32 s67, s89, 7
    s_add_u32 s93, s93, s67
    s_cmp_ge_u32 s2, 192
    s_cselect_b32 s93, 1073741824, s93
    s_lshl_b32 s66, s90, 7
    s_waitcnt lgkmcnt(0)
    s_lshl_b32 s68, s88, 8
    s_add_u32 s68, s68, s2
    s_cmp_lt_u32 s68, 8
    s_cbranch_scc0 L_cinit_6
    s_mov_b32 s36, s34
    s_mov_b32 s37, s35
    s_mov_b32 s38, 20971520
    s_mov_b32 s39, 0x20000
    s_load_dword s57, s[34:35], 0
    s_waitcnt lgkmcnt(0)
    s_mul_i32 s57, s57, 0x9E3779B1
    s_add_u32 s57, s57, 0x7F4A7C15
    s_lshl_b32 s69, s57, 7
    s_lshl_b32 s64, s2, 7
    s_mul_i32 s68, s2, 128
    s_add_u32 s68, s68, 16384
    s_add_u32 s64, s64, 4096
    v_mov_b32 v2, s69
    v_mul_u32_u24 v3, 1024, v1
    s_mov_b32 exec_hi, 0
    buffer_store_dword v2, v3, s[36:39], s68 offen sc1
    s_mov_b64 exec, -1
    s_waitcnt vmcnt(0)
    v_mov_b32 v2, s57
    s_mov_b64 exec, 1
    buffer_store_dword v2, v4, s[36:39], s64 offen sc1
    s_mov_b64 exec, -1
L_cinit_6:
    s_mov_b32 s48, s4
    s_mov_b32 s49, s5
    s_mov_b32 s50, 2097152
    s_mov_b32 s51, 0x20000
    buffer_load_dwordx2 v[12:13], v10, s[48:51], 0 offen offset:0 nt
    buffer_load_dwordx2 v[14:15], v10, s[48:51], 0 offen offset:1024 nt
    buffer_load_dwordx2 v[16:17], v10, s[48:51], 0 offen offset:2048 nt
    buffer_load_dwordx2 v[18:19], v10, s[48:51], 0 offen offset:3072 nt
    buffer_load_dwordx2 v[20:21], v10, s[48:51], s86 offen offset:0 nt
    buffer_load_dwordx2 v[22:23], v10, s[48:51], s86 offen offset:1024 nt
    buffer_load_dwordx2 v[24:25], v10, s[48:51], s86 offen offset:2048 nt
    buffer_load_dwordx2 v[26:27], v10, s[48:51], s86 offen offset:3072 nt
    buffer_load_dwordx4 v[28:31], v5, s[48:51], s63 offen offset:0 nt
    buffer_load_dwordx4 v[32:35], v5, s[48:51], s63 offen offset:1024 nt
    buffer_load_dwordx4 v[36:39], v5, s[48:51], s63 offen offset:2048 nt
    buffer_load_dwordx4 v[40:43], v5, s[48:51], s63 offen offset:3072 nt
    s_mov_b32 s44, s26
    s_mov_b32 s45, s27
    s_mov_b32 s46, 1024
    s_mov_b32 s47, 0x20000
    buffer_load_dwordx4 v[76:79], v81, s[44:47], s66 offen
    s_cmp_eq_u32 s88, 0
    s_cselect_b32 s52, s18, s24
    s_cselect_b32 s53, s19, s25
    s_mov_b32 s69, 917504
    s_cselect_b32 s54, 1835008, s69
    s_mov_b32 s55, 0x20000
    s_cselect_b64 vcc, -1, 0
    v_bfe_u32 v2, v1, 1, 3
    v_xor_b32 v2, v2, v7
    v_and_b32 v3, 1, v1
    v_mul_u32_u24 v82, 3584, v7
    v_lshl_add_u32 v82, v3, 4, v82
    v_xor_b32 v83, 4, v2
    v_lshl_add_u32 v83, v83, 5, v82
    v_lshl_add_u32 v82, v2, 5, v82
    v_bfe_u32 v2, v1, 1, 2
    v_xor_b32 v2, v2, v7
    v_lshlrev_b32 v2, 5, v2
    v_lshl_add_u32 v2, v3, 4, v2
    v_lshrrev_b32 v3, 3, v1
    v_lshl_add_u32 v2, v3, 10, v2
    v_cndmask_b32 v82, v2, v82, vcc
    v_cndmask_b32 v83, v2, v83, vcc
    s_lshl_b32 s98, s88, 13
    s_add_u32 s98, s98, 116736
    s_and_b32 s66, s2, 15
    s_lshr_b32 s67, s2, 4
    s_mul_i32 s67, s67, 7
    s_mul_i32 s94, s66, 114688
    s_lshl_b32 s68, s67, 5
    s_add_u32 s94, s94, s68
    s_lshl_b32 s96, s67, 14
    s_lshl_b32 s68, s66, 10
    s_add_u32 s96, s96, s68
    s_add_u32 s96, s96, 7536640
    s_lshr_b32 s66, s2, 3
    s_mul_i32 s67, s66, 21846
    s_lshr_b32 s67, s67, 16
    s_lshl_b32 s68, s66, 5
    s_lshl_b32 s67, s67, 4
    s_add_u32 s67, s67, s68
    s_sub_u32 s68, s66, 24
    s_mul_i32 s68, s68, 224
    s_add_u32 s68, s68, 96
    s_cmp_ge_u32 s66, 24
    s_cselect_b32 s67, s68, s67
    s_cselect_b32 s71, 98304, 0
    s_lshl_b32 s95, s67, 10
    s_and_b32 s68, s2, 7
    s_lshl_b32 s67, s68, 7
    s_add_u32 s95, s95, s67
    s_mul_i32 s97, s68, 28
    s_add_u32 s97, s97, s66
    s_lshl_b32 s97, s97, 12
    s_add_u32 s97, s97, 17825792
    s_cmp_ge_u32 s2, 224
    s_cselect_b32 s95, 1073741824, s95
    s_cselect_b32 s97, 1073741824, s97
    s_add_u32 s70, s94, 0
    s_add_u32 s69, s95, 0
    s_cmp_eq_u32 s88, 0
    s_cselect_b32 s70, s70, s69
    s_add_u32 m0, s98, 0
    s_nop 0
    buffer_load_dwordx4 v82, s[52:55], s70 offen nt lds
    s_add_u32 s70, s94, 14336
    s_add_u32 s69, s95, 8192
    s_cmp_eq_u32 s88, 0
    s_cselect_b32 s70, s70, s69
    s_add_u32 m0, s98, 1024
    s_nop 0
    buffer_load_dwordx4 v83, s[52:55], s70 offen nt lds
    s_add_u32 s70, s94, 28672
    s_add_u32 s69, s95, 16384
    s_add_u32 s69, s69, s71
    s_cmp_eq_u32 s88, 0
    s_cselect_b32 s70, s70, s69
    s_add_u32 m0, s98, 2048
    s_nop 0
    buffer_load_dwordx4 v82, s[52:55], s70 offen nt lds
    s_add_u32 s70, s94, 43008
    s_add_u32 s69, s95, 24576
    s_add_u32 s69, s69, s71
    s_cmp_eq_u32 s88, 0
    s_cselect_b32 s70, s70, s69
    s_add_u32 m0, s98, 3072
    s_nop 0
    buffer_load_dwordx4 v83, s[52:55], s70 offen nt lds
    s_add_u32 s70, s94, 57344
    s_mov_b32 s69, 1073741824
    s_cmp_eq_u32 s88, 0
    s_cselect_b32 s70, s70, s69
    s_add_u32 m0, s98, 4096
    s_nop 0
    buffer_load_dwordx4 v82, s[52:55], s70 offen nt lds
    s_add_u32 s70, s94, 71680
    s_mov_b32 s69, 1073741824
    s_cmp_eq_u32 s88, 0
    s_cselect_b32 s70, s70, s69
    s_add_u32 m0, s98, 5120
    s_nop 0
    buffer_load_dwordx4 v83, s[52:55], s70 offen nt lds
    s_add_u32 s70, s94, 86016
    s_mov_b32 s69, 1073741824
    s_cmp_eq_u32 s88, 0
    s_cselect_b32 s70, s70, s69
    s_add_u32 m0, s98, 6144
    s_nop 0
    buffer_load_dwordx4 v82, s[52:55], s70 offen nt lds
    s_add_u32 s70, s94, 100352
    s_mov_b32 s69, 1073741824
    s_cmp_eq_u32 s88, 0
    s_cselect_b32 s70, s70, s69
    s_add_u32 m0, s98, 7168
    s_nop 0
    buffer_load_dwordx4 v83, s[52:55], s70 offen nt lds
    s_cmp_eq_u32 s88, 0
    s_cselect_b32 s96, s96, s97
    s_mov_b32 s69, 1024
    s_cselect_b32 s97, 16384, s69
    v_lshlrev_b32 v8, 3, v1
    v_lshlrev_b32 v9, 2, v1
    s_and_b32 s60, s2, 7
    s_lshr_b32 s61, s2, 3
    s_lshr_b32 s62, s60, 1
    s_lshl_b32 s62, s62, 3
    s_and_b32 s63, s61, 7
    s_add_u32 s58, s62, s63
    s_and_b32 s62, s60, 1
    s_lshl_b32 s62, s62, 2
    s_lshr_b32 s63, s61, 3
    s_add_u32 s59, s62, s63
    s_mov_b32 s100, 0
    s_lshl_b32 s87, s60, 6
    s_lshl_b32 s61, s61, 1
    s_add_u32 s87, s87, s61
    s_mov_b32 s36, s34
    s_mov_b32 s37, s35
    s_mov_b32 s38, 20971520
    s_mov_b32 s39, 0x20000
    s_load_dword s57, s[34:35], 0
    s_lshl_b32 s73, s56, 12
    s_add_u32 s73, s73, 100352
    v_lshrrev_b32 v2, 3, v1
    v_and_b32 v3, 7, v1
    v_lshlrev_b32 v85, 12, v2
    v_lshl_add_u32 v85, v3, 4, v85
    v_lshrrev_b32 v86, 5, v1
    v_xor_b32 v86, v86, v3
    v_lshlrev_b32 v86, 4, v86
    v_lshl_add_u32 v86, v2, 7, v86
    v_add_u32 v86, s73, v86
    v_xor_b32 v87, 32, v86
    v_xor_b32 v88, 64, v86
    v_xor_b32 v89, 96, v86
    v_xor_b32 v2, v2, v3
    v_lshlrev_b32 v84, 9, v3
    v_lshl_add_u32 v84, v2, 4, v84
    v_add_u32 v84, s73, v84
    s_and_b32 s74, s2, 7
    s_lshl_b32 s74, s74, 18
    s_and_b32 s76, s56, 1
    s_lshl_b32 s76, s76, 17
    s_add_u32 s74, s74, s76
    s_lshr_b32 s75, s2, 3
    s_lshl_b32 s75, s75, 7
    s_add_u32 s74, s74, s75
    s_add_u32 s74, s74, 3211264
    s_add_u32 s75, s74, 32768
    s_add_u32 s76, s74, 65536
    s_add_u32 s77, s74, 98304
    s_mov_b32 s78, 0x05040100
    s_mov_b32 s79, 0x07060302
    s_waitcnt vmcnt(13)
    v_perm_b32 v90, v14, v12, s78
    v_perm_b32 v91, v18, v16, s78
    v_perm_b32 v92, v22, v20, s78
    v_perm_b32 v93, v26, v24, s78
    ds_write_b128 v84, v[90:93] offset:0
    v_perm_b32 v94, v14, v12, s79
    v_perm_b32 v95, v18, v16, s79
    v_perm_b32 v96, v22, v20, s79
    v_perm_b32 v97, v26, v24, s79
    ds_write_b128 v84, v[94:97] offset:128
    v_perm_b32 v98, v15, v13, s78
    v_perm_b32 v99, v19, v17, s78
    v_perm_b32 v100, v23, v21, s78
    v_perm_b32 v101, v27, v25, s78
    ds_write_b128 v84, v[98:101] offset:256
    v_perm_b32 v102, v15, v13, s79
    v_perm_b32 v103, v19, v17, s79
    v_perm_b32 v104, v23, v21, s79
    v_perm_b32 v105, v27, v25, s79
    ds_write_b128 v84, v[102:105] offset:384
    s_mov_b32 s40, s28
    s_mov_b32 s41, s29
    s_mov_b32 s42, 3145728
    s_mov_b32 s43, 0x20000
    buffer_load_dwordx4 v[44:47], v80, s[40:43], s93 offen nt
    s_add_u32 s93, s93, 6144
    buffer_load_dwordx4 v[48:51], v80, s[40:43], s93 offen nt
    s_add_u32 s93, s93, 6144
    buffer_load_dwordx4 v[52:55], v80, s[40:43], s93 offen nt
    s_add_u32 s93, s93, 6144
    buffer_load_dwordx4 v[56:59], v80, s[40:43], s93 offen nt
    s_add_u32 s93, s93, 6144
    buffer_load_dwordx4 v[60:63], v80, s[40:43], s93 offen nt
    s_add_u32 s93, s93, 6144
    buffer_load_dwordx4 v[64:67], v80, s[40:43], s93 offen nt
    s_add_u32 s93, s93, 6144
    buffer_load_dwordx4 v[68:71], v80, s[40:43], s93 offen nt
    s_add_u32 s93, s93, 6144
    buffer_load_dwordx4 v[72:75], v80, s[40:43], s93 offen nt
    s_waitcnt lgkmcnt(0)
    ds_read_b128 v[90:93], v86 offset:0
    ds_read_b128 v[94:97], v87 offset:1024
    ds_read_b128 v[98:101], v88 offset:2048
    ds_read_b128 v[102:105], v89 offset:3072
    s_waitcnt lgkmcnt(3)
    buffer_store_dwordx4 v[90:93], v85, s[36:39], s74 offen sc1
    s_waitcnt lgkmcnt(2)
    buffer_store_dwordx4 v[94:97], v85, s[36:39], s75 offen sc1
    s_waitcnt lgkmcnt(1)
    buffer_store_dwordx4 v[98:101], v85, s[36:39], s76 offen sc1
    s_waitcnt lgkmcnt(0)
    buffer_store_dwordx4 v[102:105], v85, s[36:39], s77 offen sc1
    s_waitcnt vmcnt(20)
    v_lshlrev_b32 v106, 16, v28
    v_and_b32 v107, 0xffff0000, v28
    v_lshlrev_b32 v108, 16, v29
    v_and_b32 v109, 0xffff0000, v29
    v_lshlrev_b32 v110, 16, v30
    v_and_b32 v111, 0xffff0000, v30
    v_lshlrev_b32 v112, 16, v31
    v_and_b32 v113, 0xffff0000, v31
    v_lshlrev_b32 v114, 16, v32
    v_and_b32 v115, 0xffff0000, v32
    v_lshlrev_b32 v116, 16, v33
    v_and_b32 v117, 0xffff0000, v33
    v_lshlrev_b32 v118, 16, v34
    v_and_b32 v119, 0xffff0000, v34
    v_lshlrev_b32 v120, 16, v35
    v_and_b32 v121, 0xffff0000, v35
    v_lshlrev_b32 v122, 16, v36
    v_and_b32 v123, 0xffff0000, v36
    v_lshlrev_b32 v124, 16, v37
    v_and_b32 v125, 0xffff0000, v37
    v_lshlrev_b32 v126, 16, v38
    v_and_b32 v127, 0xffff0000, v38
    v_lshlrev_b32 v128, 16, v39
    v_and_b32 v129, 0xffff0000, v39
    v_lshlrev_b32 v130, 16, v40
    v_and_b32 v131, 0xffff0000, v40
    v_lshlrev_b32 v132, 16, v41
    v_and_b32 v133, 0xffff0000, v41
    v_lshlrev_b32 v134, 16, v42
    v_and_b32 v135, 0xffff0000, v42
    v_lshlrev_b32 v136, 16, v43
    v_and_b32 v137, 0xffff0000, v43
    v_pk_add_f32 v[138:139], v[106:107], v[108:109]
    v_pk_add_f32 v[140:141], v[114:115], v[116:117]
    v_pk_add_f32 v[142:143], v[122:123], v[124:125]
    v_pk_add_f32 v[144:145], v[130:131], v[132:133]
    v_pk_add_f32 v[138:139], v[138:139], v[110:111]
    v_pk_add_f32 v[140:141], v[140:141], v[118:119]
    v_pk_add_f32 v[142:143], v[142:143], v[126:127]
    v_pk_add_f32 v[144:145], v[144:145], v[134:135]
    v_pk_add_f32 v[138:139], v[138:139], v[112:113]
    v_pk_add_f32 v[140:141], v[140:141], v[120:121]
    v_pk_add_f32 v[142:143], v[142:143], v[128:129]
    v_pk_add_f32 v[144:145], v[144:145], v[136:137]
    v_add_f32 v138, v138, v139
    v_add_f32 v140, v140, v141
    v_add_f32 v142, v142, v143
    v_add_f32 v144, v144, v145
    v_add_f32_dpp v138, v138, v138 quad_perm:[1,0,3,2] row_mask:0xf bank_mask:0xf
    v_add_f32_dpp v140, v140, v140 quad_perm:[1,0,3,2] row_mask:0xf bank_mask:0xf
    v_add_f32_dpp v142, v142, v142 quad_perm:[1,0,3,2] row_mask:0xf bank_mask:0xf
    v_add_f32_dpp v144, v144, v144 quad_perm:[1,0,3,2] row_mask:0xf bank_mask:0xf
    v_add_f32_dpp v138, v138, v138 quad_perm:[2,3,0,1] row_mask:0xf bank_mask:0xf
    v_add_f32_dpp v140, v140, v140 quad_perm:[2,3,0,1] row_mask:0xf bank_mask:0xf
    v_add_f32_dpp v142, v142, v142 quad_perm:[2,3,0,1] row_mask:0xf bank_mask:0xf
    v_add_f32_dpp v144, v144, v144 quad_perm:[2,3,0,1] row_mask:0xf bank_mask:0xf
    v_add_f32_dpp v138, v138, v138 row_half_mirror row_mask:0xf bank_mask:0xf
    v_add_f32_dpp v140, v140, v140 row_half_mirror row_mask:0xf bank_mask:0xf
    v_add_f32_dpp v142, v142, v142 row_half_mirror row_mask:0xf bank_mask:0xf
    v_add_f32_dpp v144, v144, v144 row_half_mirror row_mask:0xf bank_mask:0xf
    v_add_f32_dpp v138, v138, v138 row_mirror row_mask:0xf bank_mask:0xf
    v_add_f32_dpp v140, v140, v140 row_mirror row_mask:0xf bank_mask:0xf
    v_add_f32_dpp v142, v142, v142 row_mirror row_mask:0xf bank_mask:0xf
    v_add_f32_dpp v144, v144, v144 row_mirror row_mask:0xf bank_mask:0xf
    v_mov_b32 v154, v138
    v_mov_b32 v155, v140
    v_mov_b32 v156, v142
    v_mov_b32 v157, v144
    v_permlane16_swap_b32 v138, v154
    v_permlane16_swap_b32 v140, v155
    v_permlane16_swap_b32 v142, v156
    v_permlane16_swap_b32 v144, v157
    v_add_f32 v138, v138, v154
    v_add_f32 v140, v140, v155
    v_add_f32 v142, v142, v156
    v_add_f32 v144, v144, v157
    v_mov_b32 v154, v138
    v_mov_b32 v155, v140
    v_mov_b32 v156, v142
    v_mov_b32 v157, v144
    v_permlane32_swap_b32 v138, v154
    v_permlane32_swap_b32 v140, v155
    v_permlane32_swap_b32 v142, v156
    v_permlane32_swap_b32 v144, v157
    v_add_f32 v138, v138, v154
    v_add_f32 v140, v140, v155
    v_add_f32 v142, v142, v156
    v_add_f32 v144, v144, v157
    v_mul_f32 v138, -0.001953125, v138
    v_mul_f32 v140, -0.001953125, v140
    v_mul_f32 v142, -0.001953125, v142
    v_mul_f32 v144, -0.001953125, v144
    v_pk_add_f32 v[106:107], v[106:107], v[138:139] op_sel_hi:[1,0]
    v_pk_add_f32 v[108:109], v[108:109], v[138:139] op_sel_hi:[1,0]
    v_pk_add_f32 v[110:111], v[110:111], v[138:139] op_sel_hi:[1,0]
    v_pk_add_f32 v[112:113], v[112:113], v[138:139] op_sel_hi:[1,0]
    v_pk_add_f32 v[114:115], v[114:115], v[140:141] op_sel_hi:[1,0]
    v_pk_add_f32 v[116:117], v[116:117], v[140:141] op_sel_hi:[1,0]
    v_pk_add_f32 v[118:119], v[118:119], v[140:141] op_sel_hi:[1,0]
    v_pk_add_f32 v[120:121], v[120:121], v[140:141] op_sel_hi:[1,0]
    v_pk_add_f32 v[122:123], v[122:123], v[142:143] op_sel_hi:[1,0]
    v_pk_add_f32 v[124:125], v[124:125], v[142:143] op_sel_hi:[1,0]
    v_pk_add_f32 v[126:127], v[126:127], v[142:143] op_sel_hi:[1,0]
    v_pk_add_f32 v[128:129], v[128:129], v[142:143] op_sel_hi:[1,0]
    v_pk_add_f32 v[130:131], v[130:131], v[144:145] op_sel_hi:[1,0]
    v_pk_add_f32 v[132:133], v[132:133], v[144:145] op_sel_hi:[1,0]
    v_pk_add_f32 v[134:135], v[134:135], v[144:145] op_sel_hi:[1,0]
    v_pk_add_f32 v[136:137], v[136:137], v[144:145] op_sel_hi:[1,0]
    v_pk_mul_f32 v[146:147], v[106:107], v[106:107]
    v_pk_mul_f32 v[148:149], v[114:115], v[114:115]
    v_pk_mul_f32 v[150:151], v[122:123], v[122:123]
    v_pk_mul_f32 v[152:153], v[130:131], v[130:131]
    v_pk_fma_f32 v[146:147], v[108:109], v[108:109], v[146:147]
    v_pk_fma_f32 v[148:149], v[116:117], v[116:117], v[148:149]
    v_pk_fma_f32 v[150:151], v[124:125], v[124:125], v[150:151]
    v_pk_fma_f32 v[152:153], v[132:133], v[132:133], v[152:153]
    v_pk_fma_f32 v[146:147], v[110:111], v[110:111], v[146:147]
    v_pk_fma_f32 v[148:149], v[118:119], v[118:119], v[148:149]
    v_pk_fma_f32 v[150:151], v[126:127], v[126:127], v[150:151]
    v_pk_fma_f32 v[152:153], v[134:135], v[134:135], v[152:153]
    v_pk_fma_f32 v[146:147], v[112:113], v[112:113], v[146:147]
    v_pk_fma_f32 v[148:149], v[120:121], v[120:121], v[148:149]
    v_pk_fma_f32 v[150:151], v[128:129], v[128:129], v[150:151]
    v_pk_fma_f32 v[152:153], v[136:137], v[136:137], v[152:153]
    v_add_f32 v146, v146, v147
    v_add_f32 v148, v148, v149
    v_add_f32 v150, v150, v151
    v_add_f32 v152, v152, v153
    v_add_f32_dpp v146, v146, v146 quad_perm:[1,0,3,2] row_mask:0xf bank_mask:0xf
    v_add_f32_dpp v148, v148, v148 quad_perm:[1,0,3,2] row_mask:0xf bank_mask:0xf
    v_add_f32_dpp v150, v150, v150 quad_perm:[1,0,3,2] row_mask:0xf bank_mask:0xf
    v_add_f32_dpp v152, v152, v152 quad_perm:[1,0,3,2] row_mask:0xf bank_mask:0xf
    v_add_f32_dpp v146, v146, v146 quad_perm:[2,3,0,1] row_mask:0xf bank_mask:0xf
    v_add_f32_dpp v148, v148, v148 quad_perm:[2,3,0,1] row_mask:0xf bank_mask:0xf
    v_add_f32_dpp v150, v150, v150 quad_perm:[2,3,0,1] row_mask:0xf bank_mask:0xf
    v_add_f32_dpp v152, v152, v152 quad_perm:[2,3,0,1] row_mask:0xf bank_mask:0xf
    v_add_f32_dpp v146, v146, v146 row_half_mirror row_mask:0xf bank_mask:0xf
    v_add_f32_dpp v148, v148, v148 row_half_mirror row_mask:0xf bank_mask:0xf
    v_add_f32_dpp v150, v150, v150 row_half_mirror row_mask:0xf bank_mask:0xf
    v_add_f32_dpp v152, v152, v152 row_half_mirror row_mask:0xf bank_mask:0xf
    v_add_f32_dpp v146, v146, v146 row_mirror row_mask:0xf bank_mask:0xf
    v_add_f32_dpp v148, v148, v148 row_mirror row_mask:0xf bank_mask:0xf
    v_add_f32_dpp v150, v150, v150 row_mirror row_mask:0xf bank_mask:0xf
    v_add_f32_dpp v152, v152, v152 row_mirror row_mask:0xf bank_mask:0xf
    v_mov_b32 v154, v146
    v_mov_b32 v155, v148
    v_mov_b32 v156, v150
    v_mov_b32 v157, v152
    v_permlane16_swap_b32 v146, v154
    v_permlane16_swap_b32 v148, v155
    v_permlane16_swap_b32 v150, v156
    v_permlane16_swap_b32 v152, v157
    v_add_f32 v146, v146, v154
    v_add_f32 v148, v148, v155
    v_add_f32 v150, v150, v156
    v_add_f32 v152, v152, v157
    v_mov_b32 v154, v146
    v_mov_b32 v155, v148
    v_mov_b32 v156, v150
    v_mov_b32 v157, v152
    v_permlane32_swap_b32 v146, v154
    v_permlane32_swap_b32 v148, v155
    v_permlane32_swap_b32 v150, v156
    v_permlane32_swap_b32 v152, v157
    v_add_f32 v146, v146, v154
    v_add_f32 v148, v148, v155
    v_add_f32 v150, v150, v156
    v_add_f32 v152, v152, v157
    v_mov_b32 v154, 1e-5
    v_mov_b32 v155, 0.001953125
    v_fma_f32 v146, v146, v155, v154
    v_fma_f32 v148, v148, v155, v154
    v_fma_f32 v150, v150, v155, v154
    v_fma_f32 v152, v152, v155, v154
    v_rsq_f32 v158, v146
    v_rsq_f32 v159, v148
    v_rsq_f32 v160, v150
    v_rsq_f32 v161, v152
    v_mul_f32 v162, v138, v158
    v_mul_f32 v163, v140, v159
    v_mul_f32 v164, v142, v160
    v_mul_f32 v165, v144, v161
    s_lshl_b32 s63, s2, 5
    s_lshl_b32 s64, s88, 4
    s_add_u32 s63, s63, s64
    s_add_u32 s63, s63, 262144
    s_add_u32 s64, s63, 8192
    s_mov_b64 exec, 1
    buffer_store_dwordx4 v[158:161], v4, s[36:39], s63 offen sc1
    buffer_store_dwordx4 v[162:165], v4, s[36:39], s64 offen sc1
    s_mov_b64 exec, -1
    s_waitcnt lgkmcnt(0)
    s_mul_i32 s57, s57, 0x9E3779B1
    s_add_u32 s57, s57, 0x7F4A7C15
    v_lshlrev_b32 v138, 16, v76
    v_and_b32 v139, 0xffff0000, v76
    v_lshlrev_b32 v140, 16, v77
    v_and_b32 v141, 0xffff0000, v77
    v_lshlrev_b32 v142, 16, v78
    v_and_b32 v143, 0xffff0000, v78
    v_lshlrev_b32 v144, 16, v79
    v_and_b32 v145, 0xffff0000, v79
    v_mul_f32 v146, -1.442695041, v138
    v_mul_f32 v147, -1.442695041, v139
    v_mul_f32 v148, -1.442695041, v140
    v_mul_f32 v149, -1.442695041, v141
    v_mul_f32 v150, -1.442695041, v142
    v_mul_f32 v151, -1.442695041, v143
    v_mul_f32 v152, -1.442695041, v144
    v_mul_f32 v153, -1.442695041, v145
    v_exp_f32 v146, v146
    v_exp_f32 v147, v147
    v_exp_f32 v148, v148
    v_exp_f32 v149, v149
    v_exp_f32 v150, v150
    v_exp_f32 v151, v151
    v_exp_f32 v152, v152
    v_exp_f32 v153, v153
    v_add_f32 v146, 1.0, v146
    v_add_f32 v147, 1.0, v147
    v_add_f32 v148, 1.0, v148
    v_add_f32 v149, 1.0, v149
    v_add_f32 v150, 1.0, v150
    v_add_f32 v151, 1.0, v151
    v_add_f32 v152, 1.0, v152
    v_add_f32 v153, 1.0, v153
    v_rcp_f32 v146, v146
    v_rcp_f32 v147, v147
    v_rcp_f32 v148, v148
    v_rcp_f32 v149, v149
    v_rcp_f32 v150, v150
    v_rcp_f32 v151, v151
    v_rcp_f32 v152, v152
    v_rcp_f32 v153, v153
    v_mul_f32 v138, v138, v146
    v_mul_f32 v139, v139, v147
    v_mul_f32 v140, v140, v148
    v_mul_f32 v141, v141, v149
    v_mul_f32 v142, v142, v150
    v_mul_f32 v143, v143, v151
    v_mul_f32 v144, v144, v152
    v_mul_f32 v145, v145, v153
    v_cvt_pk_bf16_f32 v146, v138, v139
    v_cvt_pk_bf16_f32 v147, v140, v141
    v_cvt_pk_bf16_f32 v148, v142, v143
    v_cvt_pk_bf16_f32 v149, v144, v145
    v_lshlrev_b32 v138, 16, v146
    v_and_b32 v139, 0xffff0000, v146
    v_lshlrev_b32 v140, 16, v147
    v_and_b32 v141, 0xffff0000, v147
    v_lshlrev_b32 v142, 16, v148
    v_and_b32 v143, 0xffff0000, v148
    v_lshlrev_b32 v144, 16, v149
    v_and_b32 v145, 0xffff0000, v149
    v_and_b32 v2, 7, v1
    v_lshlrev_b32 v2, 5, v2
    v_and_b32 v3, 1, v7
    v_lshl_add_u32 v2, v3, 4, v2
    v_lshrrev_b32 v3, 1, v7
    v_lshl_add_u32 v166, v3, 3, v2
    s_mul_i32 s90, s90, 12288
    s_lshl_b32 s64, s89, 8
    s_add_u32 s90, s90, s64
    s_add_u32 s90, s90, 278528
    s_cmp_ge_u32 s2, 192
    s_cselect_b32 s90, 1073741824, s90
    s_waitcnt vmcnt(13)
    v_lshlrev_b32 v12, 16, v44
    v_and_b32 v13, 0xffff0000, v44
    v_lshlrev_b32 v14, 16, v45
    v_and_b32 v15, 0xffff0000, v45
    v_lshlrev_b32 v16, 16, v46
    v_and_b32 v17, 0xffff0000, v46
    v_lshlrev_b32 v18, 16, v47
    v_and_b32 v19, 0xffff0000, v47
    v_pk_mul_f32 v[106:107], v[12:13], v[138:139] op_sel_hi:[1,0]
    v_pk_mul_f32 v[108:109], v[14:15], v[138:139] op_sel_hi:[1,0]
    v_pk_mul_f32 v[110:111], v[16:17], v[138:139] op_sel_hi:[1,0]
    v_pk_mul_f32 v[112:113], v[18:19], v[138:139] op_sel_hi:[1,0]
    s_waitcnt vmcnt(12)
    v_lshlrev_b32 v20, 16, v48
    v_and_b32 v21, 0xffff0000, v48
    v_lshlrev_b32 v22, 16, v49
    v_and_b32 v23, 0xffff0000, v49
    v_lshlrev_b32 v24, 16, v50
    v_and_b32 v25, 0xffff0000, v50
    v_lshlrev_b32 v26, 16, v51
    v_and_b32 v27, 0xffff0000, v51
    v_pk_fma_f32 v[106:107], v[20:21], v[138:139], v[106:107] op_sel:[0,1,0] op_sel_hi:[1,1,1]
    v_pk_fma_f32 v[108:109], v[22:23], v[138:139], v[108:109] op_sel:[0,1,0] op_sel_hi:[1,1,1]
    v_pk_fma_f32 v[110:111], v[24:25], v[138:139], v[110:111] op_sel:[0,1,0] op_sel_hi:[1,1,1]
    v_pk_fma_f32 v[112:113], v[26:27], v[138:139], v[112:113] op_sel:[0,1,0] op_sel_hi:[1,1,1]
    s_waitcnt vmcnt(11)
    v_lshlrev_b32 v12, 16, v52
    v_and_b32 v13, 0xffff0000, v52
    v_lshlrev_b32 v14, 16, v53
    v_and_b32 v15, 0xffff0000, v53
    v_lshlrev_b32 v16, 16, v54
    v_and_b32 v17, 0xffff0000, v54
    v_lshlrev_b32 v18, 16, v55
    v_and_b32 v19, 0xffff0000, v55
    v_pk_fma_f32 v[106:107], v[12:13], v[140:141], v[106:107] op_sel:[0,0,0] op_sel_hi:[1,0,1]
    v_pk_fma_f32 v[108:109], v[14:15], v[140:141], v[108:109] op_sel:[0,0,0] op_sel_hi:[1,0,1]
    v_pk_fma_f32 v[110:111], v[16:17], v[140:141], v[110:111] op_sel:[0,0,0] op_sel_hi:[1,0,1]
    v_pk_fma_f32 v[112:113], v[18:19], v[140:141], v[112:113] op_sel:[0,0,0] op_sel_hi:[1,0,1]
    s_waitcnt vmcnt(10)
    v_lshlrev_b32 v20, 16, v56
    v_and_b32 v21, 0xffff0000, v56
    v_lshlrev_b32 v22, 16, v57
    v_and_b32 v23, 0xffff0000, v57
    v_lshlrev_b32 v24, 16, v58
    v_and_b32 v25, 0xffff0000, v58
    v_lshlrev_b32 v26, 16, v59
    v_and_b32 v27, 0xffff0000, v59
    v_pk_fma_f32 v[106:107], v[20:21], v[140:141], v[106:107] op_sel:[0,1,0] op_sel_hi:[1,1,1]
    v_pk_fma_f32 v[108:109], v[22:23], v[140:141], v[108:109] op_sel:[0,1,0] op_sel_hi:[1,1,1]
    v_pk_fma_f32 v[110:111], v[24:25], v[140:141], v[110:111] op_sel:[0,1,0] op_sel_hi:[1,1,1]
    v_pk_fma_f32 v[112:113], v[26:27], v[140:141], v[112:113] op_sel:[0,1,0] op_sel_hi:[1,1,1]
    s_waitcnt vmcnt(9)
    v_lshlrev_b32 v12, 16, v60
    v_and_b32 v13, 0xffff0000, v60
    v_lshlrev_b32 v14, 16, v61
    v_and_b32 v15, 0xffff0000, v61
    v_lshlrev_b32 v16, 16, v62
    v_and_b32 v17, 0xffff0000, v62
    v_lshlrev_b32 v18, 16, v63
    v_and_b32 v19, 0xffff0000, v63
    v_pk_fma_f32 v[106:107], v[12:13], v[142:143], v[106:107] op_sel:[0,0,0] op_sel_hi:[1,0,1]
    v_pk_fma_f32 v[108:109], v[14:15], v[142:143], v[108:109] op_sel:[0,0,0] op_sel_hi:[1,0,1]
    v_pk_fma_f32 v[110:111], v[16:17], v[142:143], v[110:111] op_sel:[0,0,0] op_sel_hi:[1,0,1]
    v_pk_fma_f32 v[112:113], v[18:19], v[142:143], v[112:113] op_sel:[0,0,0] op_sel_hi:[1,0,1]
    s_waitcnt vmcnt(8)
    v_lshlrev_b32 v20, 16, v64
    v_and_b32 v21, 0xffff0000, v64
    v_lshlrev_b32 v22, 16, v65
    v_and_b32 v23, 0xffff0000, v65
    v_lshlrev_b32 v24, 16, v66
    v_and_b32 v25, 0xffff0000, v66
    v_lshlrev_b32 v26, 16, v67
    v_and_b32 v27, 0xffff0000, v67
    v_pk_fma_f32 v[106:107], v[20:21], v[142:143], v[106:107] op_sel:[0,1,0] op_sel_hi:[1,1,1]
    v_pk_fma_f32 v[108:109], v[22:23], v[142:143], v[108:109] op_sel:[0,1,0] op_sel_hi:[1,1,1]
    v_pk_fma_f32 v[110:111], v[24:25], v[142:143], v[110:111] op_sel:[0,1,0] op_sel_hi:[1,1,1]
    v_pk_fma_f32 v[112:113], v[26:27], v[142:143], v[112:113] op_sel:[0,1,0] op_sel_hi:[1,1,1]
    s_waitcnt vmcnt(7)
    v_lshlrev_b32 v12, 16, v68
    v_and_b32 v13, 0xffff0000, v68
    v_lshlrev_b32 v14, 16, v69
    v_and_b32 v15, 0xffff0000, v69
    v_lshlrev_b32 v16, 16, v70
    v_and_b32 v17, 0xffff0000, v70
    v_lshlrev_b32 v18, 16, v71
    v_and_b32 v19, 0xffff0000, v71
    v_pk_fma_f32 v[106:107], v[12:13], v[144:145], v[106:107] op_sel:[0,0,0] op_sel_hi:[1,0,1]
    v_pk_fma_f32 v[108:109], v[14:15], v[144:145], v[108:109] op_sel:[0,0,0] op_sel_hi:[1,0,1]
    v_pk_fma_f32 v[110:111], v[16:17], v[144:145], v[110:111] op_sel:[0,0,0] op_sel_hi:[1,0,1]
    v_pk_fma_f32 v[112:113], v[18:19], v[144:145], v[112:113] op_sel:[0,0,0] op_sel_hi:[1,0,1]
    s_waitcnt vmcnt(6)
    v_lshlrev_b32 v20, 16, v72
    v_and_b32 v21, 0xffff0000, v72
    v_lshlrev_b32 v22, 16, v73
    v_and_b32 v23, 0xffff0000, v73
    v_lshlrev_b32 v24, 16, v74
    v_and_b32 v25, 0xffff0000, v74
    v_lshlrev_b32 v26, 16, v75
    v_and_b32 v27, 0xffff0000, v75
    v_pk_fma_f32 v[106:107], v[20:21], v[144:145], v[106:107] op_sel:[0,1,0] op_sel_hi:[1,1,1]
    v_pk_fma_f32 v[108:109], v[22:23], v[144:145], v[108:109] op_sel:[0,1,0] op_sel_hi:[1,1,1]
    v_pk_fma_f32 v[110:111], v[24:25], v[144:145], v[110:111] op_sel:[0,1,0] op_sel_hi:[1,1,1]
    v_pk_fma_f32 v[112:113], v[26:27], v[144:145], v[112:113] op_sel:[0,1,0] op_sel_hi:[1,1,1]
    v_add_f32_dpp v106, v106, v106 row_ror:8 row_mask:0xf bank_mask:0xf
    v_add_f32_dpp v107, v107, v107 row_ror:8 row_mask:0xf bank_mask:0xf
    v_add_f32_dpp v108, v108, v108 row_ror:8 row_mask:0xf bank_mask:0xf
    v_add_f32_dpp v109, v109, v109 row_ror:8 row_mask:0xf bank_mask:0xf
    v_add_f32_dpp v110, v110, v110 row_ror:8 row_mask:0xf bank_mask:0xf
    v_add_f32_dpp v111, v111, v111 row_ror:8 row_mask:0xf bank_mask:0xf
    v_add_f32_dpp v112, v112, v112 row_ror:8 row_mask:0xf bank_mask:0xf
    v_add_f32_dpp v113, v113, v113 row_ror:8 row_mask:0xf bank_mask:0xf
    v_permlane16_swap_b32 v106, v110
    v_permlane16_swap_b32 v107, v111
    v_permlane16_swap_b32 v108, v112
    v_permlane16_swap_b32 v109, v113
    v_add_f32 v106, v106, v110
    v_add_f32 v107, v107, v111
    v_add_f32 v108, v108, v112
    v_add_f32 v109, v109, v113
    s_nop 0
    v_permlane32_swap_b32 v106, v108
    v_permlane32_swap_b32 v107, v109
    v_add_f32 v106, v106, v108
    v_add_f32 v107, v107, v109
    s_mov_b32 exec_lo, 0x00ff00ff
    s_mov_b32 exec_hi, 0x00ff00ff
    buffer_store_dwordx2 v[106:107], v166, s[36:39], s90 offen sc1
    s_mov_b64 exec, -1
    s_and_b32 s16, s2, 7
    s_lshl_b32 s16, s16, 7
    s_add_u32 s16, s16, 4096
    buffer_load_dword v246, v4, s[36:39], s16 offen sc1
    s_cmp_eq_u32 s88, 0
    s_cselect_b64 vcc, -1, 0
    s_cselect_b32 s69, 8, 7
    s_cselect_b32 s70, 12, 11
    v_lshrrev_b32 v2, 2, v1
    v_lshlrev_b32 v167, s69, v2
    v_and_b32 v3, 7, v2
    v_bfe_u32 v2, v1, 3, 2
    v_cndmask_b32 v2, v2, v3, vcc
    v_lshl_add_u32 v167, v2, 5, v167
    v_and_b32 v2, 3, v1
    v_lshl_add_u32 v167, v2, 3, v167
    v_add_u32 v167, s98, v167
    s_lshl_b32 s70, 1, s70
    v_add_u32 v168, s70, v167
    v_xor_b32 v2, 0, v167
    ds_read_b64_tr_b16 v[44:45], v2
    v_xor_b32 v3, 0, v168
    ds_read_b64_tr_b16 v[46:47], v3
    v_xor_b32 v2, 32, v167
    ds_read_b64_tr_b16 v[48:49], v2
    v_xor_b32 v3, 32, v168
    ds_read_b64_tr_b16 v[50:51], v3
    v_xor_b32 v2, 64, v167
    ds_read_b64_tr_b16 v[52:53], v2
    v_xor_b32 v3, 64, v168
    ds_read_b64_tr_b16 v[54:55], v3
    v_xor_b32 v2, 96, v167
    ds_read_b64_tr_b16 v[56:57], v2
    v_xor_b32 v3, 96, v168
    ds_read_b64_tr_b16 v[58:59], v3
    v_xor_b32 v2, 128, v167
    ds_read_b64_tr_b16 v[60:61], v2
    v_xor_b32 v3, 128, v168
    ds_read_b64_tr_b16 v[62:63], v3
    v_xor_b32 v2, 160, v167
    ds_read_b64_tr_b16 v[64:65], v2
    v_xor_b32 v3, 160, v168
    ds_read_b64_tr_b16 v[66:67], v3
    v_xor_b32 v2, 192, v167
    ds_read_b64_tr_b16 v[68:69], v2
    v_xor_b32 v3, 192, v168
    ds_read_b64_tr_b16 v[70:71], v3
    s_waitcnt lgkmcnt(12)
    buffer_store_dwordx4 v[44:47], v5, s[36:39], s96 offen sc1
    s_add_u32 s96, s96, s97
    s_waitcnt lgkmcnt(10)
    buffer_store_dwordx4 v[48:51], v5, s[36:39], s96 offen sc1
    s_add_u32 s96, s96, s97
    s_waitcnt lgkmcnt(8)
    buffer_store_dwordx4 v[52:55], v5, s[36:39], s96 offen sc1
    s_add_u32 s96, s96, s97
    s_waitcnt lgkmcnt(6)
    buffer_store_dwordx4 v[56:59], v5, s[36:39], s96 offen sc1
    s_add_u32 s96, s96, s97
    s_cmp_eq_u32 s88, 0
    s_cselect_b32 s96, s96, 1073741824
    s_waitcnt lgkmcnt(4)
    buffer_store_dwordx4 v[60:63], v5, s[36:39], s96 offen sc1
    s_add_u32 s96, s96, s97
    s_waitcnt lgkmcnt(2)
    buffer_store_dwordx4 v[64:67], v5, s[36:39], s96 offen sc1
    s_add_u32 s96, s96, s97
    s_waitcnt lgkmcnt(0)
    buffer_store_dwordx4 v[68:71], v5, s[36:39], s96 offen sc1
    s_waitcnt vmcnt(0)
    s_mov_b32 s78, 0
    s_waitcnt vmcnt(0)
    s_branch L_pcini_9
L_pollini_8:
    buffer_load_dword v246, v4, s[36:39], s16 offen sc1
    s_waitcnt vmcnt(0)
L_pcini_9:
    v_xor_b32 v2, s57, v246
    v_cmp_ne_u32 vcc, 0, v2
    s_cbranch_vccz L_pdini_10
    s_add_u32 s78, s78, 1
    s_cmp_gt_u32 s78, 200000
    s_cbranch_scc1 L_pdini_10
    s_sleep 2
    s_branch L_pollini_8
L_pdini_10:
    s_and_b32 s63, s2, 7
    s_mul_i32 s63, s63, 128
    s_add_u32 s63, s63, 32768
    v_mov_b32 v2, 1
    v_mul_u32_u24 v3, 1024, v1
    s_mov_b64 exec, 0xffff
    buffer_atomic_add v2, v3, s[36:39], s63 offen sc1
    s_mov_b64 exec, -1
L_pair_7:
L_p0join_2:
    s_lshr_b32 s88, s56, 1
    s_and_b32 s89, s56, 1
    s_add_u32 s90, s87, s88
    s_sub_u32 s91, 3, s89
    s_mov_b32 s92, s89
    s_mul_i32 s95, s88, 6400
    s_add_u32 s95, s95, 70144
    v_and_b32 v2, 7, v1
    v_mul_u32_u24 v10, 4384, v2
    v_lshl_add_u32 v10, v7, 8, v10
    v_bfe_u32 v2, v1, 3, 1
    v_lshl_add_u32 v10, v2, 4, v10
    s_mul_i32 s65, s88, 35072
    v_add_u32 v10, s65, v10
    v_lshlrev_b32 v2, 2, v7
    v_sub_u32 v2, v2, v6
    v_add_u32 v2, 63, v2
    v_mul_u32_u24 v2, 80, v2
    s_mul_i32 s65, s91, 1280
    s_sub_u32 s65, s95, s65
    v_add_u32 v11, s65, v2
    s_mul_i32 s65, s92, 1280
    s_sub_u32 s65, s95, s65
    v_add_u32 v12, s65, v2
    s_waitcnt lgkmcnt(0)
    s_barrier
    s_cmp_eq_u32 s56, 1
    s_cbranch_scc1 L_cw_13
    s_cmp_eq_u32 s56, 2
    s_cbranch_scc1 L_cw_14
    s_cmp_eq_u32 s56, 3
    s_cbranch_scc1 L_cw_15
L_cw_12:
    ds_read_b128 v[106:109], v10 offset:0
    ds_read_b128 v[110:113], v10 offset:16
    ds_read_b128 v[114:117], v10 offset:32
    ds_read_b128 v[146:149], v11 offset:0
    ds_read_b128 v[166:169], v12 offset:0
    ds_read_b128 v[118:121], v10 offset:48
    ds_read_b128 v[150:153], v11 offset:16
    ds_read_b128 v[170:173], v12 offset:16
    ds_read_b128 v[122:125], v10 offset:64
    ds_read_b128 v[154:157], v11 offset:32
    ds_read_b128 v[174:177], v12 offset:32
    ds_read_b128 v[126:129], v10 offset:80
    ds_read_b128 v[158:161], v11 offset:48
    ds_read_b128 v[178:181], v12 offset:48
    s_waitcnt lgkmcnt(9)
    v_mfma_f32_16x16x32_bf16 v[24:27], v[106:109], v[146:149], 0
    ds_read_b128 v[130:133], v10 offset:96
    v_mfma_f32_16x16x32_bf16 v[28:31], v[114:117], v[146:149], 0
    ds_read_b128 v[162:165], v11 offset:80
    v_lshlrev_b32 v15, 6, v6
    v_and_b32 v2, 1, v7
    v_lshl_add_u32 v15, v2, 5, v15
    v_lshrrev_b32 v2, 1, v7
    v_lshl_add_u32 v15, v2, 4, v15
    v_mfma_f32_16x16x32_bf16 v[32:35], v[106:109], v[166:169], 0
    ds_read_b128 v[182:185], v12 offset:80
    v_mfma_f32_16x16x32_bf16 v[36:39], v[114:117], v[166:169], 0
    v_mul_u32_u24 v3, 80, v6
    v_lshl_add_u32 v3, v7, 3, v3
    v_sub_u32 v3, 5064, v3
    s_mul_i32 s65, s91, 1280
    s_sub_u32 s65, s95, s65
    v_add_u32 v13, s65, v3
    s_mul_i32 s65, s92, 1280
    s_sub_u32 s65, s95, s65
    v_add_u32 v14, s65, v3
    s_waitcnt lgkmcnt(9)
    v_mfma_f32_16x16x32_bf16 v[24:27], v[110:113], v[150:153], v[24:27]
    ds_read_b128 v[134:137], v10 offset:112
    v_mfma_f32_16x16x32_bf16 v[28:31], v[118:121], v[150:153], v[28:31]
    ds_read_b128 v[146:149], v11 offset:96
    v_lshlrev_b32 v2, 7, v6
    v_lshl_add_u32 v2, v7, 4, v2
    s_lshl_b32 s64, s91, 11
    s_add_u32 s64, s64, 83968
    v_add_u32 v18, s64, v2
    s_lshl_b32 s64, s92, 11
    s_add_u32 s64, s64, 83968
    v_add_u32 v19, s64, v2
    v_mfma_f32_16x16x32_bf16 v[32:35], v[110:113], v[170:173], v[32:35]
    ds_read_b128 v[166:169], v12 offset:96
    v_mfma_f32_16x16x32_bf16 v[36:39], v[118:121], v[170:173], v[36:39]
    v_lshlrev_b32 v2, 6, v6
    v_lshl_add_u32 v2, v7, 3, v2
    s_lshl_b32 s65, s88, 12
    s_lshl_b32 s64, s91, 10
    s_add_u32 s64, s64, s65
    s_add_u32 s64, s64, 100352
    v_add_u32 v20, s64, v2
    s_lshl_b32 s64, s92, 10
    s_add_u32 s64, s64, s65
    s_add_u32 s64, s64, 100352
    v_add_u32 v21, s64, v2
    s_waitcnt lgkmcnt(9)
    v_mfma_f32_16x16x32_bf16 v[24:27], v[114:117], v[154:157], v[24:27]
    ds_read_b128 v[138:141], v10 offset:128
    v_mfma_f32_16x16x32_bf16 v[28:31], v[122:125], v[154:157], v[28:31]
    ds_read_b128 v[150:153], v11 offset:112
    s_lshl_b32 s60, s90, 12
    s_lshl_b32 s93, s91, 10
    s_add_u32 s93, s93, s60
    s_add_u32 s93, s93, 5373952
    s_lshl_b32 s94, s92, 10
    s_add_u32 s94, s94, s60
    s_add_u32 s94, s94, 5373952
    v_mfma_f32_16x16x32_bf16 v[32:35], v[114:117], v[174:177], v[32:35]
    ds_read_b128 v[170:173], v12 offset:112
    v_mfma_f32_16x16x32_bf16 v[36:39], v[122:125], v[174:177], v[36:39]
    s_mov_b32 s40, s14
    s_mov_b32 s41, s15
    s_mov_b32 s42, 1024
    s_mov_b32 s43, 0x20000
    s_lshl_b32 s60, s90, 1
    buffer_load_ushort v63, v4, s[40:43], s60 offen
    s_waitcnt lgkmcnt(9)
    v_mfma_f32_16x16x32_bf16 v[24:27], v[118:121], v[158:161], v[24:27]
    ds_read_b128 v[142:145], v10 offset:144
    v_mfma_f32_16x16x32_bf16 v[28:31], v[126:129], v[158:161], v[28:31]
    ds_read_b128 v[154:157], v11 offset:128
    s_lshr_b32 s96, s2, 3
    s_and_b32 s96, s96, 15
    s_mul_i32 s96, s96, 1024
    s_add_u32 s96, s96, 32768
    s_lshl_b32 s97, s57, 7
    s_add_u32 s97, s97, 64
    v_min_u32 v16, 7, v1
    v_mul_u32_u24 v16, 128, v16
    v_mfma_f32_16x16x32_bf16 v[32:35], v[118:121], v[178:181], v[32:35]
    ds_read_b128 v[174:177], v12 offset:128
    v_mfma_f32_16x16x32_bf16 v[36:39], v[126:129], v[178:181], v[36:39]
    s_waitcnt lgkmcnt(9)
    v_mfma_f32_16x16x32_bf16 v[24:27], v[122:125], v[162:165], v[24:27]
    ds_read_b128 v[106:109], v10 offset:160
    v_mfma_f32_16x16x32_bf16 v[28:31], v[130:133], v[162:165], v[28:31]
    ds_read_b128 v[158:161], v11 offset:160
    v_mfma_f32_16x16x32_bf16 v[32:35], v[122:125], v[182:185], v[32:35]
    ds_read_b128 v[178:181], v12 offset:160
    v_mfma_f32_16x16x32_bf16 v[36:39], v[130:133], v[182:185], v[36:39]
    s_waitcnt lgkmcnt(9)
    v_mfma_f32_16x16x32_bf16 v[24:27], v[126:129], v[146:149], v[24:27]
    ds_read_b128 v[110:113], v10 offset:176
    v_mfma_f32_16x16x32_bf16 v[28:31], v[134:137], v[146:149], v[28:31]
    ds_read_b128 v[162:165], v11 offset:176
    v_mfma_f32_16x16x32_bf16 v[32:35], v[126:129], v[166:169], v[32:35]
    ds_read_b128 v[182:185], v12 offset:176
    v_mfma_f32_16x16x32_bf16 v[36:39], v[134:137], v[166:169], v[36:39]
    s_waitcnt lgkmcnt(9)
    v_mfma_f32_16x16x32_bf16 v[24:27], v[130:133], v[150:153], v[24:27]
    ds_read_b128 v[114:117], v10 offset:192
    v_mfma_f32_16x16x32_bf16 v[28:31], v[138:141], v[150:153], v[28:31]
    ds_read_b128 v[146:149], v11 offset:192
    v_mfma_f32_16x16x32_bf16 v[32:35], v[130:133], v[170:173], v[32:35]
    ds_read_b128 v[166:169], v12 offset:192
    v_mfma_f32_16x16x32_bf16 v[36:39], v[138:141], v[170:173], v[36:39]
    s_waitcnt lgkmcnt(9)
    v_mfma_f32_16x16x32_bf16 v[24:27], v[134:137], v[154:157], v[24:27]
    ds_read_b128 v[118:121], v10 offset:208
    v_mfma_f32_16x16x32_bf16 v[28:31], v[142:145], v[154:157], v[28:31]
    ds_read_b128 v[150:153], v11 offset:208
    v_mfma_f32_16x16x32_bf16 v[32:35], v[134:137], v[174:177], v[32:35]
    ds_read_b128 v[170:173], v12 offset:208
    v_mfma_f32_16x16x32_bf16 v[36:39], v[142:145], v[174:177], v[36:39]
    s_waitcnt lgkmcnt(9)
    v_mfma_f32_16x16x32_bf16 v[24:27], v[138:141], v[158:161], v[24:27]
    ds_read_b128 v[122:125], v10 offset:224
    v_mfma_f32_16x16x32_bf16 v[28:31], v[106:109], v[158:161], v[28:31]
    ds_read_b128 v[154:157], v11 offset:240
    v_mfma_f32_16x16x32_bf16 v[32:35], v[138:141], v[178:181], v[32:35]
    ds_read_b128 v[174:177], v12 offset:240
    v_mfma_f32_16x16x32_bf16 v[36:39], v[106:109], v[178:181], v[36:39]
    s_waitcnt lgkmcnt(9)
    v_mfma_f32_16x16x32_bf16 v[24:27], v[142:145], v[162:165], v[24:27]
    ds_read_b128 v[126:129], v10 offset:240
    v_mfma_f32_16x16x32_bf16 v[28:31], v[110:113], v[162:165], v[28:31]
    ds_read_b128 v[158:161], v11 offset:256
    v_mfma_f32_16x16x32_bf16 v[32:35], v[142:145], v[182:185], v[32:35]
    ds_read_b128 v[178:181], v12 offset:256
    v_mfma_f32_16x16x32_bf16 v[36:39], v[110:113], v[182:185], v[36:39]
    s_waitcnt lgkmcnt(9)
    v_mfma_f32_16x16x32_bf16 v[24:27], v[106:109], v[146:149], v[24:27]
    ds_read_b128 v[130:133], v10 offset:256
    v_mfma_f32_16x16x32_bf16 v[28:31], v[114:117], v[146:149], v[28:31]
    ds_read_b128 v[162:165], v11 offset:272
    v_mfma_f32_16x16x32_bf16 v[32:35], v[106:109], v[166:169], v[32:35]
    ds_read_b128 v[182:185], v12 offset:272
    v_mfma_f32_16x16x32_bf16 v[36:39], v[114:117], v[166:169], v[36:39]
    s_waitcnt lgkmcnt(9)
    v_mfma_f32_16x16x32_bf16 v[24:27], v[110:113], v[150:153], v[24:27]
    ds_read_b128 v[134:137], v10 offset:272
    v_mfma_f32_16x16x32_bf16 v[28:31], v[118:121], v[150:153], v[28:31]
    ds_read_b128 v[146:149], v11 offset:288
    v_mfma_f32_16x16x32_bf16 v[32:35], v[110:113], v[170:173], v[32:35]
    ds_read_b128 v[166:169], v12 offset:288
    v_mfma_f32_16x16x32_bf16 v[36:39], v[118:121], v[170:173], v[36:39]
    s_waitcnt lgkmcnt(9)
    v_mfma_f32_16x16x32_bf16 v[24:27], v[114:117], v[154:157], v[24:27]
    ds_read_b128 v[138:141], v10 offset:1024
    v_mfma_f32_16x16x32_bf16 v[28:31], v[122:125], v[154:157], v[28:31]
    ds_read_b128 v[142:145], v10 offset:1040
    v_mfma_f32_16x16x32_bf16 v[32:35], v[114:117], v[174:177], v[32:35]
    ds_read_b128 v[106:109], v10 offset:1056
    v_mfma_f32_16x16x32_bf16 v[36:39], v[122:125], v[174:177], v[36:39]
    ds_read_b128 v[150:153], v11 offset:1280
    s_waitcnt lgkmcnt(10)
    v_mfma_f32_16x16x32_bf16 v[24:27], v[118:121], v[158:161], v[24:27]
    ds_read_b128 v[110:113], v10 offset:1072
    v_mfma_f32_16x16x32_bf16 v[28:31], v[126:129], v[158:161], v[28:31]
    ds_read_b128 v[154:157], v11 offset:1296
    v_mfma_f32_16x16x32_bf16 v[32:35], v[118:121], v[178:181], v[32:35]
    v_mfma_f32_16x16x32_bf16 v[36:39], v[126:129], v[178:181], v[36:39]
    s_waitcnt lgkmcnt(9)
    v_mfma_f32_16x16x32_bf16 v[24:27], v[122:125], v[162:165], v[24:27]
    ds_read_b128 v[114:117], v10 offset:1088
    v_mfma_f32_16x16x32_bf16 v[28:31], v[130:133], v[162:165], v[28:31]
    ds_read_b128 v[158:161], v11 offset:1312
    v_mfma_f32_16x16x32_bf16 v[32:35], v[122:125], v[182:185], v[32:35]
    v_mfma_f32_16x16x32_bf16 v[36:39], v[130:133], v[182:185], v[36:39]
    s_waitcnt lgkmcnt(8)
    v_mfma_f32_16x16x32_bf16 v[24:27], v[126:129], v[146:149], v[24:27]
    ds_read_b128 v[118:121], v10 offset:1104
    v_mfma_f32_16x16x32_bf16 v[28:31], v[134:137], v[146:149], v[28:31]
    ds_read_b128 v[162:165], v11 offset:1328
    v_mfma_f32_16x16x32_bf16 v[32:35], v[126:129], v[166:169], v[32:35]
    v_mfma_f32_16x16x32_bf16 v[36:39], v[134:137], v[166:169], v[36:39]
    s_waitcnt lgkmcnt(6)
    v_mfma_f32_16x16x32_bf16 v[24:27], v[138:141], v[150:153], v[24:27]
    ds_read_b128 v[122:125], v10 offset:1120
    v_mfma_f32_16x16x32_bf16 v[28:31], v[106:109], v[150:153], v[28:31]
    ds_read_b128 v[146:149], v11 offset:1360
    s_waitcnt lgkmcnt(6)
    v_mfma_f32_16x16x32_bf16 v[24:27], v[142:145], v[154:157], v[24:27]
    ds_read_b128 v[126:129], v10 offset:1136
    v_mfma_f32_16x16x32_bf16 v[28:31], v[110:113], v[154:157], v[28:31]
    ds_read_b128 v[150:153], v11 offset:1376
    s_waitcnt lgkmcnt(6)
    v_mfma_f32_16x16x32_bf16 v[24:27], v[106:109], v[158:161], v[24:27]
    ds_read_b128 v[130:133], v10 offset:1152
    v_mfma_f32_16x16x32_bf16 v[28:31], v[114:117], v[158:161], v[28:31]
    ds_read_b128 v[154:157], v11 offset:1392
    s_waitcnt lgkmcnt(6)
    v_mfma_f32_16x16x32_bf16 v[24:27], v[110:113], v[162:165], v[24:27]
    ds_read_b128 v[134:137], v10 offset:1168
    v_mfma_f32_16x16x32_bf16 v[28:31], v[118:121], v[162:165], v[28:31]
    ds_read_b128 v[158:161], v11 offset:1408
    s_waitcnt lgkmcnt(6)
    v_mfma_f32_16x16x32_bf16 v[24:27], v[114:117], v[146:149], v[24:27]
    ds_read_b128 v[138:141], v10 offset:1184
    v_mfma_f32_16x16x32_bf16 v[28:31], v[122:125], v[146:149], v[28:31]
    ds_read_b128 v[162:165], v11 offset:1440
    s_waitcnt lgkmcnt(6)
    v_mfma_f32_16x16x32_bf16 v[24:27], v[118:121], v[150:153], v[24:27]
    ds_read_b128 v[142:145], v10 offset:1200
    v_mfma_f32_16x16x32_bf16 v[28:31], v[126:129], v[150:153], v[28:31]
    ds_read_b128 v[146:149], v11 offset:1456
    s_waitcnt lgkmcnt(6)
    v_mfma_f32_16x16x32_bf16 v[24:27], v[122:125], v[154:157], v[24:27]
    ds_read_b128 v[106:109], v10 offset:1216
    v_mfma_f32_16x16x32_bf16 v[28:31], v[130:133], v[154:157], v[28:31]
    ds_read_b128 v[150:153], v11 offset:1472
    s_waitcnt lgkmcnt(6)
    v_mfma_f32_16x16x32_bf16 v[24:27], v[126:129], v[158:161], v[24:27]
    ds_read_b128 v[110:113], v10 offset:1232
    v_mfma_f32_16x16x32_bf16 v[28:31], v[134:137], v[158:161], v[28:31]
    ds_read_b128 v[154:157], v11 offset:1488
    s_waitcnt lgkmcnt(6)
    v_mfma_f32_16x16x32_bf16 v[24:27], v[130:133], v[162:165], v[24:27]
    ds_read_b128 v[114:117], v10 offset:1248
    v_mfma_f32_16x16x32_bf16 v[28:31], v[138:141], v[162:165], v[28:31]
    ds_read_b128 v[158:161], v11 offset:1520
    s_waitcnt lgkmcnt(6)
    v_mfma_f32_16x16x32_bf16 v[24:27], v[134:137], v[146:149], v[24:27]
    ds_read_b128 v[118:121], v10 offset:1264
    v_mfma_f32_16x16x32_bf16 v[28:31], v[142:145], v[146:149], v[28:31]
    ds_read_b128 v[162:165], v11 offset:1536
    s_waitcnt lgkmcnt(6)
    v_mfma_f32_16x16x32_bf16 v[24:27], v[138:141], v[150:153], v[24:27]
    ds_read_b128 v[122:125], v10 offset:1280
    v_mfma_f32_16x16x32_bf16 v[28:31], v[106:109], v[150:153], v[28:31]
    ds_read_b128 v[146:149], v11 offset:1552
    s_waitcnt lgkmcnt(6)
    v_mfma_f32_16x16x32_bf16 v[24:27], v[142:145], v[154:157], v[24:27]
    ds_read_b128 v[126:129], v10 offset:1296
    v_mfma_f32_16x16x32_bf16 v[28:31], v[110:113], v[154:157], v[28:31]
    ds_read_b128 v[150:153], v11 offset:1568
    buffer_load_dword v56, v16, s[36:39], s96 offen sc1
    s_waitcnt lgkmcnt(6)
    v_mfma_f32_16x16x32_bf16 v[24:27], v[106:109], v[158:161], v[24:27]
    ds_read_b128 v[130:133], v10 offset:2048
    v_mfma_f32_16x16x32_bf16 v[28:31], v[114:117], v[158:161], v[28:31]
    ds_read_b128 v[134:137], v10 offset:2064
    ds_read_b128 v[138:141], v10 offset:2080
    ds_read_b128 v[154:157], v11 offset:2560
    s_waitcnt lgkmcnt(8)
    v_mfma_f32_16x16x32_bf16 v[24:27], v[110:113], v[162:165], v[24:27]
    ds_read_b128 v[142:145], v10 offset:2096
    v_mfma_f32_16x16x32_bf16 v[28:31], v[118:121], v[162:165], v[28:31]
    ds_read_b128 v[158:161], v11 offset:2576
    s_waitcnt lgkmcnt(8)
    v_mfma_f32_16x16x32_bf16 v[24:27], v[114:117], v[146:149], v[24:27]
    ds_read_b128 v[106:109], v10 offset:2112
    v_mfma_f32_16x16x32_bf16 v[28:31], v[122:125], v[146:149], v[28:31]
    ds_read_b128 v[162:165], v11 offset:2592
    s_waitcnt lgkmcnt(8)
    v_mfma_f32_16x16x32_bf16 v[24:27], v[118:121], v[150:153], v[24:27]
    ds_read_b128 v[110:113], v10 offset:2128
    v_mfma_f32_16x16x32_bf16 v[28:31], v[126:129], v[150:153], v[28:31]
    ds_read_b128 v[146:149], v11 offset:2608
    s_waitcnt lgkmcnt(6)
    v_mfma_f32_16x16x32_bf16 v[24:27], v[130:133], v[154:157], v[24:27]
    ds_read_b128 v[114:117], v10 offset:2144
    v_mfma_f32_16x16x32_bf16 v[28:31], v[138:141], v[154:157], v[28:31]
    ds_read_b128 v[150:153], v11 offset:2640
    s_waitcnt lgkmcnt(6)
    v_mfma_f32_16x16x32_bf16 v[24:27], v[134:137], v[158:161], v[24:27]
    ds_read_b128 v[118:121], v10 offset:2160
    v_mfma_f32_16x16x32_bf16 v[28:31], v[142:145], v[158:161], v[28:31]
    ds_read_b128 v[154:157], v11 offset:2656
    s_waitcnt lgkmcnt(6)
    v_mfma_f32_16x16x32_bf16 v[24:27], v[138:141], v[162:165], v[24:27]
    ds_read_b128 v[122:125], v10 offset:2176
    v_mfma_f32_16x16x32_bf16 v[28:31], v[106:109], v[162:165], v[28:31]
    ds_read_b128 v[158:161], v11 offset:2672
    s_waitcnt lgkmcnt(6)
    v_mfma_f32_16x16x32_bf16 v[24:27], v[142:145], v[146:149], v[24:27]
    ds_read_b128 v[126:129], v10 offset:2192
    v_mfma_f32_16x16x32_bf16 v[28:31], v[110:113], v[146:149], v[28:31]
    ds_read_b128 v[162:165], v11 offset:2688
    s_waitcnt lgkmcnt(6)
    v_mfma_f32_16x16x32_bf16 v[24:27], v[106:109], v[150:153], v[24:27]
    ds_read_b128 v[130:133], v10 offset:2208
    v_mfma_f32_16x16x32_bf16 v[28:31], v[114:117], v[150:153], v[28:31]
    ds_read_b128 v[146:149], v11 offset:2720
    s_waitcnt lgkmcnt(6)
    v_mfma_f32_16x16x32_bf16 v[24:27], v[110:113], v[154:157], v[24:27]
    ds_read_b128 v[134:137], v10 offset:2224
    v_mfma_f32_16x16x32_bf16 v[28:31], v[118:121], v[154:157], v[28:31]
    ds_read_b128 v[150:153], v11 offset:2736
    s_waitcnt lgkmcnt(6)
    v_mfma_f32_16x16x32_bf16 v[24:27], v[114:117], v[158:161], v[24:27]
    ds_read_b128 v[138:141], v10 offset:2240
    v_mfma_f32_16x16x32_bf16 v[28:31], v[122:125], v[158:161], v[28:31]
    ds_read_b128 v[154:157], v11 offset:2752
    s_waitcnt lgkmcnt(6)
    v_mfma_f32_16x16x32_bf16 v[24:27], v[118:121], v[162:165], v[24:27]
    ds_read_b128 v[142:145], v10 offset:2256
    v_mfma_f32_16x16x32_bf16 v[28:31], v[126:129], v[162:165], v[28:31]
    ds_read_b128 v[158:161], v11 offset:2768
    s_mov_b32 s78, 0
    s_waitcnt vmcnt(0)
    s_branch L_pcs1b0_17
L_polls1b0_16:
    buffer_load_dword v56, v16, s[36:39], s96 offen sc1
    s_waitcnt vmcnt(0)
L_pcs1b0_17:
    v_xor_b32 v2, s97, v56
    v_cmp_ne_u32 vcc, 0, v2
    s_cbranch_vccz L_pds1b0_18
    s_add_u32 s78, s78, 1
    s_cmp_gt_u32 s78, 200000
    s_cbranch_scc1 L_pds1b0_18
    s_sleep 2
    s_branch L_polls1b0_16
L_pds1b0_18:
    s_barrier
    s_waitcnt lgkmcnt(6)
    v_mfma_f32_16x16x32_bf16 v[24:27], v[122:125], v[146:149], v[24:27]
    ds_read_b128 v[106:109], v10 offset:2272
    v_mfma_f32_16x16x32_bf16 v[28:31], v[130:133], v[146:149], v[28:31]
    ds_read_b128 v[162:165], v11 offset:2800
    v_and_b32 v2, 7, v1
    v_mul_u32_u24 v17, 12288, v2
    v_lshrrev_b32 v2, 3, v1
    v_cmp_lt_u32 vcc, 2, v2
    s_nop 1
    v_cndmask_b32 v3, 0, 1, vcc
    v_mul_u32_u24 v56, 3, v3
    v_sub_u32 v2, v2, v56
    v_min_u32 v2, 2, v2
    v_lshl_add_u32 v17, v2, 11, v17
    v_lshl_add_u32 v17, v3, 2, v17
    s_lshl_b32 s60, s87, 2
    s_add_u32 s60, s60, 278528
    buffer_load_dword v60, v17, s[36:39], s60 offen sc1
    s_waitcnt lgkmcnt(6)
    v_mfma_f32_16x16x32_bf16 v[24:27], v[126:129], v[150:153], v[24:27]
    ds_read_b128 v[110:113], v10 offset:2288
    v_mfma_f32_16x16x32_bf16 v[28:31], v[134:137], v[150:153], v[28:31]
    ds_read_b128 v[146:149], v11 offset:2816
    s_lshl_b32 s96, s90, 12
    s_add_u32 s96, s96, 3211264
    s_waitcnt lgkmcnt(6)
    v_mfma_f32_16x16x32_bf16 v[24:27], v[130:133], v[154:157], v[24:27]
    ds_read_b128 v[114:117], v10 offset:2304
    v_mfma_f32_16x16x32_bf16 v[28:31], v[138:141], v[154:157], v[28:31]
    ds_read_b128 v[150:153], v11 offset:2832
    s_mov_b32 m0, 100352
    s_nop 0
    buffer_load_dwordx4 v5, s[36:39], s96 offen offset:0 sc1 lds
    s_waitcnt lgkmcnt(6)
    v_mfma_f32_16x16x32_bf16 v[24:27], v[134:137], v[158:161], v[24:27]
    ds_read_b128 v[118:121], v10 offset:2320
    v_mfma_f32_16x16x32_bf16 v[28:31], v[142:145], v[158:161], v[28:31]
    ds_read_b128 v[154:157], v11 offset:2848
    s_mov_b32 m0, 100352
    s_nop 0
    buffer_load_dwordx4 v5, s[36:39], s96 offen offset:1024 sc1 lds
    s_waitcnt lgkmcnt(6)
    v_mfma_f32_16x16x32_bf16 v[24:27], v[138:141], v[162:165], v[24:27]
    ds_read_b128 v[122:125], v10 offset:3072
    v_mfma_f32_16x16x32_bf16 v[28:31], v[106:109], v[162:165], v[28:31]
    ds_read_b128 v[126:129], v10 offset:3088
    ds_read_b128 v[130:133], v10 offset:3104
    ds_read_b128 v[158:161], v11 offset:3840
    s_mov_b32 m0, 83968
    s_mov_b32 s97, 262144
    buffer_load_dwordx4 v5, s[36:39], s97 offen offset:0 sc1 lds
    s_waitcnt lgkmcnt(8)
    v_mfma_f32_16x16x32_bf16 v[24:27], v[142:145], v[146:149], v[24:27]
    ds_read_b128 v[134:137], v10 offset:3120
    v_mfma_f32_16x16x32_bf16 v[28:31], v[110:113], v[146:149], v[28:31]
    ds_read_b128 v[162:165], v11 offset:3856
    s_mov_b32 m0, 83968
    s_mov_b32 s97, 262144
    buffer_load_dwordx4 v5, s[36:39], s97 offen offset:1024 sc1 lds
    s_waitcnt lgkmcnt(8)
    v_mfma_f32_16x16x32_bf16 v[24:27], v[106:109], v[150:153], v[24:27]
    ds_read_b128 v[138:141], v10 offset:3136
    v_mfma_f32_16x16x32_bf16 v[28:31], v[114:117], v[150:153], v[28:31]
    ds_read_b128 v[146:149], v11 offset:3872
    s_mov_b32 m0, 83968
    s_mov_b32 s97, 262144
    buffer_load_dwordx4 v5, s[36:39], s97 offen offset:2048 sc1 lds
    s_waitcnt lgkmcnt(8)
    v_mfma_f32_16x16x32_bf16 v[24:27], v[110:113], v[154:157], v[24:27]
    ds_read_b128 v[142:145], v10 offset:3152
    v_mfma_f32_16x16x32_bf16 v[28:31], v[118:121], v[154:157], v[28:31]
    ds_read_b128 v[150:153], v11 offset:3888
    s_mov_b32 m0, 83968
    s_mov_b32 s97, 262144
    buffer_load_dwordx4 v5, s[36:39], s97 offen offset:3072 sc1 lds
    s_waitcnt lgkmcnt(6)
    v_mfma_f32_16x16x32_bf16 v[24:27], v[122:125], v[158:161], v[24:27]
    ds_read_b128 v[106:109], v10 offset:3168
    v_mfma_f32_16x16x32_bf16 v[28:31], v[130:133], v[158:161], v[28:31]
    ds_read_b128 v[154:157], v11 offset:3920
    s_mul_i32 s98, s59, 7
    s_lshl_b32 s99, s56, 1
    s_add_u32 s98, s98, s99
    s_lshl_b32 s98, s98, 14
    s_add_u32 s98, s98, 7536640
    s_add_u32 s99, s98, 16384
    s_cmp_eq_u32 s56, 3
    s_cselect_b32 s99, 1073741824, s99
    s_waitcnt lgkmcnt(6)
    v_mfma_f32_16x16x32_bf16 v[24:27], v[126:129], v[162:165], v[24:27]
    ds_read_b128 v[110:113], v10 offset:3184
    v_mfma_f32_16x16x32_bf16 v[28:31], v[134:137], v[162:165], v[28:31]
    ds_read_b128 v[158:161], v11 offset:3936
    s_add_u32 s73, s98, 917504
    buffer_load_dwordx4 a[0:3], v5, s[36:39], s73 offen offset:0 sc1
    s_waitcnt lgkmcnt(6)
    v_mfma_f32_16x16x32_bf16 v[24:27], v[130:133], v[146:149], v[24:27]
    ds_read_b128 v[114:117], v10 offset:3200
    v_mfma_f32_16x16x32_bf16 v[28:31], v[138:141], v[146:149], v[28:31]
    ds_read_b128 v[162:165], v11 offset:3952
    s_add_u32 s73, s99, 917504
    buffer_load_dwordx4 a[64:67], v5, s[36:39], s73 offen offset:0 sc1
    s_waitcnt lgkmcnt(6)
    v_mfma_f32_16x16x32_bf16 v[24:27], v[134:137], v[150:153], v[24:27]
    ds_read_b128 v[118:121], v10 offset:3216
    v_mfma_f32_16x16x32_bf16 v[28:31], v[142:145], v[150:153], v[28:31]
    ds_read_b128 v[146:149], v11 offset:3968
    s_add_u32 s73, s98, 917504
    buffer_load_dwordx4 a[4:7], v5, s[36:39], s73 offen offset:1024 sc1
    s_waitcnt lgkmcnt(6)
    v_mfma_f32_16x16x32_bf16 v[24:27], v[138:141], v[154:157], v[24:27]
    ds_read_b128 v[122:125], v10 offset:3232
    v_mfma_f32_16x16x32_bf16 v[28:31], v[106:109], v[154:157], v[28:31]
    ds_read_b128 v[150:153], v11 offset:4000
    s_add_u32 s73, s99, 917504
    buffer_load_dwordx4 a[68:71], v5, s[36:39], s73 offen offset:1024 sc1
    s_waitcnt lgkmcnt(6)
    v_mfma_f32_16x16x32_bf16 v[24:27], v[142:145], v[158:161], v[24:27]
    ds_read_b128 v[126:129], v10 offset:3248
    v_mfma_f32_16x16x32_bf16 v[28:31], v[110:113], v[158:161], v[28:31]
    ds_read_b128 v[154:157], v11 offset:4016
    s_add_u32 s73, s98, 917504
    buffer_load_dwordx4 a[8:11], v5, s[36:39], s73 offen offset:2048 sc1
    s_waitcnt lgkmcnt(6)
    v_mfma_f32_16x16x32_bf16 v[24:27], v[106:109], v[162:165], v[24:27]
    ds_read_b128 v[130:133], v10 offset:3264
    v_mfma_f32_16x16x32_bf16 v[28:31], v[114:117], v[162:165], v[28:31]
    ds_read_b128 v[158:161], v11 offset:4032
    s_add_u32 s73, s99, 917504
    buffer_load_dwordx4 a[72:75], v5, s[36:39], s73 offen offset:2048 sc1
    s_waitcnt lgkmcnt(6)
    v_mfma_f32_16x16x32_bf16 v[24:27], v[110:113], v[146:149], v[24:27]
    ds_read_b128 v[134:137], v10 offset:3280
    v_mfma_f32_16x16x32_bf16 v[28:31], v[118:121], v[146:149], v[28:31]
    ds_read_b128 v[162:165], v11 offset:4048
    s_add_u32 s73, s98, 917504
    buffer_load_dwordx4 a[12:15], v5, s[36:39], s73 offen offset:3072 sc1
    s_waitcnt lgkmcnt(6)
    v_mfma_f32_16x16x32_bf16 v[24:27], v[114:117], v[150:153], v[24:27]
    ds_read_b128 v[138:141], v10 offset:3296
    v_mfma_f32_16x16x32_bf16 v[28:31], v[122:125], v[150:153], v[28:31]
    ds_read_b128 v[146:149], v11 offset:4080
    s_add_u32 s73, s99, 917504
    buffer_load_dwordx4 a[76:79], v5, s[36:39], s73 offen offset:3072 sc1
    s_waitcnt lgkmcnt(6)
    v_mfma_f32_16x16x32_bf16 v[24:27], v[118:121], v[154:157], v[24:27]
    ds_read_b128 v[142:145], v10 offset:3312
    v_mfma_f32_16x16x32_bf16 v[28:31], v[126:129], v[154:157], v[28:31]
    ds_read_b128 v[150:153], v11 offset:4096
    s_add_u32 s73, s98, 921600
    buffer_load_dwordx4 a[16:19], v5, s[36:39], s73 offen offset:0 sc1
    s_waitcnt lgkmcnt(6)
    v_mfma_f32_16x16x32_bf16 v[24:27], v[122:125], v[158:161], v[24:27]
    ds_read_b128 v[106:109], v10 offset:3328
    v_mfma_f32_16x16x32_bf16 v[28:31], v[130:133], v[158:161], v[28:31]
    ds_read_b128 v[154:157], v11 offset:4112
    s_add_u32 s73, s99, 921600
    buffer_load_dwordx4 a[80:83], v5, s[36:39], s73 offen offset:0 sc1
    s_waitcnt lgkmcnt(6)
    v_mfma_f32_16x16x32_bf16 v[24:27], v[126:129], v[162:165], v[24:27]
    ds_read_b128 v[110:113], v10 offset:3344
    v_mfma_f32_16x16x32_bf16 v[28:31], v[134:137], v[162:165], v[28:31]
    ds_read_b128 v[158:161], v11 offset:4128
    s_add_u32 s73, s98, 921600
    buffer_load_dwordx4 a[20:23], v5, s[36:39], s73 offen offset:1024 sc1
    s_waitcnt lgkmcnt(6)
    v_mfma_f32_16x16x32_bf16 v[24:27], v[130:133], v[146:149], v[24:27]
    v_mfma_f32_16x16x32_bf16 v[28:31], v[138:141], v[146:149], v[28:31]
    s_add_u32 s73, s99, 921600
    buffer_load_dwordx4 a[84:87], v5, s[36:39], s73 offen offset:1024 sc1
    s_waitcnt lgkmcnt(4)
    v_mfma_f32_16x16x32_bf16 v[24:27], v[134:137], v[150:153], v[24:27]
    v_mfma_f32_16x16x32_bf16 v[28:31], v[142:145], v[150:153], v[28:31]
    s_waitcnt lgkmcnt(2)
    v_mfma_f32_16x16x32_bf16 v[24:27], v[138:141], v[154:157], v[24:27]
    v_mfma_f32_16x16x32_bf16 v[28:31], v[106:109], v[154:157], v[28:31]
    s_waitcnt lgkmcnt(0)
    v_mfma_f32_16x16x32_bf16 v[24:27], v[142:145], v[158:161], v[24:27]
    v_mfma_f32_16x16x32_bf16 v[28:31], v[110:113], v[158:161], v[28:31]
    s_waitcnt vmcnt(18)
    v_add_f32_dpp v60, v60, v60 quad_perm:[1,0,3,2] row_mask:0xf bank_mask:0xf
    s_nop 1
    v_add_f32_dpp v60, v60, v60 quad_perm:[2,3,0,1] row_mask:0xf bank_mask:0xf
    s_nop 1
    v_add_f32_dpp v60, v60, v60 row_half_mirror row_mask:0xf bank_mask:0xf
    v_cvt_pk_bf16_f32 v60, v60, v60
    v_lshlrev_b32 v60, 16, v60
    v_add_u32 v2, 133120, v9
    ds_write_b32 v2, v60
    s_waitcnt vmcnt(12) lgkmcnt(0)
    s_branch L_cepi_11
L_cw_13:
    ds_read_b128 v[106:109], v10 offset:0
    ds_read_b128 v[110:113], v10 offset:16
    ds_read_b128 v[114:117], v10 offset:32
    ds_read_b128 v[146:149], v11 offset:0
    ds_read_b128 v[166:169], v12 offset:0
    ds_read_b128 v[118:121], v10 offset:48
    ds_read_b128 v[150:153], v11 offset:16
    ds_read_b128 v[170:173], v12 offset:16
    ds_read_b128 v[122:125], v10 offset:64
    ds_read_b128 v[154:157], v11 offset:32
    ds_read_b128 v[174:177], v12 offset:32
    ds_read_b128 v[126:129], v10 offset:80
    ds_read_b128 v[158:161], v11 offset:48
    ds_read_b128 v[178:181], v12 offset:48
    s_waitcnt lgkmcnt(9)
    v_mfma_f32_16x16x32_bf16 v[24:27], v[106:109], v[146:149], 0
    ds_read_b128 v[130:133], v10 offset:96
    v_mfma_f32_16x16x32_bf16 v[28:31], v[114:117], v[146:149], 0
    ds_read_b128 v[162:165], v11 offset:80
    s_mov_b32 s44, s20
    s_mov_b32 s45, s21
    s_mov_b32 s46, 8388608
    s_mov_b32 s47, 0x20000
    v_lshlrev_b32 v104, 12, v7
    v_bfe_u32 v105, v1, 2, 2
    v_lshl_add_u32 v104, v105, 10, v104
    v_and_b32 v105, 3, v1
    v_lshl_add_u32 v104, v105, 7, v104
    s_lshl_b32 s64, s58, 18
    s_lshl_b32 s65, s59, 15
    s_add_u32 s64, s64, s65
    s_add_u32 s64, s64, 0
    buffer_load_dword v105, v104, s[44:47], s64 offen offset:0
L_pf_19:
    v_mfma_f32_16x16x32_bf16 v[32:35], v[106:109], v[166:169], 0
    ds_read_b128 v[182:185], v12 offset:80
    v_mfma_f32_16x16x32_bf16 v[36:39], v[114:117], v[166:169], 0
    v_lshlrev_b32 v15, 6, v6
    v_and_b32 v2, 1, v7
    v_lshl_add_u32 v15, v2, 5, v15
    v_lshrrev_b32 v2, 1, v7
    v_lshl_add_u32 v15, v2, 4, v15
    s_waitcnt lgkmcnt(9)
    v_mfma_f32_16x16x32_bf16 v[24:27], v[110:113], v[150:153], v[24:27]
    ds_read_b128 v[134:137], v10 offset:112
    v_mfma_f32_16x16x32_bf16 v[28:31], v[118:121], v[150:153], v[28:31]
    ds_read_b128 v[146:149], v11 offset:96
    v_mul_u32_u24 v3, 80, v6
    v_lshl_add_u32 v3, v7, 3, v3
    v_sub_u32 v3, 5064, v3
    s_mul_i32 s65, s91, 1280
    s_sub_u32 s65, s95, s65
    v_add_u32 v13, s65, v3
    s_mul_i32 s65, s92, 1280
    s_sub_u32 s65, s95, s65
    v_add_u32 v14, s65, v3
    v_mfma_f32_16x16x32_bf16 v[32:35], v[110:113], v[170:173], v[32:35]
    ds_read_b128 v[166:169], v12 offset:96
    v_mfma_f32_16x16x32_bf16 v[36:39], v[118:121], v[170:173], v[36:39]
    v_lshlrev_b32 v2, 7, v6
    v_lshl_add_u32 v2, v7, 4, v2
    s_lshl_b32 s64, s91, 11
    s_add_u32 s64, s64, 83968
    v_add_u32 v18, s64, v2
    s_lshl_b32 s64, s92, 11
    s_add_u32 s64, s64, 83968
    v_add_u32 v19, s64, v2
    s_waitcnt lgkmcnt(9)
    v_mfma_f32_16x16x32_bf16 v[24:27], v[114:117], v[154:157], v[24:27]
    ds_read_b128 v[138:141], v10 offset:128
    v_mfma_f32_16x16x32_bf16 v[28:31], v[122:125], v[154:157], v[28:31]
    ds_read_b128 v[150:153], v11 offset:112
    v_lshlrev_b32 v2, 6, v6
    v_lshl_add_u32 v2, v7, 3, v2
    s_lshl_b32 s65, s88, 12
    s_lshl_b32 s64, s91, 10
    s_add_u32 s64, s64, s65
    s_add_u32 s64, s64, 100352
    v_add_u32 v20, s64, v2
    s_lshl_b32 s64, s92, 10
    s_add_u32 s64, s64, s65
    s_add_u32 s64, s64, 100352
    v_add_u32 v21, s64, v2
    v_mfma_f32_16x16x32_bf16 v[32:35], v[114:117], v[174:177], v[32:35]
    ds_read_b128 v[170:173], v12 offset:112
    v_mfma_f32_16x16x32_bf16 v[36:39], v[122:125], v[174:177], v[36:39]
    s_lshl_b32 s60, s90, 12
    s_lshl_b32 s93, s91, 10
    s_add_u32 s93, s93, s60
    s_add_u32 s93, s93, 5373952
    s_lshl_b32 s94, s92, 10
    s_add_u32 s94, s94, s60
    s_add_u32 s94, s94, 5373952
    s_waitcnt lgkmcnt(9)
    v_mfma_f32_16x16x32_bf16 v[24:27], v[118:121], v[158:161], v[24:27]
    ds_read_b128 v[142:145], v10 offset:144
    v_mfma_f32_16x16x32_bf16 v[28:31], v[126:129], v[158:161], v[28:31]
    ds_read_b128 v[154:157], v11 offset:128
    s_mov_b32 s40, s14
    s_mov_b32 s41, s15
    s_mov_b32 s42, 1024
    s_mov_b32 s43, 0x20000
    s_lshl_b32 s60, s90, 1
    buffer_load_ushort v63, v4, s[40:43], s60 offen
    v_mfma_f32_16x16x32_bf16 v[32:35], v[118:121], v[178:181], v[32:35]
    ds_read_b128 v[174:177], v12 offset:128
    v_mfma_f32_16x16x32_bf16 v[36:39], v[126:129], v[178:181], v[36:39]
    s_waitcnt lgkmcnt(9)
    v_mfma_f32_16x16x32_bf16 v[24:27], v[122:125], v[162:165], v[24:27]
    ds_read_b128 v[106:109], v10 offset:160
    v_mfma_f32_16x16x32_bf16 v[28:31], v[130:133], v[162:165], v[28:31]
    ds_read_b128 v[158:161], v11 offset:160
    v_mfma_f32_16x16x32_bf16 v[32:35], v[122:125], v[182:185], v[32:35]
    ds_read_b128 v[178:181], v12 offset:160
    v_mfma_f32_16x16x32_bf16 v[36:39], v[130:133], v[182:185], v[36:39]
    s_waitcnt lgkmcnt(9)
    v_mfma_f32_16x16x32_bf16 v[24:27], v[126:129], v[146:149], v[24:27]
    ds_read_b128 v[110:113], v10 offset:176
    v_mfma_f32_16x16x32_bf16 v[28:31], v[134:137], v[146:149], v[28:31]
    ds_read_b128 v[162:165], v11 offset:176
    v_mfma_f32_16x16x32_bf16 v[32:35], v[126:129], v[166:169], v[32:35]
    ds_read_b128 v[182:185], v12 offset:176
    v_mfma_f32_16x16x32_bf16 v[36:39], v[134:137], v[166:169], v[36:39]
    s_waitcnt lgkmcnt(9)
    v_mfma_f32_16x16x32_bf16 v[24:27], v[130:133], v[150:153], v[24:27]
    ds_read_b128 v[114:117], v10 offset:192
    v_mfma_f32_16x16x32_bf16 v[28:31], v[138:141], v[150:153], v[28:31]
    ds_read_b128 v[146:149], v11 offset:192
    v_mfma_f32_16x16x32_bf16 v[32:35], v[130:133], v[170:173], v[32:35]
    ds_read_b128 v[166:169], v12 offset:192
    v_mfma_f32_16x16x32_bf16 v[36:39], v[138:141], v[170:173], v[36:39]
    s_waitcnt lgkmcnt(9)
    v_mfma_f32_16x16x32_bf16 v[24:27], v[134:137], v[154:157], v[24:27]
    ds_read_b128 v[118:121], v10 offset:208
    v_mfma_f32_16x16x32_bf16 v[28:31], v[142:145], v[154:157], v[28:31]
    ds_read_b128 v[150:153], v11 offset:208
    v_mfma_f32_16x16x32_bf16 v[32:35], v[134:137], v[174:177], v[32:35]
    ds_read_b128 v[170:173], v12 offset:208
    v_mfma_f32_16x16x32_bf16 v[36:39], v[142:145], v[174:177], v[36:39]
    s_waitcnt lgkmcnt(9)
    v_mfma_f32_16x16x32_bf16 v[24:27], v[138:141], v[158:161], v[24:27]
    ds_read_b128 v[122:125], v10 offset:224
    v_mfma_f32_16x16x32_bf16 v[28:31], v[106:109], v[158:161], v[28:31]
    ds_read_b128 v[154:157], v11 offset:240
    v_mfma_f32_16x16x32_bf16 v[32:35], v[138:141], v[178:181], v[32:35]
    ds_read_b128 v[174:177], v12 offset:240
    v_mfma_f32_16x16x32_bf16 v[36:39], v[106:109], v[178:181], v[36:39]
    s_waitcnt lgkmcnt(9)
    v_mfma_f32_16x16x32_bf16 v[24:27], v[142:145], v[162:165], v[24:27]
    ds_read_b128 v[126:129], v10 offset:240
    v_mfma_f32_16x16x32_bf16 v[28:31], v[110:113], v[162:165], v[28:31]
    ds_read_b128 v[158:161], v11 offset:256
    v_mfma_f32_16x16x32_bf16 v[32:35], v[142:145], v[182:185], v[32:35]
    ds_read_b128 v[178:181], v12 offset:256
    v_mfma_f32_16x16x32_bf16 v[36:39], v[110:113], v[182:185], v[36:39]
    s_waitcnt lgkmcnt(9)
    v_mfma_f32_16x16x32_bf16 v[24:27], v[106:109], v[146:149], v[24:27]
    ds_read_b128 v[130:133], v10 offset:256
    v_mfma_f32_16x16x32_bf16 v[28:31], v[114:117], v[146:149], v[28:31]
    ds_read_b128 v[162:165], v11 offset:272
    v_mfma_f32_16x16x32_bf16 v[32:35], v[106:109], v[166:169], v[32:35]
    ds_read_b128 v[182:185], v12 offset:272
    v_mfma_f32_16x16x32_bf16 v[36:39], v[114:117], v[166:169], v[36:39]
    s_waitcnt lgkmcnt(9)
    v_mfma_f32_16x16x32_bf16 v[24:27], v[110:113], v[150:153], v[24:27]
    ds_read_b128 v[134:137], v10 offset:272
    v_mfma_f32_16x16x32_bf16 v[28:31], v[118:121], v[150:153], v[28:31]
    ds_read_b128 v[146:149], v11 offset:288
    v_mfma_f32_16x16x32_bf16 v[32:35], v[110:113], v[170:173], v[32:35]
    ds_read_b128 v[166:169], v12 offset:288
    v_mfma_f32_16x16x32_bf16 v[36:39], v[118:121], v[170:173], v[36:39]
    s_waitcnt lgkmcnt(9)
    v_mfma_f32_16x16x32_bf16 v[24:27], v[114:117], v[154:157], v[24:27]
    ds_read_b128 v[138:141], v10 offset:1024
    v_mfma_f32_16x16x32_bf16 v[28:31], v[122:125], v[154:157], v[28:31]
    ds_read_b128 v[142:145], v10 offset:1040
    v_mfma_f32_16x16x32_bf16 v[32:35], v[114:117], v[174:177], v[32:35]
    ds_read_b128 v[106:109], v10 offset:1056
    v_mfma_f32_16x16x32_bf16 v[36:39], v[122:125], v[174:177], v[36:39]
    ds_read_b128 v[150:153], v11 offset:1280
    ds_read_b128 v[170:173], v12 offset:1280
    s_waitcnt lgkmcnt(11)
    v_mfma_f32_16x16x32_bf16 v[24:27], v[118:121], v[158:161], v[24:27]
    ds_read_b128 v[110:113], v10 offset:1072
    v_mfma_f32_16x16x32_bf16 v[28:31], v[126:129], v[158:161], v[28:31]
    ds_read_b128 v[154:157], v11 offset:1296
    v_mfma_f32_16x16x32_bf16 v[32:35], v[118:121], v[178:181], v[32:35]
    ds_read_b128 v[174:177], v12 offset:1296
    v_mfma_f32_16x16x32_bf16 v[36:39], v[126:129], v[178:181], v[36:39]
    s_waitcnt lgkmcnt(11)
    v_mfma_f32_16x16x32_bf16 v[24:27], v[122:125], v[162:165], v[24:27]
    ds_read_b128 v[114:117], v10 offset:1088
    v_mfma_f32_16x16x32_bf16 v[28:31], v[130:133], v[162:165], v[28:31]
    ds_read_b128 v[158:161], v11 offset:1312
    v_mfma_f32_16x16x32_bf16 v[32:35], v[122:125], v[182:185], v[32:35]
    ds_read_b128 v[178:181], v12 offset:1312
    v_mfma_f32_16x16x32_bf16 v[36:39], v[130:133], v[182:185], v[36:39]
    s_waitcnt lgkmcnt(11)
    v_mfma_f32_16x16x32_bf16 v[24:27], v[126:129], v[146:149], v[24:27]
    ds_read_b128 v[118:121], v10 offset:1104
    v_mfma_f32_16x16x32_bf16 v[28:31], v[134:137], v[146:149], v[28:31]
    ds_read_b128 v[162:165], v11 offset:1328
    v_mfma_f32_16x16x32_bf16 v[32:35], v[126:129], v[166:169], v[32:35]
    ds_read_b128 v[182:185], v12 offset:1328
    v_mfma_f32_16x16x32_bf16 v[36:39], v[134:137], v[166:169], v[36:39]
    s_waitcnt lgkmcnt(9)
    v_mfma_f32_16x16x32_bf16 v[24:27], v[138:141], v[150:153], v[24:27]
    ds_read_b128 v[122:125], v10 offset:1120
    v_mfma_f32_16x16x32_bf16 v[28:31], v[106:109], v[150:153], v[28:31]
    ds_read_b128 v[146:149], v11 offset:1360
    v_mfma_f32_16x16x32_bf16 v[32:35], v[138:141], v[170:173], v[32:35]
    ds_read_b128 v[166:169], v12 offset:1360
    v_mfma_f32_16x16x32_bf16 v[36:39], v[106:109], v[170:173], v[36:39]
    s_waitcnt lgkmcnt(9)
    v_mfma_f32_16x16x32_bf16 v[24:27], v[142:145], v[154:157], v[24:27]
    ds_read_b128 v[126:129], v10 offset:1136
    v_mfma_f32_16x16x32_bf16 v[28:31], v[110:113], v[154:157], v[28:31]
    ds_read_b128 v[150:153], v11 offset:1376
    v_mfma_f32_16x16x32_bf16 v[32:35], v[142:145], v[174:177], v[32:35]
    ds_read_b128 v[170:173], v12 offset:1376
    v_mfma_f32_16x16x32_bf16 v[36:39], v[110:113], v[174:177], v[36:39]
    s_waitcnt lgkmcnt(9)
    v_mfma_f32_16x16x32_bf16 v[24:27], v[106:109], v[158:161], v[24:27]
    ds_read_b128 v[130:133], v10 offset:1152
    v_mfma_f32_16x16x32_bf16 v[28:31], v[114:117], v[158:161], v[28:31]
    ds_read_b128 v[154:157], v11 offset:1392
    v_mfma_f32_16x16x32_bf16 v[32:35], v[106:109], v[178:181], v[32:35]
    ds_read_b128 v[174:177], v12 offset:1392
    v_mfma_f32_16x16x32_bf16 v[36:39], v[114:117], v[178:181], v[36:39]
    s_waitcnt lgkmcnt(9)
    v_mfma_f32_16x16x32_bf16 v[24:27], v[110:113], v[162:165], v[24:27]
    ds_read_b128 v[134:137], v10 offset:1168
    v_mfma_f32_16x16x32_bf16 v[28:31], v[118:121], v[162:165], v[28:31]
    ds_read_b128 v[158:161], v11 offset:1408
    v_mfma_f32_16x16x32_bf16 v[32:35], v[110:113], v[182:185], v[32:35]
    ds_read_b128 v[178:181], v12 offset:1408
    v_mfma_f32_16x16x32_bf16 v[36:39], v[118:121], v[182:185], v[36:39]
    s_waitcnt lgkmcnt(9)
    v_mfma_f32_16x16x32_bf16 v[24:27], v[114:117], v[146:149], v[24:27]
    ds_read_b128 v[138:141], v10 offset:1184
    v_mfma_f32_16x16x32_bf16 v[28:31], v[122:125], v[146:149], v[28:31]
    ds_read_b128 v[162:165], v11 offset:1440
    v_mfma_f32_16x16x32_bf16 v[32:35], v[114:117], v[166:169], v[32:35]
    ds_read_b128 v[182:185], v12 offset:1440
    v_mfma_f32_16x16x32_bf16 v[36:39], v[122:125], v[166:169], v[36:39]
    s_waitcnt lgkmcnt(9)
    v_mfma_f32_16x16x32_bf16 v[24:27], v[118:121], v[150:153], v[24:27]
    ds_read_b128 v[142:145], v10 offset:1200
    v_mfma_f32_16x16x32_bf16 v[28:31], v[126:129], v[150:153], v[28:31]
    ds_read_b128 v[146:149], v11 offset:1456
    v_mfma_f32_16x16x32_bf16 v[32:35], v[118:121], v[170:173], v[32:35]
    ds_read_b128 v[166:169], v12 offset:1456
    v_mfma_f32_16x16x32_bf16 v[36:39], v[126:129], v[170:173], v[36:39]
    s_waitcnt lgkmcnt(9)
    v_mfma_f32_16x16x32_bf16 v[24:27], v[122:125], v[154:157], v[24:27]
    ds_read_b128 v[106:109], v10 offset:1216
    v_mfma_f32_16x16x32_bf16 v[28:31], v[130:133], v[154:157], v[28:31]
    ds_read_b128 v[150:153], v11 offset:1472
    v_mfma_f32_16x16x32_bf16 v[32:35], v[122:125], v[174:177], v[32:35]
    ds_read_b128 v[170:173], v12 offset:1472
    v_mfma_f32_16x16x32_bf16 v[36:39], v[130:133], v[174:177], v[36:39]
    s_waitcnt lgkmcnt(9)
    v_mfma_f32_16x16x32_bf16 v[24:27], v[126:129], v[158:161], v[24:27]
    ds_read_b128 v[110:113], v10 offset:1232
    v_mfma_f32_16x16x32_bf16 v[28:31], v[134:137], v[158:161], v[28:31]
    ds_read_b128 v[154:157], v11 offset:1488
    v_mfma_f32_16x16x32_bf16 v[32:35], v[126:129], v[178:181], v[32:35]
    ds_read_b128 v[174:177], v12 offset:1488
    v_mfma_f32_16x16x32_bf16 v[36:39], v[134:137], v[178:181], v[36:39]
    s_waitcnt lgkmcnt(9)
    v_mfma_f32_16x16x32_bf16 v[24:27], v[130:133], v[162:165], v[24:27]
    ds_read_b128 v[114:117], v10 offset:1248
    v_mfma_f32_16x16x32_bf16 v[28:31], v[138:141], v[162:165], v[28:31]
    ds_read_b128 v[158:161], v11 offset:1520
    v_mfma_f32_16x16x32_bf16 v[32:35], v[130:133], v[182:185], v[32:35]
    ds_read_b128 v[178:181], v12 offset:1520
    v_mfma_f32_16x16x32_bf16 v[36:39], v[138:141], v[182:185], v[36:39]
    s_waitcnt lgkmcnt(9)
    v_mfma_f32_16x16x32_bf16 v[24:27], v[134:137], v[146:149], v[24:27]
    ds_read_b128 v[118:121], v10 offset:1264
    v_mfma_f32_16x16x32_bf16 v[28:31], v[142:145], v[146:149], v[28:31]
    ds_read_b128 v[162:165], v11 offset:1536
    v_mfma_f32_16x16x32_bf16 v[32:35], v[134:137], v[166:169], v[32:35]
    ds_read_b128 v[182:185], v12 offset:1536
    v_mfma_f32_16x16x32_bf16 v[36:39], v[142:145], v[166:169], v[36:39]
    s_waitcnt lgkmcnt(9)
    v_mfma_f32_16x16x32_bf16 v[24:27], v[138:141], v[150:153], v[24:27]
    ds_read_b128 v[122:125], v10 offset:1280
    v_mfma_f32_16x16x32_bf16 v[28:31], v[106:109], v[150:153], v[28:31]
    ds_read_b128 v[146:149], v11 offset:1552
    v_mfma_f32_16x16x32_bf16 v[32:35], v[138:141], v[170:173], v[32:35]
    ds_read_b128 v[166:169], v12 offset:1552
    v_mfma_f32_16x16x32_bf16 v[36:39], v[106:109], v[170:173], v[36:39]
    s_waitcnt lgkmcnt(9)
    v_mfma_f32_16x16x32_bf16 v[24:27], v[142:145], v[154:157], v[24:27]
    ds_read_b128 v[126:129], v10 offset:1296
    v_mfma_f32_16x16x32_bf16 v[28:31], v[110:113], v[154:157], v[28:31]
    ds_read_b128 v[150:153], v11 offset:1568
    v_mfma_f32_16x16x32_bf16 v[32:35], v[142:145], v[174:177], v[32:35]
    ds_read_b128 v[170:173], v12 offset:1568
    v_mfma_f32_16x16x32_bf16 v[36:39], v[110:113], v[174:177], v[36:39]
    s_barrier
    s_waitcnt lgkmcnt(9)
    v_mfma_f32_16x16x32_bf16 v[24:27], v[106:109], v[158:161], v[24:27]
    ds_read_b128 v[130:133], v10 offset:2048
    v_mfma_f32_16x16x32_bf16 v[28:31], v[114:117], v[158:161], v[28:31]
    ds_read_b128 v[134:137], v10 offset:2064
    s_lshl_b32 s96, s90, 12
    s_add_u32 s96, s96, 3213312
    v_mfma_f32_16x16x32_bf16 v[32:35], v[106:109], v[178:181], v[32:35]
    ds_read_b128 v[138:141], v10 offset:2080
    v_mfma_f32_16x16x32_bf16 v[36:39], v[114:117], v[178:181], v[36:39]
    ds_read_b128 v[154:157], v11 offset:2560
    s_mov_b32 m0, 102400
    s_nop 0
    buffer_load_dwordx4 v5, s[36:39], s96 offen offset:0 sc1 lds
    s_waitcnt lgkmcnt(10)
    v_mfma_f32_16x16x32_bf16 v[24:27], v[110:113], v[162:165], v[24:27]
    ds_read_b128 v[142:145], v10 offset:2096
    v_mfma_f32_16x16x32_bf16 v[28:31], v[118:121], v[162:165], v[28:31]
    ds_read_b128 v[158:161], v11 offset:2576
    s_mov_b32 m0, 102400
    s_nop 0
    buffer_load_dwordx4 v5, s[36:39], s96 offen offset:1024 sc1 lds
    v_mfma_f32_16x16x32_bf16 v[32:35], v[110:113], v[182:185], v[32:35]
    v_mfma_f32_16x16x32_bf16 v[36:39], v[118:121], v[182:185], v[36:39]
    s_mov_b32 m0, 88064
    s_mov_b32 s97, 266240
    buffer_load_dwordx4 v5, s[36:39], s97 offen offset:0 sc1 lds
    s_waitcnt lgkmcnt(9)
    v_mfma_f32_16x16x32_bf16 v[24:27], v[114:117], v[146:149], v[24:27]
    ds_read_b128 v[106:109], v10 offset:2112
    v_mfma_f32_16x16x32_bf16 v[28:31], v[122:125], v[146:149], v[28:31]
    ds_read_b128 v[162:165], v11 offset:2592
    s_mov_b32 m0, 88064
    s_mov_b32 s97, 266240
    buffer_load_dwordx4 v5, s[36:39], s97 offen offset:1024 sc1 lds
    v_mfma_f32_16x16x32_bf16 v[32:35], v[114:117], v[166:169], v[32:35]
    v_mfma_f32_16x16x32_bf16 v[36:39], v[122:125], v[166:169], v[36:39]
    s_mov_b32 m0, 88064
    s_mov_b32 s97, 266240
    buffer_load_dwordx4 v5, s[36:39], s97 offen offset:2048 sc1 lds
    s_waitcnt lgkmcnt(8)
    v_mfma_f32_16x16x32_bf16 v[24:27], v[118:121], v[150:153], v[24:27]
    ds_read_b128 v[110:113], v10 offset:2128
    v_mfma_f32_16x16x32_bf16 v[28:31], v[126:129], v[150:153], v[28:31]
    ds_read_b128 v[146:149], v11 offset:2608
    s_mov_b32 m0, 88064
    s_mov_b32 s97, 266240
    buffer_load_dwordx4 v5, s[36:39], s97 offen offset:3072 sc1 lds
    v_mfma_f32_16x16x32_bf16 v[32:35], v[118:121], v[170:173], v[32:35]
    v_mfma_f32_16x16x32_bf16 v[36:39], v[126:129], v[170:173], v[36:39]
    s_mul_i32 s98, s59, 7
    s_lshl_b32 s99, s56, 1
    s_add_u32 s98, s98, s99
    s_lshl_b32 s98, s98, 14
    s_add_u32 s98, s98, 7536640
    s_add_u32 s99, s98, 16384
    s_cmp_eq_u32 s56, 3
    s_cselect_b32 s99, 1073741824, s99
    s_waitcnt lgkmcnt(6)
    v_mfma_f32_16x16x32_bf16 v[24:27], v[130:133], v[154:157], v[24:27]
    ds_read_b128 v[114:117], v10 offset:2144
    v_mfma_f32_16x16x32_bf16 v[28:31], v[138:141], v[154:157], v[28:31]
    ds_read_b128 v[150:153], v11 offset:2640
    s_add_u32 s73, s98, 917504
    buffer_load_dwordx4 a[0:3], v5, s[36:39], s73 offen offset:0 sc1
    s_waitcnt lgkmcnt(6)
    v_mfma_f32_16x16x32_bf16 v[24:27], v[134:137], v[158:161], v[24:27]
    ds_read_b128 v[118:121], v10 offset:2160
    v_mfma_f32_16x16x32_bf16 v[28:31], v[142:145], v[158:161], v[28:31]
    ds_read_b128 v[154:157], v11 offset:2656
    s_add_u32 s73, s99, 917504
    buffer_load_dwordx4 a[64:67], v5, s[36:39], s73 offen offset:0 sc1
    s_waitcnt lgkmcnt(6)
    v_mfma_f32_16x16x32_bf16 v[24:27], v[138:141], v[162:165], v[24:27]
    ds_read_b128 v[122:125], v10 offset:2176
    v_mfma_f32_16x16x32_bf16 v[28:31], v[106:109], v[162:165], v[28:31]
    ds_read_b128 v[158:161], v11 offset:2672
    s_add_u32 s73, s98, 917504
    buffer_load_dwordx4 a[4:7], v5, s[36:39], s73 offen offset:1024 sc1
    s_waitcnt lgkmcnt(6)
    v_mfma_f32_16x16x32_bf16 v[24:27], v[142:145], v[146:149], v[24:27]
    ds_read_b128 v[126:129], v10 offset:2192
    v_mfma_f32_16x16x32_bf16 v[28:31], v[110:113], v[146:149], v[28:31]
    ds_read_b128 v[162:165], v11 offset:2688
    s_add_u32 s73, s99, 917504
    buffer_load_dwordx4 a[68:71], v5, s[36:39], s73 offen offset:1024 sc1
    s_waitcnt lgkmcnt(6)
    v_mfma_f32_16x16x32_bf16 v[24:27], v[106:109], v[150:153], v[24:27]
    ds_read_b128 v[130:133], v10 offset:2208
    v_mfma_f32_16x16x32_bf16 v[28:31], v[114:117], v[150:153], v[28:31]
    ds_read_b128 v[146:149], v11 offset:2720
    s_add_u32 s73, s98, 917504
    buffer_load_dwordx4 a[8:11], v5, s[36:39], s73 offen offset:2048 sc1
    s_waitcnt lgkmcnt(6)
    v_mfma_f32_16x16x32_bf16 v[24:27], v[110:113], v[154:157], v[24:27]
    ds_read_b128 v[134:137], v10 offset:2224
    v_mfma_f32_16x16x32_bf16 v[28:31], v[118:121], v[154:157], v[28:31]
    ds_read_b128 v[150:153], v11 offset:2736
    s_add_u32 s73, s99, 917504
    buffer_load_dwordx4 a[72:75], v5, s[36:39], s73 offen offset:2048 sc1
    s_waitcnt lgkmcnt(6)
    v_mfma_f32_16x16x32_bf16 v[24:27], v[114:117], v[158:161], v[24:27]
    ds_read_b128 v[138:141], v10 offset:2240
    v_mfma_f32_16x16x32_bf16 v[28:31], v[122:125], v[158:161], v[28:31]
    ds_read_b128 v[154:157], v11 offset:2752
    s_add_u32 s73, s98, 917504
    buffer_load_dwordx4 a[12:15], v5, s[36:39], s73 offen offset:3072 sc1
    s_waitcnt lgkmcnt(6)
    v_mfma_f32_16x16x32_bf16 v[24:27], v[118:121], v[162:165], v[24:27]
    ds_read_b128 v[142:145], v10 offset:2256
    v_mfma_f32_16x16x32_bf16 v[28:31], v[126:129], v[162:165], v[28:31]
    ds_read_b128 v[158:161], v11 offset:2768
    s_add_u32 s73, s99, 917504
    buffer_load_dwordx4 a[76:79], v5, s[36:39], s73 offen offset:3072 sc1
    s_waitcnt lgkmcnt(6)
    v_mfma_f32_16x16x32_bf16 v[24:27], v[122:125], v[146:149], v[24:27]
    ds_read_b128 v[106:109], v10 offset:2272
    v_mfma_f32_16x16x32_bf16 v[28:31], v[130:133], v[146:149], v[28:31]
    ds_read_b128 v[162:165], v11 offset:2800
    s_add_u32 s73, s98, 921600
    buffer_load_dwordx4 a[16:19], v5, s[36:39], s73 offen offset:0 sc1
    s_waitcnt lgkmcnt(6)
    v_mfma_f32_16x16x32_bf16 v[24:27], v[126:129], v[150:153], v[24:27]
    ds_read_b128 v[110:113], v10 offset:2288
    v_mfma_f32_16x16x32_bf16 v[28:31], v[134:137], v[150:153], v[28:31]
    ds_read_b128 v[146:149], v11 offset:2816
    s_add_u32 s73, s99, 921600
    buffer_load_dwordx4 a[80:83], v5, s[36:39], s73 offen offset:0 sc1
    s_waitcnt lgkmcnt(6)
    v_mfma_f32_16x16x32_bf16 v[24:27], v[130:133], v[154:157], v[24:27]
    ds_read_b128 v[114:117], v10 offset:2304
    v_mfma_f32_16x16x32_bf16 v[28:31], v[138:141], v[154:157], v[28:31]
    ds_read_b128 v[150:153], v11 offset:2832
    s_add_u32 s73, s98, 921600
    buffer_load_dwordx4 a[20:23], v5, s[36:39], s73 offen offset:1024 sc1
    s_waitcnt lgkmcnt(6)
    v_mfma_f32_16x16x32_bf16 v[24:27], v[134:137], v[158:161], v[24:27]
    ds_read_b128 v[118:121], v10 offset:2320
    v_mfma_f32_16x16x32_bf16 v[28:31], v[142:145], v[158:161], v[28:31]
    ds_read_b128 v[154:157], v11 offset:2848
    s_add_u32 s73, s99, 921600
    buffer_load_dwordx4 a[84:87], v5, s[36:39], s73 offen offset:1024 sc1
    s_waitcnt lgkmcnt(6)
    v_mfma_f32_16x16x32_bf16 v[24:27], v[138:141], v[162:165], v[24:27]
    v_mfma_f32_16x16x32_bf16 v[28:31], v[106:109], v[162:165], v[28:31]
    s_waitcnt lgkmcnt(4)
    v_mfma_f32_16x16x32_bf16 v[24:27], v[142:145], v[146:149], v[24:27]
    v_mfma_f32_16x16x32_bf16 v[28:31], v[110:113], v[146:149], v[28:31]
    s_waitcnt lgkmcnt(2)
    v_mfma_f32_16x16x32_bf16 v[24:27], v[106:109], v[150:153], v[24:27]
    v_mfma_f32_16x16x32_bf16 v[28:31], v[114:117], v[150:153], v[28:31]
    s_waitcnt lgkmcnt(0)
    v_mfma_f32_16x16x32_bf16 v[24:27], v[110:113], v[154:157], v[24:27]
    v_mfma_f32_16x16x32_bf16 v[28:31], v[118:121], v[154:157], v[28:31]
    s_waitcnt vmcnt(12) lgkmcnt(0)
    s_branch L_cepi_11
L_cw_14:
    ds_read_b128 v[106:109], v10 offset:0
    ds_read_b128 v[110:113], v10 offset:16
    ds_read_b128 v[114:117], v10 offset:32
    ds_read_b128 v[146:149], v11 offset:0
    ds_read_b128 v[166:169], v12 offset:0
    ds_read_b128 v[118:121], v10 offset:48
    ds_read_b128 v[150:153], v11 offset:16
    ds_read_b128 v[170:173], v12 offset:16
    ds_read_b128 v[122:125], v10 offset:64
    ds_read_b128 v[154:157], v11 offset:32
    ds_read_b128 v[174:177], v12 offset:32
    ds_read_b128 v[126:129], v10 offset:80
    ds_read_b128 v[158:161], v11 offset:48
    ds_read_b128 v[178:181], v12 offset:48
    s_waitcnt lgkmcnt(9)
    v_mfma_f32_16x16x32_bf16 v[24:27], v[106:109], v[146:149], 0
    ds_read_b128 v[130:133], v10 offset:96
    v_mfma_f32_16x16x32_bf16 v[28:31], v[114:117], v[146:149], 0
    ds_read_b128 v[162:165], v11 offset:80
    s_mov_b32 s44, s20
    s_mov_b32 s45, s21
    s_mov_b32 s46, 8388608
    s_mov_b32 s47, 0x20000
    v_lshlrev_b32 v104, 12, v7
    v_bfe_u32 v105, v1, 2, 2
    v_lshl_add_u32 v104, v105, 10, v104
    v_and_b32 v105, 3, v1
    v_lshl_add_u32 v104, v105, 7, v104
    s_lshl_b32 s64, s58, 18
    s_lshl_b32 s65, s59, 15
    s_add_u32 s64, s64, s65
    s_add_u32 s64, s64, 16384
    buffer_load_dword v105, v104, s[44:47], s64 offen offset:0
L_pf_20:
    v_mfma_f32_16x16x32_bf16 v[32:35], v[106:109], v[166:169], 0
    ds_read_b128 v[182:185], v12 offset:80
    v_mfma_f32_16x16x32_bf16 v[36:39], v[114:117], v[166:169], 0
    v_lshlrev_b32 v15, 6, v6
    v_and_b32 v2, 1, v7
    v_lshl_add_u32 v15, v2, 5, v15
    v_lshrrev_b32 v2, 1, v7
    v_lshl_add_u32 v15, v2, 4, v15
    s_waitcnt lgkmcnt(9)
    v_mfma_f32_16x16x32_bf16 v[24:27], v[110:113], v[150:153], v[24:27]
    ds_read_b128 v[134:137], v10 offset:112
    v_mfma_f32_16x16x32_bf16 v[28:31], v[118:121], v[150:153], v[28:31]
    ds_read_b128 v[146:149], v11 offset:96
    v_mul_u32_u24 v3, 80, v6
    v_lshl_add_u32 v3, v7, 3, v3
    v_sub_u32 v3, 5064, v3
    s_mul_i32 s65, s91, 1280
    s_sub_u32 s65, s95, s65
    v_add_u32 v13, s65, v3
    s_mul_i32 s65, s92, 1280
    s_sub_u32 s65, s95, s65
    v_add_u32 v14, s65, v3
    v_mfma_f32_16x16x32_bf16 v[32:35], v[110:113], v[170:173], v[32:35]
    ds_read_b128 v[166:169], v12 offset:96
    v_mfma_f32_16x16x32_bf16 v[36:39], v[118:121], v[170:173], v[36:39]
    v_lshlrev_b32 v2, 7, v6
    v_lshl_add_u32 v2, v7, 4, v2
    s_lshl_b32 s64, s91, 11
    s_add_u32 s64, s64, 83968
    v_add_u32 v18, s64, v2
    s_lshl_b32 s64, s92, 11
    s_add_u32 s64, s64, 83968
    v_add_u32 v19, s64, v2
    s_waitcnt lgkmcnt(9)
    v_mfma_f32_16x16x32_bf16 v[24:27], v[114:117], v[154:157], v[24:27]
    ds_read_b128 v[138:141], v10 offset:128
    v_mfma_f32_16x16x32_bf16 v[28:31], v[122:125], v[154:157], v[28:31]
    ds_read_b128 v[150:153], v11 offset:112
    v_lshlrev_b32 v2, 6, v6
    v_lshl_add_u32 v2, v7, 3, v2
    s_lshl_b32 s65, s88, 12
    s_lshl_b32 s64, s91, 10
    s_add_u32 s64, s64, s65
    s_add_u32 s64, s64, 100352
    v_add_u32 v20, s64, v2
    s_lshl_b32 s64, s92, 10
    s_add_u32 s64, s64, s65
    s_add_u32 s64, s64, 100352
    v_add_u32 v21, s64, v2
    v_mfma_f32_16x16x32_bf16 v[32:35], v[114:117], v[174:177], v[32:35]
    ds_read_b128 v[170:173], v12 offset:112
    v_mfma_f32_16x16x32_bf16 v[36:39], v[122:125], v[174:177], v[36:39]
    s_lshl_b32 s60, s90, 12
    s_lshl_b32 s93, s91, 10
    s_add_u32 s93, s93, s60
    s_add_u32 s93, s93, 5373952
    s_lshl_b32 s94, s92, 10
    s_add_u32 s94, s94, s60
    s_add_u32 s94, s94, 5373952
    s_waitcnt lgkmcnt(9)
    v_mfma_f32_16x16x32_bf16 v[24:27], v[118:121], v[158:161], v[24:27]
    ds_read_b128 v[142:145], v10 offset:144
    v_mfma_f32_16x16x32_bf16 v[28:31], v[126:129], v[158:161], v[28:31]
    ds_read_b128 v[154:157], v11 offset:128
    s_mov_b32 s40, s14
    s_mov_b32 s41, s15
    s_mov_b32 s42, 1024
    s_mov_b32 s43, 0x20000
    s_lshl_b32 s60, s90, 1
    buffer_load_ushort v63, v4, s[40:43], s60 offen
    v_mfma_f32_16x16x32_bf16 v[32:35], v[118:121], v[178:181], v[32:35]
    ds_read_b128 v[174:177], v12 offset:128
    v_mfma_f32_16x16x32_bf16 v[36:39], v[126:129], v[178:181], v[36:39]
    s_waitcnt lgkmcnt(9)
    v_mfma_f32_16x16x32_bf16 v[24:27], v[122:125], v[162:165], v[24:27]
    ds_read_b128 v[106:109], v10 offset:160
    v_mfma_f32_16x16x32_bf16 v[28:31], v[130:133], v[162:165], v[28:31]
    ds_read_b128 v[158:161], v11 offset:160
    v_mfma_f32_16x16x32_bf16 v[32:35], v[122:125], v[182:185], v[32:35]
    ds_read_b128 v[178:181], v12 offset:160
    v_mfma_f32_16x16x32_bf16 v[36:39], v[130:133], v[182:185], v[36:39]
    s_waitcnt lgkmcnt(9)
    v_mfma_f32_16x16x32_bf16 v[24:27], v[126:129], v[146:149], v[24:27]
    ds_read_b128 v[110:113], v10 offset:176
    v_mfma_f32_16x16x32_bf16 v[28:31], v[134:137], v[146:149], v[28:31]
    ds_read_b128 v[162:165], v11 offset:176
    v_mfma_f32_16x16x32_bf16 v[32:35], v[126:129], v[166:169], v[32:35]
    ds_read_b128 v[182:185], v12 offset:176
    v_mfma_f32_16x16x32_bf16 v[36:39], v[134:137], v[166:169], v[36:39]
    s_waitcnt lgkmcnt(9)
    v_mfma_f32_16x16x32_bf16 v[24:27], v[130:133], v[150:153], v[24:27]
    ds_read_b128 v[114:117], v10 offset:192
    v_mfma_f32_16x16x32_bf16 v[28:31], v[138:141], v[150:153], v[28:31]
    ds_read_b128 v[146:149], v11 offset:192
    v_mfma_f32_16x16x32_bf16 v[32:35], v[130:133], v[170:173], v[32:35]
    ds_read_b128 v[166:169], v12 offset:192
    v_mfma_f32_16x16x32_bf16 v[36:39], v[138:141], v[170:173], v[36:39]
    s_waitcnt lgkmcnt(9)
    v_mfma_f32_16x16x32_bf16 v[24:27], v[134:137], v[154:157], v[24:27]
    ds_read_b128 v[118:121], v10 offset:208
    v_mfma_f32_16x16x32_bf16 v[28:31], v[142:145], v[154:157], v[28:31]
    ds_read_b128 v[150:153], v11 offset:208
    v_mfma_f32_16x16x32_bf16 v[32:35], v[134:137], v[174:177], v[32:35]
    ds_read_b128 v[170:173], v12 offset:208
    v_mfma_f32_16x16x32_bf16 v[36:39], v[142:145], v[174:177], v[36:39]
    s_waitcnt lgkmcnt(9)
    v_mfma_f32_16x16x32_bf16 v[24:27], v[138:141], v[158:161], v[24:27]
    ds_read_b128 v[122:125], v10 offset:224
    v_mfma_f32_16x16x32_bf16 v[28:31], v[106:109], v[158:161], v[28:31]
    ds_read_b128 v[154:157], v11 offset:240
    v_mfma_f32_16x16x32_bf16 v[32:35], v[138:141], v[178:181], v[32:35]
    ds_read_b128 v[174:177], v12 offset:240
    v_mfma_f32_16x16x32_bf16 v[36:39], v[106:109], v[178:181], v[36:39]
    s_waitcnt lgkmcnt(9)
    v_mfma_f32_16x16x32_bf16 v[24:27], v[142:145], v[162:165], v[24:27]
    ds_read_b128 v[126:129], v10 offset:240
    v_mfma_f32_16x16x32_bf16 v[28:31], v[110:113], v[162:165], v[28:31]
    ds_read_b128 v[158:161], v11 offset:256
    v_mfma_f32_16x16x32_bf16 v[32:35], v[142:145], v[182:185], v[32:35]
    ds_read_b128 v[178:181], v12 offset:256
    v_mfma_f32_16x16x32_bf16 v[36:39], v[110:113], v[182:185], v[36:39]
    s_waitcnt lgkmcnt(9)
    v_mfma_f32_16x16x32_bf16 v[24:27], v[106:109], v[146:149], v[24:27]
    ds_read_b128 v[130:133], v10 offset:256
    v_mfma_f32_16x16x32_bf16 v[28:31], v[114:117], v[146:149], v[28:31]
    ds_read_b128 v[162:165], v11 offset:272
    v_mfma_f32_16x16x32_bf16 v[32:35], v[106:109], v[166:169], v[32:35]
    ds_read_b128 v[182:185], v12 offset:272
    v_mfma_f32_16x16x32_bf16 v[36:39], v[114:117], v[166:169], v[36:39]
    s_waitcnt lgkmcnt(9)
    v_mfma_f32_16x16x32_bf16 v[24:27], v[110:113], v[150:153], v[24:27]
    ds_read_b128 v[134:137], v10 offset:272
    v_mfma_f32_16x16x32_bf16 v[28:31], v[118:121], v[150:153], v[28:31]
    ds_read_b128 v[146:149], v11 offset:288
    v_mfma_f32_16x16x32_bf16 v[32:35], v[110:113], v[170:173], v[32:35]
    ds_read_b128 v[166:169], v12 offset:288
    v_mfma_f32_16x16x32_bf16 v[36:39], v[118:121], v[170:173], v[36:39]
    s_waitcnt lgkmcnt(9)
    v_mfma_f32_16x16x32_bf16 v[24:27], v[114:117], v[154:157], v[24:27]
    ds_read_b128 v[138:141], v10 offset:1024
    v_mfma_f32_16x16x32_bf16 v[28:31], v[122:125], v[154:157], v[28:31]
    ds_read_b128 v[142:145], v10 offset:1040
    v_mfma_f32_16x16x32_bf16 v[32:35], v[114:117], v[174:177], v[32:35]
    ds_read_b128 v[106:109], v10 offset:1056
    v_mfma_f32_16x16x32_bf16 v[36:39], v[122:125], v[174:177], v[36:39]
    ds_read_b128 v[150:153], v11 offset:1280
    s_waitcnt lgkmcnt(10)
    v_mfma_f32_16x16x32_bf16 v[24:27], v[118:121], v[158:161], v[24:27]
    ds_read_b128 v[110:113], v10 offset:1072
    v_mfma_f32_16x16x32_bf16 v[28:31], v[126:129], v[158:161], v[28:31]
    ds_read_b128 v[154:157], v11 offset:1296
    v_mfma_f32_16x16x32_bf16 v[32:35], v[118:121], v[178:181], v[32:35]
    v_mfma_f32_16x16x32_bf16 v[36:39], v[126:129], v[178:181], v[36:39]
    s_waitcnt lgkmcnt(9)
    v_mfma_f32_16x16x32_bf16 v[24:27], v[122:125], v[162:165], v[24:27]
    ds_read_b128 v[114:117], v10 offset:1088
    v_mfma_f32_16x16x32_bf16 v[28:31], v[130:133], v[162:165], v[28:31]
    ds_read_b128 v[158:161], v11 offset:1312
    v_mfma_f32_16x16x32_bf16 v[32:35], v[122:125], v[182:185], v[32:35]
    v_mfma_f32_16x16x32_bf16 v[36:39], v[130:133], v[182:185], v[36:39]
    s_waitcnt lgkmcnt(8)
    v_mfma_f32_16x16x32_bf16 v[24:27], v[126:129], v[146:149], v[24:27]
    ds_read_b128 v[118:121], v10 offset:1104
    v_mfma_f32_16x16x32_bf16 v[28:31], v[134:137], v[146:149], v[28:31]
    ds_read_b128 v[162:165], v11 offset:1328
    v_mfma_f32_16x16x32_bf16 v[32:35], v[126:129], v[166:169], v[32:35]
    v_mfma_f32_16x16x32_bf16 v[36:39], v[134:137], v[166:169], v[36:39]
    s_waitcnt lgkmcnt(6)
    v_mfma_f32_16x16x32_bf16 v[24:27], v[138:141], v[150:153], v[24:27]
    ds_read_b128 v[122:125], v10 offset:1120
    v_mfma_f32_16x16x32_bf16 v[28:31], v[106:109], v[150:153], v[28:31]
    ds_read_b128 v[146:149], v11 offset:1360
    s_waitcnt lgkmcnt(6)
    v_mfma_f32_16x16x32_bf16 v[24:27], v[142:145], v[154:157], v[24:27]
    ds_read_b128 v[126:129], v10 offset:1136
    v_mfma_f32_16x16x32_bf16 v[28:31], v[110:113], v[154:157], v[28:31]
    ds_read_b128 v[150:153], v11 offset:1376
    s_waitcnt lgkmcnt(6)
    v_mfma_f32_16x16x32_bf16 v[24:27], v[106:109], v[158:161], v[24:27]
    ds_read_b128 v[130:133], v10 offset:1152
    v_mfma_f32_16x16x32_bf16 v[28:31], v[114:117], v[158:161], v[28:31]
    ds_read_b128 v[154:157], v11 offset:1392
    s_waitcnt lgkmcnt(6)
    v_mfma_f32_16x16x32_bf16 v[24:27], v[110:113], v[162:165], v[24:27]
    ds_read_b128 v[134:137], v10 offset:1168
    v_mfma_f32_16x16x32_bf16 v[28:31], v[118:121], v[162:165], v[28:31]
    ds_read_b128 v[158:161], v11 offset:1408
    s_waitcnt lgkmcnt(6)
    v_mfma_f32_16x16x32_bf16 v[24:27], v[114:117], v[146:149], v[24:27]
    ds_read_b128 v[138:141], v10 offset:1184
    v_mfma_f32_16x16x32_bf16 v[28:31], v[122:125], v[146:149], v[28:31]
    ds_read_b128 v[162:165], v11 offset:1440
    s_waitcnt lgkmcnt(6)
    v_mfma_f32_16x16x32_bf16 v[24:27], v[118:121], v[150:153], v[24:27]
    ds_read_b128 v[142:145], v10 offset:1200
    v_mfma_f32_16x16x32_bf16 v[28:31], v[126:129], v[150:153], v[28:31]
    ds_read_b128 v[146:149], v11 offset:1456
    s_waitcnt lgkmcnt(6)
    v_mfma_f32_16x16x32_bf16 v[24:27], v[122:125], v[154:157], v[24:27]
    ds_read_b128 v[106:109], v10 offset:1216
    v_mfma_f32_16x16x32_bf16 v[28:31], v[130:133], v[154:157], v[28:31]
    ds_read_b128 v[150:153], v11 offset:1472
    s_waitcnt lgkmcnt(6)
    v_mfma_f32_16x16x32_bf16 v[24:27], v[126:129], v[158:161], v[24:27]
    ds_read_b128 v[110:113], v10 offset:1232
    v_mfma_f32_16x16x32_bf16 v[28:31], v[134:137], v[158:161], v[28:31]
    ds_read_b128 v[154:157], v11 offset:1488
    s_waitcnt lgkmcnt(6)
    v_mfma_f32_16x16x32_bf16 v[24:27], v[130:133], v[162:165], v[24:27]
    ds_read_b128 v[114:117], v10 offset:1248
    v_mfma_f32_16x16x32_bf16 v[28:31], v[138:141], v[162:165], v[28:31]
    ds_read_b128 v[158:161], v11 offset:1520
    s_waitcnt lgkmcnt(6)
    v_mfma_f32_16x16x32_bf16 v[24:27], v[134:137], v[146:149], v[24:27]
    ds_read_b128 v[118:121], v10 offset:1264
    v_mfma_f32_16x16x32_bf16 v[28:31], v[142:145], v[146:149], v[28:31]
    ds_read_b128 v[162:165], v11 offset:1536
    s_waitcnt lgkmcnt(6)
    v_mfma_f32_16x16x32_bf16 v[24:27], v[138:141], v[150:153], v[24:27]
    ds_read_b128 v[122:125], v10 offset:1280
    v_mfma_f32_16x16x32_bf16 v[28:31], v[106:109], v[150:153], v[28:31]
    ds_read_b128 v[146:149], v11 offset:1552
    s_waitcnt lgkmcnt(6)
    v_mfma_f32_16x16x32_bf16 v[24:27], v[142:145], v[154:157], v[24:27]
    ds_read_b128 v[126:129], v10 offset:1296
    v_mfma_f32_16x16x32_bf16 v[28:31], v[110:113], v[154:157], v[28:31]
    ds_read_b128 v[150:153], v11 offset:1568
    s_waitcnt lgkmcnt(6)
    v_mfma_f32_16x16x32_bf16 v[24:27], v[106:109], v[158:161], v[24:27]
    ds_read_b128 v[130:133], v10 offset:2048
    v_mfma_f32_16x16x32_bf16 v[28:31], v[114:117], v[158:161], v[28:31]
    ds_read_b128 v[134:137], v10 offset:2064
    ds_read_b128 v[138:141], v10 offset:2080
    ds_read_b128 v[154:157], v11 offset:2560
    s_waitcnt lgkmcnt(8)
    v_mfma_f32_16x16x32_bf16 v[24:27], v[110:113], v[162:165], v[24:27]
    ds_read_b128 v[142:145], v10 offset:2096
    v_mfma_f32_16x16x32_bf16 v[28:31], v[118:121], v[162:165], v[28:31]
    ds_read_b128 v[158:161], v11 offset:2576
    s_waitcnt lgkmcnt(8)
    v_mfma_f32_16x16x32_bf16 v[24:27], v[114:117], v[146:149], v[24:27]
    ds_read_b128 v[106:109], v10 offset:2112
    v_mfma_f32_16x16x32_bf16 v[28:31], v[122:125], v[146:149], v[28:31]
    ds_read_b128 v[162:165], v11 offset:2592
    s_waitcnt lgkmcnt(8)
    v_mfma_f32_16x16x32_bf16 v[24:27], v[118:121], v[150:153], v[24:27]
    ds_read_b128 v[110:113], v10 offset:2128
    v_mfma_f32_16x16x32_bf16 v[28:31], v[126:129], v[150:153], v[28:31]
    ds_read_b128 v[146:149], v11 offset:2608
    s_waitcnt lgkmcnt(6)
    v_mfma_f32_16x16x32_bf16 v[24:27], v[130:133], v[154:157], v[24:27]
    ds_read_b128 v[114:117], v10 offset:2144
    v_mfma_f32_16x16x32_bf16 v[28:31], v[138:141], v[154:157], v[28:31]
    ds_read_b128 v[150:153], v11 offset:2640
    s_waitcnt lgkmcnt(6)
    v_mfma_f32_16x16x32_bf16 v[24:27], v[134:137], v[158:161], v[24:27]
    ds_read_b128 v[118:121], v10 offset:2160
    v_mfma_f32_16x16x32_bf16 v[28:31], v[142:145], v[158:161], v[28:31]
    ds_read_b128 v[154:157], v11 offset:2656
    s_waitcnt lgkmcnt(6)
    v_mfma_f32_16x16x32_bf16 v[24:27], v[138:141], v[162:165], v[24:27]
    ds_read_b128 v[122:125], v10 offset:2176
    v_mfma_f32_16x16x32_bf16 v[28:31], v[106:109], v[162:165], v[28:31]
    ds_read_b128 v[158:161], v11 offset:2672
    s_waitcnt lgkmcnt(6)
    v_mfma_f32_16x16x32_bf16 v[24:27], v[142:145], v[146:149], v[24:27]
    ds_read_b128 v[126:129], v10 offset:2192
    v_mfma_f32_16x16x32_bf16 v[28:31], v[110:113], v[146:149], v[28:31]
    ds_read_b128 v[162:165], v11 offset:2688
    s_waitcnt lgkmcnt(6)
    v_mfma_f32_16x16x32_bf16 v[24:27], v[106:109], v[150:153], v[24:27]
    ds_read_b128 v[130:133], v10 offset:2208
    v_mfma_f32_16x16x32_bf16 v[28:31], v[114:117], v[150:153], v[28:31]
    ds_read_b128 v[146:149], v11 offset:2720
    s_waitcnt lgkmcnt(6)
    v_mfma_f32_16x16x32_bf16 v[24:27], v[110:113], v[154:157], v[24:27]
    ds_read_b128 v[134:137], v10 offset:2224
    v_mfma_f32_16x16x32_bf16 v[28:31], v[118:121], v[154:157], v[28:31]
    ds_read_b128 v[150:153], v11 offset:2736
    s_waitcnt lgkmcnt(6)
    v_mfma_f32_16x16x32_bf16 v[24:27], v[114:117], v[158:161], v[24:27]
    ds_read_b128 v[138:141], v10 offset:2240
    v_mfma_f32_16x16x32_bf16 v[28:31], v[122:125], v[158:161], v[28:31]
    ds_read_b128 v[154:157], v11 offset:2752
    s_waitcnt lgkmcnt(6)
    v_mfma_f32_16x16x32_bf16 v[24:27], v[118:121], v[162:165], v[24:27]
    ds_read_b128 v[142:145], v10 offset:2256
    v_mfma_f32_16x16x32_bf16 v[28:31], v[126:129], v[162:165], v[28:31]
    ds_read_b128 v[158:161], v11 offset:2768
    s_barrier
    s_waitcnt lgkmcnt(6)
    v_mfma_f32_16x16x32_bf16 v[24:27], v[122:125], v[146:149], v[24:27]
    ds_read_b128 v[106:109], v10 offset:2272
    v_mfma_f32_16x16x32_bf16 v[28:31], v[130:133], v[146:149], v[28:31]
    ds_read_b128 v[162:165], v11 offset:2800
    s_lshl_b32 s96, s90, 12
    s_add_u32 s96, s96, 3211264
    s_waitcnt lgkmcnt(6)
    v_mfma_f32_16x16x32_bf16 v[24:27], v[126:129], v[150:153], v[24:27]
    ds_read_b128 v[110:113], v10 offset:2288
    v_mfma_f32_16x16x32_bf16 v[28:31], v[134:137], v[150:153], v[28:31]
    ds_read_b128 v[146:149], v11 offset:2816
    s_mov_b32 m0, 104448
    s_nop 0
    buffer_load_dwordx4 v5, s[36:39], s96 offen offset:0 sc1 lds
    s_waitcnt lgkmcnt(6)
    v_mfma_f32_16x16x32_bf16 v[24:27], v[130:133], v[154:157], v[24:27]
    ds_read_b128 v[114:117], v10 offset:2304
    v_mfma_f32_16x16x32_bf16 v[28:31], v[138:141], v[154:157], v[28:31]
    ds_read_b128 v[150:153], v11 offset:2832
    s_mov_b32 m0, 104448
    s_nop 0
    buffer_load_dwordx4 v5, s[36:39], s96 offen offset:1024 sc1 lds
    s_waitcnt lgkmcnt(6)
    v_mfma_f32_16x16x32_bf16 v[24:27], v[134:137], v[158:161], v[24:27]
    ds_read_b128 v[118:121], v10 offset:2320
    v_mfma_f32_16x16x32_bf16 v[28:31], v[142:145], v[158:161], v[28:31]
    ds_read_b128 v[154:157], v11 offset:2848
    s_mov_b32 m0, 92160
    s_mov_b32 s97, 270336
    buffer_load_dwordx4 v5, s[36:39], s97 offen offset:0 sc1 lds
    s_waitcnt lgkmcnt(6)
    v_mfma_f32_16x16x32_bf16 v[24:27], v[138:141], v[162:165], v[24:27]
    ds_read_b128 v[122:125], v10 offset:3072
    v_mfma_f32_16x16x32_bf16 v[28:31], v[106:109], v[162:165], v[28:31]
    ds_read_b128 v[126:129], v10 offset:3088
    ds_read_b128 v[130:133], v10 offset:3104
    ds_read_b128 v[158:161], v11 offset:3840
    s_mov_b32 m0, 92160
    s_mov_b32 s97, 270336
    buffer_load_dwordx4 v5, s[36:39], s97 offen offset:1024 sc1 lds
    s_waitcnt lgkmcnt(8)
    v_mfma_f32_16x16x32_bf16 v[24:27], v[142:145], v[146:149], v[24:27]
    ds_read_b128 v[134:137], v10 offset:3120
    v_mfma_f32_16x16x32_bf16 v[28:31], v[110:113], v[146:149], v[28:31]
    ds_read_b128 v[162:165], v11 offset:3856
    s_mov_b32 m0, 92160
    s_mov_b32 s97, 270336
    buffer_load_dwordx4 v5, s[36:39], s97 offen offset:2048 sc1 lds
    s_waitcnt lgkmcnt(8)
    v_mfma_f32_16x16x32_bf16 v[24:27], v[106:109], v[150:153], v[24:27]
    ds_read_b128 v[138:141], v10 offset:3136
    v_mfma_f32_16x16x32_bf16 v[28:31], v[114:117], v[150:153], v[28:31]
    ds_read_b128 v[146:149], v11 offset:3872
    s_mov_b32 m0, 92160
    s_mov_b32 s97, 270336
    buffer_load_dwordx4 v5, s[36:39], s97 offen offset:3072 sc1 lds
    s_waitcnt lgkmcnt(8)
    v_mfma_f32_16x16x32_bf16 v[24:27], v[110:113], v[154:157], v[24:27]
    ds_read_b128 v[142:145], v10 offset:3152
    v_mfma_f32_16x16x32_bf16 v[28:31], v[118:121], v[154:157], v[28:31]
    ds_read_b128 v[150:153], v11 offset:3888
    s_mul_i32 s98, s59, 7
    s_lshl_b32 s99, s56, 1
    s_add_u32 s98, s98, s99
    s_lshl_b32 s98, s98, 14
    s_add_u32 s98, s98, 7536640
    s_add_u32 s99, s98, 16384
    s_cmp_eq_u32 s56, 3
    s_cselect_b32 s99, 1073741824, s99
    s_waitcnt lgkmcnt(6)
    v_mfma_f32_16x16x32_bf16 v[24:27], v[122:125], v[158:161], v[24:27]
    ds_read_b128 v[106:109], v10 offset:3168
    v_mfma_f32_16x16x32_bf16 v[28:31], v[130:133], v[158:161], v[28:31]
    ds_read_b128 v[154:157], v11 offset:3920
    s_add_u32 s73, s98, 917504
    buffer_load_dwordx4 a[0:3], v5, s[36:39], s73 offen offset:0 sc1
    s_waitcnt lgkmcnt(6)
    v_mfma_f32_16x16x32_bf16 v[24:27], v[126:129], v[162:165], v[24:27]
    ds_read_b128 v[110:113], v10 offset:3184
    v_mfma_f32_16x16x32_bf16 v[28:31], v[134:137], v[162:165], v[28:31]
    ds_read_b128 v[158:161], v11 offset:3936
    s_add_u32 s73, s99, 917504
    buffer_load_dwordx4 a[64:67], v5, s[36:39], s73 offen offset:0 sc1
    s_waitcnt lgkmcnt(6)
    v_mfma_f32_16x16x32_bf16 v[24:27], v[130:133], v[146:149], v[24:27]
    ds_read_b128 v[114:117], v10 offset:3200
    v_mfma_f32_16x16x32_bf16 v[28:31], v[138:141], v[146:149], v[28:31]
    ds_read_b128 v[162:165], v11 offset:3952
    s_add_u32 s73, s98, 917504
    buffer_load_dwordx4 a[4:7], v5, s[36:39], s73 offen offset:1024 sc1
    s_waitcnt lgkmcnt(6)
    v_mfma_f32_16x16x32_bf16 v[24:27], v[134:137], v[150:153], v[24:27]
    ds_read_b128 v[118:121], v10 offset:3216
    v_mfma_f32_16x16x32_bf16 v[28:31], v[142:145], v[150:153], v[28:31]
    ds_read_b128 v[146:149], v11 offset:3968
    s_add_u32 s73, s99, 917504
    buffer_load_dwordx4 a[68:71], v5, s[36:39], s73 offen offset:1024 sc1
    s_waitcnt lgkmcnt(6)
    v_mfma_f32_16x16x32_bf16 v[24:27], v[138:141], v[154:157], v[24:27]
    ds_read_b128 v[122:125], v10 offset:3232
    v_mfma_f32_16x16x32_bf16 v[28:31], v[106:109], v[154:157], v[28:31]
    ds_read_b128 v[150:153], v11 offset:4000
    s_add_u32 s73, s98, 917504
    buffer_load_dwordx4 a[8:11], v5, s[36:39], s73 offen offset:2048 sc1
    s_waitcnt lgkmcnt(6)
    v_mfma_f32_16x16x32_bf16 v[24:27], v[142:145], v[158:161], v[24:27]
    ds_read_b128 v[126:129], v10 offset:3248
    v_mfma_f32_16x16x32_bf16 v[28:31], v[110:113], v[158:161], v[28:31]
    ds_read_b128 v[154:157], v11 offset:4016
    s_add_u32 s73, s99, 917504
    buffer_load_dwordx4 a[72:75], v5, s[36:39], s73 offen offset:2048 sc1
    s_waitcnt lgkmcnt(6)
    v_mfma_f32_16x16x32_bf16 v[24:27], v[106:109], v[162:165], v[24:27]
    ds_read_b128 v[130:133], v10 offset:3264
    v_mfma_f32_16x16x32_bf16 v[28:31], v[114:117], v[162:165], v[28:31]
    ds_read_b128 v[158:161], v11 offset:4032
    s_add_u32 s73, s98, 917504
    buffer_load_dwordx4 a[12:15], v5, s[36:39], s73 offen offset:3072 sc1
    s_waitcnt lgkmcnt(6)
    v_mfma_f32_16x16x32_bf16 v[24:27], v[110:113], v[146:149], v[24:27]
    ds_read_b128 v[134:137], v10 offset:3280
    v_mfma_f32_16x16x32_bf16 v[28:31], v[118:121], v[146:149], v[28:31]
    ds_read_b128 v[162:165], v11 offset:4048
    s_add_u32 s73, s99, 917504
    buffer_load_dwordx4 a[76:79], v5, s[36:39], s73 offen offset:3072 sc1
    s_waitcnt lgkmcnt(6)
    v_mfma_f32_16x16x32_bf16 v[24:27], v[114:117], v[150:153], v[24:27]
    ds_read_b128 v[138:141], v10 offset:3296
    v_mfma_f32_16x16x32_bf16 v[28:31], v[122:125], v[150:153], v[28:31]
    ds_read_b128 v[146:149], v11 offset:4080
    s_add_u32 s73, s98, 921600
    buffer_load_dwordx4 a[16:19], v5, s[36:39], s73 offen offset:0 sc1
    s_waitcnt lgkmcnt(6)
    v_mfma_f32_16x16x32_bf16 v[24:27], v[118:121], v[154:157], v[24:27]
    ds_read_b128 v[142:145], v10 offset:3312
    v_mfma_f32_16x16x32_bf16 v[28:31], v[126:129], v[154:157], v[28:31]
    ds_read_b128 v[150:153], v11 offset:4096
    s_add_u32 s73, s99, 921600
    buffer_load_dwordx4 a[80:83], v5, s[36:39], s73 offen offset:0 sc1
    s_waitcnt lgkmcnt(6)
    v_mfma_f32_16x16x32_bf16 v[24:27], v[122:125], v[158:161], v[24:27]
    ds_read_b128 v[106:109], v10 offset:3328
    v_mfma_f32_16x16x32_bf16 v[28:31], v[130:133], v[158:161], v[28:31]
    ds_read_b128 v[154:157], v11 offset:4112
    s_add_u32 s73, s98, 921600
    buffer_load_dwordx4 a[20:23], v5, s[36:39], s73 offen offset:1024 sc1
    s_waitcnt lgkmcnt(6)
    v_mfma_f32_16x16x32_bf16 v[24:27], v[126:129], v[162:165], v[24:27]
    ds_read_b128 v[110:113], v10 offset:3344
    v_mfma_f32_16x16x32_bf16 v[28:31], v[134:137], v[162:165], v[28:31]
    ds_read_b128 v[158:161], v11 offset:4128
    s_add_u32 s73, s99, 921600
    buffer_load_dwordx4 a[84:87], v5, s[36:39], s73 offen offset:1024 sc1
    s_waitcnt lgkmcnt(6)
    v_mfma_f32_16x16x32_bf16 v[24:27], v[130:133], v[146:149], v[24:27]
    v_mfma_f32_16x16x32_bf16 v[28:31], v[138:141], v[146:149], v[28:31]
    s_waitcnt lgkmcnt(4)
    v_mfma_f32_16x16x32_bf16 v[24:27], v[134:137], v[150:153], v[24:27]
    v_mfma_f32_16x16x32_bf16 v[28:31], v[142:145], v[150:153], v[28:31]
    s_waitcnt lgkmcnt(2)
    v_mfma_f32_16x16x32_bf16 v[24:27], v[138:141], v[154:157], v[24:27]
    v_mfma_f32_16x16x32_bf16 v[28:31], v[106:109], v[154:157], v[28:31]
    s_waitcnt lgkmcnt(0)
    v_mfma_f32_16x16x32_bf16 v[24:27], v[142:145], v[158:161], v[24:27]
    v_mfma_f32_16x16x32_bf16 v[28:31], v[110:113], v[158:161], v[28:31]
    s_waitcnt vmcnt(12) lgkmcnt(0)
    s_branch L_cepi_11
L_cw_15:
    ds_read_b128 v[106:109], v10 offset:0
    ds_read_b128 v[110:113], v10 offset:16
    ds_read_b128 v[114:117], v10 offset:32
    ds_read_b128 v[146:149], v11 offset:0
    ds_read_b128 v[166:169], v12 offset:0
    ds_read_b128 v[118:121], v10 offset:48
    ds_read_b128 v[150:153], v11 offset:16
    ds_read_b128 v[170:173], v12 offset:16
    ds_read_b128 v[122:125], v10 offset:64
    ds_read_b128 v[154:157], v11 offset:32
    ds_read_b128 v[174:177], v12 offset:32
    ds_read_b128 v[126:129], v10 offset:80
    ds_read_b128 v[158:161], v11 offset:48
    ds_read_b128 v[178:181], v12 offset:48
    s_waitcnt lgkmcnt(9)
    v_mfma_f32_16x16x32_bf16 v[24:27], v[106:109], v[146:149], 0
    ds_read_b128 v[130:133], v10 offset:96
    v_mfma_f32_16x16x32_bf16 v[28:31], v[114:117], v[146:149], 0
    ds_read_b128 v[162:165], v11 offset:80
    v_lshlrev_b32 v15, 6, v6
    v_and_b32 v2, 1, v7
    v_lshl_add_u32 v15, v2, 5, v15
    v_lshrrev_b32 v2, 1, v7
    v_lshl_add_u32 v15, v2, 4, v15
    v_mfma_f32_16x16x32_bf16 v[32:35], v[106:109], v[166:169], 0
    ds_read_b128 v[182:185], v12 offset:80
    v_mfma_f32_16x16x32_bf16 v[36:39], v[114:117], v[166:169], 0
    v_mul_u32_u24 v3, 80, v6
    v_lshl_add_u32 v3, v7, 3, v3
    v_sub_u32 v3, 5064, v3
    s_mul_i32 s65, s91, 1280
    s_sub_u32 s65, s95, s65
    v_add_u32 v13, s65, v3
    s_mul_i32 s65, s92, 1280
    s_sub_u32 s65, s95, s65
    v_add_u32 v14, s65, v3
    s_waitcnt lgkmcnt(9)
    v_mfma_f32_16x16x32_bf16 v[24:27], v[110:113], v[150:153], v[24:27]
    ds_read_b128 v[134:137], v10 offset:112
    v_mfma_f32_16x16x32_bf16 v[28:31], v[118:121], v[150:153], v[28:31]
    ds_read_b128 v[146:149], v11 offset:96
    v_lshlrev_b32 v2, 7, v6
    v_lshl_add_u32 v2, v7, 4, v2
    s_lshl_b32 s64, s91, 11
    s_add_u32 s64, s64, 83968
    v_add_u32 v18, s64, v2
    s_lshl_b32 s64, s92, 11
    s_add_u32 s64, s64, 83968
    v_add_u32 v19, s64, v2
    v_mfma_f32_16x16x32_bf16 v[32:35], v[110:113], v[170:173], v[32:35]
    ds_read_b128 v[166:169], v12 offset:96
    v_mfma_f32_16x16x32_bf16 v[36:39], v[118:121], v[170:173], v[36:39]
    v_lshlrev_b32 v2, 6, v6
    v_lshl_add_u32 v2, v7, 3, v2
    s_lshl_b32 s65, s88, 12
    s_lshl_b32 s64, s91, 10
    s_add_u32 s64, s64, s65
    s_add_u32 s64, s64, 100352
    v_add_u32 v20, s64, v2
    s_lshl_b32 s64, s92, 10
    s_add_u32 s64, s64, s65
    s_add_u32 s64, s64, 100352
    v_add_u32 v21, s64, v2
    s_waitcnt lgkmcnt(9)
    v_mfma_f32_16x16x32_bf16 v[24:27], v[114:117], v[154:157], v[24:27]
    ds_read_b128 v[138:141], v10 offset:128
    v_mfma_f32_16x16x32_bf16 v[28:31], v[122:125], v[154:157], v[28:31]
    ds_read_b128 v[150:153], v11 offset:112
    s_lshl_b32 s60, s90, 12
    s_lshl_b32 s93, s91, 10
    s_add_u32 s93, s93, s60
    s_add_u32 s93, s93, 5373952
    s_lshl_b32 s94, s92, 10
    s_add_u32 s94, s94, s60
    s_add_u32 s94, s94, 5373952
    v_mfma_f32_16x16x32_bf16 v[32:35], v[114:117], v[174:177], v[32:35]
    ds_read_b128 v[170:173], v12 offset:112
    v_mfma_f32_16x16x32_bf16 v[36:39], v[122:125], v[174:177], v[36:39]
    s_mov_b32 s40, s14
    s_mov_b32 s41, s15
    s_mov_b32 s42, 1024
    s_mov_b32 s43, 0x20000
    s_lshl_b32 s60, s90, 1
    buffer_load_ushort v63, v4, s[40:43], s60 offen
    s_waitcnt lgkmcnt(9)
    v_mfma_f32_16x16x32_bf16 v[24:27], v[118:121], v[158:161], v[24:27]
    ds_read_b128 v[142:145], v10 offset:144
    v_mfma_f32_16x16x32_bf16 v[28:31], v[126:129], v[158:161], v[28:31]
    ds_read_b128 v[154:157], v11 offset:128
    v_mfma_f32_16x16x32_bf16 v[32:35], v[118:121], v[178:181], v[32:35]
    ds_read_b128 v[174:177], v12 offset:128
    v_mfma_f32_16x16x32_bf16 v[36:39], v[126:129], v[178:181], v[36:39]
    s_waitcnt lgkmcnt(9)
    v_mfma_f32_16x16x32_bf16 v[24:27], v[122:125], v[162:165], v[24:27]
    ds_read_b128 v[106:109], v10 offset:160
    v_mfma_f32_16x16x32_bf16 v[28:31], v[130:133], v[162:165], v[28:31]
    ds_read_b128 v[158:161], v11 offset:160
    v_mfma_f32_16x16x32_bf16 v[32:35], v[122:125], v[182:185], v[32:35]
    ds_read_b128 v[178:181], v12 offset:160
    v_mfma_f32_16x16x32_bf16 v[36:39], v[130:133], v[182:185], v[36:39]
    s_waitcnt lgkmcnt(9)
    v_mfma_f32_16x16x32_bf16 v[24:27], v[126:129], v[146:149], v[24:27]
    ds_read_b128 v[110:113], v10 offset:176
    v_mfma_f32_16x16x32_bf16 v[28:31], v[134:137], v[146:149], v[28:31]
    ds_read_b128 v[162:165], v11 offset:176
    v_mfma_f32_16x16x32_bf16 v[32:35], v[126:129], v[166:169], v[32:35]
    ds_read_b128 v[182:185], v12 offset:176
    v_mfma_f32_16x16x32_bf16 v[36:39], v[134:137], v[166:169], v[36:39]
    s_waitcnt lgkmcnt(9)
    v_mfma_f32_16x16x32_bf16 v[24:27], v[130:133], v[150:153], v[24:27]
    ds_read_b128 v[114:117], v10 offset:192
    v_mfma_f32_16x16x32_bf16 v[28:31], v[138:141], v[150:153], v[28:31]
    ds_read_b128 v[146:149], v11 offset:192
    v_mfma_f32_16x16x32_bf16 v[32:35], v[130:133], v[170:173], v[32:35]
    ds_read_b128 v[166:169], v12 offset:192
    v_mfma_f32_16x16x32_bf16 v[36:39], v[138:141], v[170:173], v[36:39]
    s_waitcnt lgkmcnt(9)
    v_mfma_f32_16x16x32_bf16 v[24:27], v[134:137], v[154:157], v[24:27]
    ds_read_b128 v[118:121], v10 offset:208
    v_mfma_f32_16x16x32_bf16 v[28:31], v[142:145], v[154:157], v[28:31]
    ds_read_b128 v[150:153], v11 offset:208
    v_mfma_f32_16x16x32_bf16 v[32:35], v[134:137], v[174:177], v[32:35]
    ds_read_b128 v[170:173], v12 offset:208
    v_mfma_f32_16x16x32_bf16 v[36:39], v[142:145], v[174:177], v[36:39]
    s_waitcnt lgkmcnt(9)
    v_mfma_f32_16x16x32_bf16 v[24:27], v[138:141], v[158:161], v[24:27]
    ds_read_b128 v[122:125], v10 offset:224
    v_mfma_f32_16x16x32_bf16 v[28:31], v[106:109], v[158:161], v[28:31]
    ds_read_b128 v[154:157], v11 offset:240
    v_mfma_f32_16x16x32_bf16 v[32:35], v[138:141], v[178:181], v[32:35]
    ds_read_b128 v[174:177], v12 offset:240
    v_mfma_f32_16x16x32_bf16 v[36:39], v[106:109], v[178:181], v[36:39]
    s_waitcnt lgkmcnt(9)
    v_mfma_f32_16x16x32_bf16 v[24:27], v[142:145], v[162:165], v[24:27]
    ds_read_b128 v[126:129], v10 offset:240
    v_mfma_f32_16x16x32_bf16 v[28:31], v[110:113], v[162:165], v[28:31]
    ds_read_b128 v[158:161], v11 offset:256
    v_mfma_f32_16x16x32_bf16 v[32:35], v[142:145], v[182:185], v[32:35]
    ds_read_b128 v[178:181], v12 offset:256
    v_mfma_f32_16x16x32_bf16 v[36:39], v[110:113], v[182:185], v[36:39]
    s_waitcnt lgkmcnt(9)
    v_mfma_f32_16x16x32_bf16 v[24:27], v[106:109], v[146:149], v[24:27]
    ds_read_b128 v[130:133], v10 offset:256
    v_mfma_f32_16x16x32_bf16 v[28:31], v[114:117], v[146:149], v[28:31]
    ds_read_b128 v[162:165], v11 offset:272
    v_mfma_f32_16x16x32_bf16 v[32:35], v[106:109], v[166:169], v[32:35]
    ds_read_b128 v[182:185], v12 offset:272
    v_mfma_f32_16x16x32_bf16 v[36:39], v[114:117], v[166:169], v[36:39]
    s_waitcnt lgkmcnt(9)
    v_mfma_f32_16x16x32_bf16 v[24:27], v[110:113], v[150:153], v[24:27]
    ds_read_b128 v[134:137], v10 offset:272
    v_mfma_f32_16x16x32_bf16 v[28:31], v[118:121], v[150:153], v[28:31]
    ds_read_b128 v[146:149], v11 offset:288
    v_mfma_f32_16x16x32_bf16 v[32:35], v[110:113], v[170:173], v[32:35]
    ds_read_b128 v[166:169], v12 offset:288
    v_mfma_f32_16x16x32_bf16 v[36:39], v[118:121], v[170:173], v[36:39]
    s_waitcnt lgkmcnt(9)
    v_mfma_f32_16x16x32_bf16 v[24:27], v[114:117], v[154:157], v[24:27]
    ds_read_b128 v[138:141], v10 offset:1024
    v_mfma_f32_16x16x32_bf16 v[28:31], v[122:125], v[154:157], v[28:31]
    ds_read_b128 v[142:145], v10 offset:1040
    v_mfma_f32_16x16x32_bf16 v[32:35], v[114:117], v[174:177], v[32:35]
    ds_read_b128 v[106:109], v10 offset:1056
    v_mfma_f32_16x16x32_bf16 v[36:39], v[122:125], v[174:177], v[36:39]
    ds_read_b128 v[150:153], v11 offset:1280
    ds_read_b128 v[170:173], v12 offset:1280
    s_waitcnt lgkmcnt(11)
    v_mfma_f32_16x16x32_bf16 v[24:27], v[118:121], v[158:161], v[24:27]
    ds_read_b128 v[110:113], v10 offset:1072
    v_mfma_f32_16x16x32_bf16 v[28:31], v[126:129], v[158:161], v[28:31]
    ds_read_b128 v[154:157], v11 offset:1296
    v_mfma_f32_16x16x32_bf16 v[32:35], v[118:121], v[178:181], v[32:35]
    ds_read_b128 v[174:177], v12 offset:1296
    v_mfma_f32_16x16x32_bf16 v[36:39], v[126:129], v[178:181], v[36:39]
    s_waitcnt lgkmcnt(11)
    v_mfma_f32_16x16x32_bf16 v[24:27], v[122:125], v[162:165], v[24:27]
    ds_read_b128 v[114:117], v10 offset:1088
    v_mfma_f32_16x16x32_bf16 v[28:31], v[130:133], v[162:165], v[28:31]
    ds_read_b128 v[158:161], v11 offset:1312
    v_mfma_f32_16x16x32_bf16 v[32:35], v[122:125], v[182:185], v[32:35]
    ds_read_b128 v[178:181], v12 offset:1312
    v_mfma_f32_16x16x32_bf16 v[36:39], v[130:133], v[182:185], v[36:39]
    s_waitcnt lgkmcnt(11)
    v_mfma_f32_16x16x32_bf16 v[24:27], v[126:129], v[146:149], v[24:27]
    ds_read_b128 v[118:121], v10 offset:1104
    v_mfma_f32_16x16x32_bf16 v[28:31], v[134:137], v[146:149], v[28:31]
    ds_read_b128 v[162:165], v11 offset:1328
    v_mfma_f32_16x16x32_bf16 v[32:35], v[126:129], v[166:169], v[32:35]
    ds_read_b128 v[182:185], v12 offset:1328
    v_mfma_f32_16x16x32_bf16 v[36:39], v[134:137], v[166:169], v[36:39]
    s_waitcnt lgkmcnt(9)
    v_mfma_f32_16x16x32_bf16 v[24:27], v[138:141], v[150:153], v[24:27]
    ds_read_b128 v[122:125], v10 offset:1120
    v_mfma_f32_16x16x32_bf16 v[28:31], v[106:109], v[150:153], v[28:31]
    ds_read_b128 v[146:149], v11 offset:1360
    v_mfma_f32_16x16x32_bf16 v[32:35], v[138:141], v[170:173], v[32:35]
    ds_read_b128 v[166:169], v12 offset:1360
    v_mfma_f32_16x16x32_bf16 v[36:39], v[106:109], v[170:173], v[36:39]
    s_waitcnt lgkmcnt(9)
    v_mfma_f32_16x16x32_bf16 v[24:27], v[142:145], v[154:157], v[24:27]
    ds_read_b128 v[126:129], v10 offset:1136
    v_mfma_f32_16x16x32_bf16 v[28:31], v[110:113], v[154:157], v[28:31]
    ds_read_b128 v[150:153], v11 offset:1376
    v_mfma_f32_16x16x32_bf16 v[32:35], v[142:145], v[174:177], v[32:35]
    ds_read_b128 v[170:173], v12 offset:1376
    v_mfma_f32_16x16x32_bf16 v[36:39], v[110:113], v[174:177], v[36:39]
    s_waitcnt lgkmcnt(9)
    v_mfma_f32_16x16x32_bf16 v[24:27], v[106:109], v[158:161], v[24:27]
    ds_read_b128 v[130:133], v10 offset:1152
    v_mfma_f32_16x16x32_bf16 v[28:31], v[114:117], v[158:161], v[28:31]
    ds_read_b128 v[154:157], v11 offset:1392
    v_mfma_f32_16x16x32_bf16 v[32:35], v[106:109], v[178:181], v[32:35]
    ds_read_b128 v[174:177], v12 offset:1392
    v_mfma_f32_16x16x32_bf16 v[36:39], v[114:117], v[178:181], v[36:39]
    s_waitcnt lgkmcnt(9)
    v_mfma_f32_16x16x32_bf16 v[24:27], v[110:113], v[162:165], v[24:27]
    ds_read_b128 v[134:137], v10 offset:1168
    v_mfma_f32_16x16x32_bf16 v[28:31], v[118:121], v[162:165], v[28:31]
    ds_read_b128 v[158:161], v11 offset:1408
    v_mfma_f32_16x16x32_bf16 v[32:35], v[110:113], v[182:185], v[32:35]
    ds_read_b128 v[178:181], v12 offset:1408
    v_mfma_f32_16x16x32_bf16 v[36:39], v[118:121], v[182:185], v[36:39]
    s_waitcnt lgkmcnt(9)
    v_mfma_f32_16x16x32_bf16 v[24:27], v[114:117], v[146:149], v[24:27]
    ds_read_b128 v[138:141], v10 offset:1184
    v_mfma_f32_16x16x32_bf16 v[28:31], v[122:125], v[146:149], v[28:31]
    ds_read_b128 v[162:165], v11 offset:1440
    v_mfma_f32_16x16x32_bf16 v[32:35], v[114:117], v[166:169], v[32:35]
    ds_read_b128 v[182:185], v12 offset:1440
    v_mfma_f32_16x16x32_bf16 v[36:39], v[122:125], v[166:169], v[36:39]
    s_waitcnt lgkmcnt(9)
    v_mfma_f32_16x16x32_bf16 v[24:27], v[118:121], v[150:153], v[24:27]
    ds_read_b128 v[142:145], v10 offset:1200
    v_mfma_f32_16x16x32_bf16 v[28:31], v[126:129], v[150:153], v[28:31]
    ds_read_b128 v[146:149], v11 offset:1456
    v_mfma_f32_16x16x32_bf16 v[32:35], v[118:121], v[170:173], v[32:35]
    ds_read_b128 v[166:169], v12 offset:1456
    v_mfma_f32_16x16x32_bf16 v[36:39], v[126:129], v[170:173], v[36:39]
    s_waitcnt lgkmcnt(9)
    v_mfma_f32_16x16x32_bf16 v[24:27], v[122:125], v[154:157], v[24:27]
    ds_read_b128 v[106:109], v10 offset:1216
    v_mfma_f32_16x16x32_bf16 v[28:31], v[130:133], v[154:157], v[28:31]
    ds_read_b128 v[150:153], v11 offset:1472
    v_mfma_f32_16x16x32_bf16 v[32:35], v[122:125], v[174:177], v[32:35]
    ds_read_b128 v[170:173], v12 offset:1472
    v_mfma_f32_16x16x32_bf16 v[36:39], v[130:133], v[174:177], v[36:39]
    s_waitcnt lgkmcnt(9)
    v_mfma_f32_16x16x32_bf16 v[24:27], v[126:129], v[158:161], v[24:27]
    ds_read_b128 v[110:113], v10 offset:1232
    v_mfma_f32_16x16x32_bf16 v[28:31], v[134:137], v[158:161], v[28:31]
    ds_read_b128 v[154:157], v11 offset:1488
    v_mfma_f32_16x16x32_bf16 v[32:35], v[126:129], v[178:181], v[32:35]
    ds_read_b128 v[174:177], v12 offset:1488
    v_mfma_f32_16x16x32_bf16 v[36:39], v[134:137], v[178:181], v[36:39]
    s_waitcnt lgkmcnt(9)
    v_mfma_f32_16x16x32_bf16 v[24:27], v[130:133], v[162:165], v[24:27]
    ds_read_b128 v[114:117], v10 offset:1248
    v_mfma_f32_16x16x32_bf16 v[28:31], v[138:141], v[162:165], v[28:31]
    ds_read_b128 v[158:161], v11 offset:1520
    v_mfma_f32_16x16x32_bf16 v[32:35], v[130:133], v[182:185], v[32:35]
    ds_read_b128 v[178:181], v12 offset:1520
    v_mfma_f32_16x16x32_bf16 v[36:39], v[138:141], v[182:185], v[36:39]
    s_waitcnt lgkmcnt(9)
    v_mfma_f32_16x16x32_bf16 v[24:27], v[134:137], v[146:149], v[24:27]
    ds_read_b128 v[118:121], v10 offset:1264
    v_mfma_f32_16x16x32_bf16 v[28:31], v[142:145], v[146:149], v[28:31]
    ds_read_b128 v[162:165], v11 offset:1536
    v_mfma_f32_16x16x32_bf16 v[32:35], v[134:137], v[166:169], v[32:35]
    ds_read_b128 v[182:185], v12 offset:1536
    v_mfma_f32_16x16x32_bf16 v[36:39], v[142:145], v[166:169], v[36:39]
    s_waitcnt lgkmcnt(9)
    v_mfma_f32_16x16x32_bf16 v[24:27], v[138:141], v[150:153], v[24:27]
    ds_read_b128 v[122:125], v10 offset:1280
    v_mfma_f32_16x16x32_bf16 v[28:31], v[106:109], v[150:153], v[28:31]
    ds_read_b128 v[146:149], v11 offset:1552
    v_mfma_f32_16x16x32_bf16 v[32:35], v[138:141], v[170:173], v[32:35]
    ds_read_b128 v[166:169], v12 offset:1552
    v_mfma_f32_16x16x32_bf16 v[36:39], v[106:109], v[170:173], v[36:39]
    s_waitcnt lgkmcnt(9)
    v_mfma_f32_16x16x32_bf16 v[24:27], v[142:145], v[154:157], v[24:27]
    ds_read_b128 v[126:129], v10 offset:1296
    v_mfma_f32_16x16x32_bf16 v[28:31], v[110:113], v[154:157], v[28:31]
    ds_read_b128 v[150:153], v11 offset:1568
    v_mfma_f32_16x16x32_bf16 v[32:35], v[142:145], v[174:177], v[32:35]
    ds_read_b128 v[170:173], v12 offset:1568
    v_mfma_f32_16x16x32_bf16 v[36:39], v[110:113], v[174:177], v[36:39]
    s_barrier
    s_waitcnt lgkmcnt(9)
    v_mfma_f32_16x16x32_bf16 v[24:27], v[106:109], v[158:161], v[24:27]
    ds_read_b128 v[130:133], v10 offset:2048
    v_mfma_f32_16x16x32_bf16 v[28:31], v[114:117], v[158:161], v[28:31]
    ds_read_b128 v[134:137], v10 offset:2064
    s_lshl_b32 s96, s90, 12
    s_add_u32 s96, s96, 3213312
    v_mfma_f32_16x16x32_bf16 v[32:35], v[106:109], v[178:181], v[32:35]
    ds_read_b128 v[138:141], v10 offset:2080
    v_mfma_f32_16x16x32_bf16 v[36:39], v[114:117], v[178:181], v[36:39]
    ds_read_b128 v[154:157], v11 offset:2560
    s_mov_b32 m0, 106496
    s_nop 0
    buffer_load_dwordx4 v5, s[36:39], s96 offen offset:0 sc1 lds
    s_waitcnt lgkmcnt(10)
    v_mfma_f32_16x16x32_bf16 v[24:27], v[110:113], v[162:165], v[24:27]
    ds_read_b128 v[142:145], v10 offset:2096
    v_mfma_f32_16x16x32_bf16 v[28:31], v[118:121], v[162:165], v[28:31]
    ds_read_b128 v[158:161], v11 offset:2576
    s_mov_b32 m0, 106496
    s_nop 0
    buffer_load_dwordx4 v5, s[36:39], s96 offen offset:1024 sc1 lds
    v_mfma_f32_16x16x32_bf16 v[32:35], v[110:113], v[182:185], v[32:35]
    v_mfma_f32_16x16x32_bf16 v[36:39], v[118:121], v[182:185], v[36:39]
    s_mov_b32 m0, 96256
    s_mov_b32 s97, 274432
    buffer_load_dwordx4 v5, s[36:39], s97 offen offset:0 sc1 lds
    s_waitcnt lgkmcnt(9)
    v_mfma_f32_16x16x32_bf16 v[24:27], v[114:117], v[146:149], v[24:27]
    ds_read_b128 v[106:109], v10 offset:2112
    v_mfma_f32_16x16x32_bf16 v[28:31], v[122:125], v[146:149], v[28:31]
    ds_read_b128 v[162:165], v11 offset:2592
    s_mov_b32 m0, 96256
    s_mov_b32 s97, 274432
    buffer_load_dwordx4 v5, s[36:39], s97 offen offset:1024 sc1 lds
    v_mfma_f32_16x16x32_bf16 v[32:35], v[114:117], v[166:169], v[32:35]
    v_mfma_f32_16x16x32_bf16 v[36:39], v[122:125], v[166:169], v[36:39]
    s_mov_b32 m0, 96256
    s_mov_b32 s97, 274432
    buffer_load_dwordx4 v5, s[36:39], s97 offen offset:2048 sc1 lds
    s_waitcnt lgkmcnt(8)
    v_mfma_f32_16x16x32_bf16 v[24:27], v[118:121], v[150:153], v[24:27]
    ds_read_b128 v[110:113], v10 offset:2128
    v_mfma_f32_16x16x32_bf16 v[28:31], v[126:129], v[150:153], v[28:31]
    ds_read_b128 v[146:149], v11 offset:2608
    s_mov_b32 m0, 96256
    s_mov_b32 s97, 274432
    buffer_load_dwordx4 v5, s[36:39], s97 offen offset:3072 sc1 lds
    v_mfma_f32_16x16x32_bf16 v[32:35], v[118:121], v[170:173], v[32:35]
    v_mfma_f32_16x16x32_bf16 v[36:39], v[126:129], v[170:173], v[36:39]
    s_mul_i32 s98, s59, 7
    s_lshl_b32 s99, s56, 1
    s_add_u32 s98, s98, s99
    s_lshl_b32 s98, s98, 14
    s_add_u32 s98, s98, 7536640
    s_add_u32 s99, s98, 16384
    s_cmp_eq_u32 s56, 3
    s_cselect_b32 s99, 1073741824, s99
    s_waitcnt lgkmcnt(6)
    v_mfma_f32_16x16x32_bf16 v[24:27], v[130:133], v[154:157], v[24:27]
    ds_read_b128 v[114:117], v10 offset:2144
    v_mfma_f32_16x16x32_bf16 v[28:31], v[138:141], v[154:157], v[28:31]
    ds_read_b128 v[150:153], v11 offset:2640
    s_add_u32 s73, s98, 917504
    buffer_load_dwordx4 a[0:3], v5, s[36:39], s73 offen offset:0 sc1
    s_waitcnt lgkmcnt(6)
    v_mfma_f32_16x16x32_bf16 v[24:27], v[134:137], v[158:161], v[24:27]
    ds_read_b128 v[118:121], v10 offset:2160
    v_mfma_f32_16x16x32_bf16 v[28:31], v[142:145], v[158:161], v[28:31]
    ds_read_b128 v[154:157], v11 offset:2656
    s_add_u32 s73, s99, 917504
    buffer_load_dwordx4 a[64:67], v5, s[36:39], s73 offen offset:0 sc1
    s_waitcnt lgkmcnt(6)
    v_mfma_f32_16x16x32_bf16 v[24:27], v[138:141], v[162:165], v[24:27]
    ds_read_b128 v[122:125], v10 offset:2176
    v_mfma_f32_16x16x32_bf16 v[28:31], v[106:109], v[162:165], v[28:31]
    ds_read_b128 v[158:161], v11 offset:2672
    s_add_u32 s73, s98, 917504
    buffer_load_dwordx4 a[4:7], v5, s[36:39], s73 offen offset:1024 sc1
    s_waitcnt lgkmcnt(6)
    v_mfma_f32_16x16x32_bf16 v[24:27], v[142:145], v[146:149], v[24:27]
    ds_read_b128 v[126:129], v10 offset:2192
    v_mfma_f32_16x16x32_bf16 v[28:31], v[110:113], v[146:149], v[28:31]
    ds_read_b128 v[162:165], v11 offset:2688
    s_add_u32 s73, s99, 917504
    buffer_load_dwordx4 a[68:71], v5, s[36:39], s73 offen offset:1024 sc1
    s_waitcnt lgkmcnt(6)
    v_mfma_f32_16x16x32_bf16 v[24:27], v[106:109], v[150:153], v[24:27]
    ds_read_b128 v[130:133], v10 offset:2208
    v_mfma_f32_16x16x32_bf16 v[28:31], v[114:117], v[150:153], v[28:31]
    ds_read_b128 v[146:149], v11 offset:2720
    s_add_u32 s73, s98, 917504
    buffer_load_dwordx4 a[8:11], v5, s[36:39], s73 offen offset:2048 sc1
    s_waitcnt lgkmcnt(6)
    v_mfma_f32_16x16x32_bf16 v[24:27], v[110:113], v[154:157], v[24:27]
    ds_read_b128 v[134:137], v10 offset:2224
    v_mfma_f32_16x16x32_bf16 v[28:31], v[118:121], v[154:157], v[28:31]
    ds_read_b128 v[150:153], v11 offset:2736
    s_add_u32 s73, s99, 917504
    buffer_load_dwordx4 a[72:75], v5, s[36:39], s73 offen offset:2048 sc1
    s_waitcnt lgkmcnt(6)
    v_mfma_f32_16x16x32_bf16 v[24:27], v[114:117], v[158:161], v[24:27]
    ds_read_b128 v[138:141], v10 offset:2240
    v_mfma_f32_16x16x32_bf16 v[28:31], v[122:125], v[158:161], v[28:31]
    ds_read_b128 v[154:157], v11 offset:2752
    s_add_u32 s73, s98, 917504
    buffer_load_dwordx4 a[12:15], v5, s[36:39], s73 offen offset:3072 sc1
    s_waitcnt lgkmcnt(6)
    v_mfma_f32_16x16x32_bf16 v[24:27], v[118:121], v[162:165], v[24:27]
    ds_read_b128 v[142:145], v10 offset:2256
    v_mfma_f32_16x16x32_bf16 v[28:31], v[126:129], v[162:165], v[28:31]
    ds_read_b128 v[158:161], v11 offset:2768
    s_add_u32 s73, s99, 917504
    buffer_load_dwordx4 a[76:79], v5, s[36:39], s73 offen offset:3072 sc1
    s_waitcnt lgkmcnt(6)
    v_mfma_f32_16x16x32_bf16 v[24:27], v[122:125], v[146:149], v[24:27]
    ds_read_b128 v[106:109], v10 offset:2272
    v_mfma_f32_16x16x32_bf16 v[28:31], v[130:133], v[146:149], v[28:31]
    ds_read_b128 v[162:165], v11 offset:2800
    s_add_u32 s73, s98, 921600
    buffer_load_dwordx4 a[16:19], v5, s[36:39], s73 offen offset:0 sc1
    s_waitcnt lgkmcnt(6)
    v_mfma_f32_16x16x32_bf16 v[24:27], v[126:129], v[150:153], v[24:27]
    ds_read_b128 v[110:113], v10 offset:2288
    v_mfma_f32_16x16x32_bf16 v[28:31], v[134:137], v[150:153], v[28:31]
    ds_read_b128 v[146:149], v11 offset:2816
    s_add_u32 s73, s99, 921600
    buffer_load_dwordx4 a[80:83], v5, s[36:39], s73 offen offset:0 sc1
    s_waitcnt lgkmcnt(6)
    v_mfma_f32_16x16x32_bf16 v[24:27], v[130:133], v[154:157], v[24:27]
    ds_read_b128 v[114:117], v10 offset:2304
    v_mfma_f32_16x16x32_bf16 v[28:31], v[138:141], v[154:157], v[28:31]
    ds_read_b128 v[150:153], v11 offset:2832
    s_add_u32 s73, s98, 921600
    buffer_load_dwordx4 a[20:23], v5, s[36:39], s73 offen offset:1024 sc1
    s_waitcnt lgkmcnt(6)
    v_mfma_f32_16x16x32_bf16 v[24:27], v[134:137], v[158:161], v[24:27]
    ds_read_b128 v[118:121], v10 offset:2320
    v_mfma_f32_16x16x32_bf16 v[28:31], v[142:145], v[158:161], v[28:31]
    ds_read_b128 v[154:157], v11 offset:2848
    s_add_u32 s73, s99, 921600
    buffer_load_dwordx4 a[84:87], v5, s[36:39], s73 offen offset:1024 sc1
    s_waitcnt lgkmcnt(6)
    v_mfma_f32_16x16x32_bf16 v[24:27], v[138:141], v[162:165], v[24:27]
    v_mfma_f32_16x16x32_bf16 v[28:31], v[106:109], v[162:165], v[28:31]
    s_waitcnt lgkmcnt(4)
    v_mfma_f32_16x16x32_bf16 v[24:27], v[142:145], v[146:149], v[24:27]
    v_mfma_f32_16x16x32_bf16 v[28:31], v[110:113], v[146:149], v[28:31]
    s_waitcnt lgkmcnt(2)
    v_mfma_f32_16x16x32_bf16 v[24:27], v[106:109], v[150:153], v[24:27]
    v_mfma_f32_16x16x32_bf16 v[28:31], v[114:117], v[150:153], v[28:31]
    s_waitcnt lgkmcnt(0)
    v_mfma_f32_16x16x32_bf16 v[24:27], v[110:113], v[154:157], v[24:27]
    v_mfma_f32_16x16x32_bf16 v[28:31], v[118:121], v[154:157], v[28:31]
    s_waitcnt vmcnt(12) lgkmcnt(0)
L_cepi_11:
    ds_read_b64 v[186:187], v13 offset:32
    ds_read_b64 v[188:189], v13 offset:0
    ds_read_b64 v[190:191], v14 offset:32
    ds_read_b64 v[192:193], v14 offset:0
    s_mul_i32 s60, s88, 96
    s_add_u32 s60, s60, 133120
    v_mov_b32 v2, s60
    v_lshlrev_b32 v63, 16, v63
    s_barrier
    ds_read2_b32 v[60:61], v2 offset0:0 offset1:8
    ds_read_b32 v62, v2 offset:64
    ds_read_b64 v[64:65], v20 offset:0
    ds_read_b64 v[66:67], v20 offset:32
    ds_read_b64 v[68:69], v21 offset:0
    ds_read_b64 v[70:71], v21 offset:32
    ds_read_b128 v[72:75], v18 offset:0
    ds_read_b128 v[88:91], v18 offset:8192
    ds_read_b128 v[76:79], v18 offset:64
    ds_read_b128 v[92:95], v18 offset:8256
    ds_read_b128 v[80:83], v19 offset:0
    ds_read_b128 v[96:99], v19 offset:8192
    ds_read_b128 v[84:87], v19 offset:64
    ds_read_b128 v[100:103], v19 offset:8256
    s_waitcnt lgkmcnt(12)
    v_lshlrev_b32 v123, 16, v187
    v_and_b32 v122, 0xffff0000, v187
    v_lshlrev_b32 v125, 16, v186
    v_and_b32 v124, 0xffff0000, v186
    v_lshlrev_b32 v127, 16, v189
    v_and_b32 v126, 0xffff0000, v189
    v_lshlrev_b32 v129, 16, v188
    v_and_b32 v128, 0xffff0000, v188
    v_lshlrev_b32 v131, 16, v191
    v_and_b32 v130, 0xffff0000, v191
    v_lshlrev_b32 v133, 16, v190
    v_and_b32 v132, 0xffff0000, v190
    v_lshlrev_b32 v135, 16, v193
    v_and_b32 v134, 0xffff0000, v193
    v_lshlrev_b32 v137, 16, v192
    v_and_b32 v136, 0xffff0000, v192
    v_pk_fma_f32 v[122:123], v[122:123], v[62:63], v[24:25] op_sel:[0,1,0] op_sel_hi:[1,1,1]
    v_pk_fma_f32 v[124:125], v[124:125], v[62:63], v[26:27] op_sel:[0,1,0] op_sel_hi:[1,1,1]
    v_pk_fma_f32 v[126:127], v[126:127], v[62:63], v[28:29] op_sel:[0,1,0] op_sel_hi:[1,1,1]
    v_pk_fma_f32 v[128:129], v[128:129], v[62:63], v[30:31] op_sel:[0,1,0] op_sel_hi:[1,1,1]
    v_pk_fma_f32 v[130:131], v[130:131], v[62:63], v[32:33] op_sel:[0,1,0] op_sel_hi:[1,1,1]
    v_pk_fma_f32 v[132:133], v[132:133], v[62:63], v[34:35] op_sel:[0,1,0] op_sel_hi:[1,1,1]
    v_pk_fma_f32 v[134:135], v[134:135], v[62:63], v[36:37] op_sel:[0,1,0] op_sel_hi:[1,1,1]
    v_pk_fma_f32 v[136:137], v[136:137], v[62:63], v[38:39] op_sel:[0,1,0] op_sel_hi:[1,1,1]
    v_add_f32 v61, 1.0, v61
    v_cvt_pk_bf16_f32 v61, v61, v61
    v_lshlrev_b32 v61, 16, v61
    s_waitcnt lgkmcnt(8)
    v_lshlrev_b32 v106, 16, v64
    v_and_b32 v107, 0xffff0000, v64
    v_lshlrev_b32 v108, 16, v65
    v_and_b32 v109, 0xffff0000, v65
    v_lshlrev_b32 v110, 16, v66
    v_and_b32 v111, 0xffff0000, v66
    v_lshlrev_b32 v112, 16, v67
    v_and_b32 v113, 0xffff0000, v67
    v_lshlrev_b32 v114, 16, v68
    v_and_b32 v115, 0xffff0000, v68
    v_lshlrev_b32 v116, 16, v69
    v_and_b32 v117, 0xffff0000, v69
    v_lshlrev_b32 v118, 16, v70
    v_and_b32 v119, 0xffff0000, v70
    v_lshlrev_b32 v120, 16, v71
    v_and_b32 v121, 0xffff0000, v71
    v_pk_mul_f32 v[122:123], v[122:123], v[62:63] op_sel:[0,0] op_sel_hi:[1,0]
    v_pk_mul_f32 v[124:125], v[124:125], v[62:63] op_sel:[0,0] op_sel_hi:[1,0]
    v_pk_mul_f32 v[126:127], v[126:127], v[62:63] op_sel:[0,0] op_sel_hi:[1,0]
    v_pk_mul_f32 v[128:129], v[128:129], v[62:63] op_sel:[0,0] op_sel_hi:[1,0]
    v_pk_mul_f32 v[130:131], v[130:131], v[62:63] op_sel:[0,0] op_sel_hi:[1,0]
    v_pk_mul_f32 v[132:133], v[132:133], v[62:63] op_sel:[0,0] op_sel_hi:[1,0]
    v_pk_mul_f32 v[134:135], v[134:135], v[62:63] op_sel:[0,0] op_sel_hi:[1,0]
    v_pk_mul_f32 v[136:137], v[136:137], v[62:63] op_sel:[0,0] op_sel_hi:[1,0]
    s_waitcnt lgkmcnt(0)
    v_pk_fma_f32 v[146:147], v[106:107], v[72:73], v[88:89]
    v_pk_fma_f32 v[148:149], v[108:109], v[74:75], v[90:91]
    v_pk_fma_f32 v[150:151], v[110:111], v[76:77], v[92:93]
    v_pk_fma_f32 v[152:153], v[112:113], v[78:79], v[94:95]
    v_pk_fma_f32 v[154:155], v[114:115], v[80:81], v[96:97]
    v_pk_fma_f32 v[156:157], v[116:117], v[82:83], v[98:99]
    v_pk_fma_f32 v[158:159], v[118:119], v[84:85], v[100:101]
    v_pk_fma_f32 v[160:161], v[120:121], v[86:87], v[102:103]
    v_pk_fma_f32 v[146:147], v[146:147], v[60:61], v[60:61] op_sel:[0,1,0] op_sel_hi:[1,1,0]
    v_pk_fma_f32 v[148:149], v[148:149], v[60:61], v[60:61] op_sel:[0,1,0] op_sel_hi:[1,1,0]
    v_pk_fma_f32 v[150:151], v[150:151], v[60:61], v[60:61] op_sel:[0,1,0] op_sel_hi:[1,1,0]
    v_pk_fma_f32 v[152:153], v[152:153], v[60:61], v[60:61] op_sel:[0,1,0] op_sel_hi:[1,1,0]
    v_pk_fma_f32 v[154:155], v[154:155], v[60:61], v[60:61] op_sel:[0,1,0] op_sel_hi:[1,1,0]
    v_pk_fma_f32 v[156:157], v[156:157], v[60:61], v[60:61] op_sel:[0,1,0] op_sel_hi:[1,1,0]
    v_pk_fma_f32 v[158:159], v[158:159], v[60:61], v[60:61] op_sel:[0,1,0] op_sel_hi:[1,1,0]
    v_pk_fma_f32 v[160:161], v[160:161], v[60:61], v[60:61] op_sel:[0,1,0] op_sel_hi:[1,1,0]
    v_pk_fma_f32 v[146:147], v[146:147], v[122:123], v[106:107]
    v_pk_fma_f32 v[148:149], v[148:149], v[124:125], v[108:109]
    v_pk_fma_f32 v[150:151], v[150:151], v[126:127], v[110:111]
    v_pk_fma_f32 v[152:153], v[152:153], v[128:129], v[112:113]
    v_pk_fma_f32 v[154:155], v[154:155], v[130:131], v[114:115]
    v_pk_fma_f32 v[156:157], v[156:157], v[132:133], v[116:117]
    v_pk_fma_f32 v[158:159], v[158:159], v[134:135], v[118:119]
    v_pk_fma_f32 v[160:161], v[160:161], v[136:137], v[120:121]
    v_cvt_pk_bf16_f32 v166, v146, v147
    v_cvt_pk_bf16_f32 v167, v148, v149
    v_cvt_pk_bf16_f32 v168, v150, v151
    v_cvt_pk_bf16_f32 v169, v152, v153
    v_cvt_pk_bf16_f32 v170, v154, v155
    v_cvt_pk_bf16_f32 v171, v156, v157
    v_cvt_pk_bf16_f32 v172, v158, v159
    v_cvt_pk_bf16_f32 v173, v160, v161
    v_permlane16_swap_b32 v166, v168
    v_permlane16_swap_b32 v167, v169
    buffer_store_dwordx4 v[166:169], v15, s[36:39], s93 offen sc1
    v_permlane16_swap_b32 v170, v172
    v_permlane16_swap_b32 v171, v173
    buffer_store_dwordx4 v[170:173], v15, s[36:39], s94 offen sc1
    v_mov_b32 v10, -2.302208198
    s_mov_b32 s16, -0.1029432397
    s_mov_b32 s17, -0.1029432397
    s_lshl_b32 s90, s56, 9
    s_mul_i32 s98, s59, 7
    s_lshl_b32 s99, s56, 1
    s_add_u32 s98, s98, s99
    s_lshl_b32 s98, s98, 14
    s_add_u32 s98, s98, 7536640
    s_add_u32 s99, s98, 16384
    s_cmp_eq_u32 s56, 3
    s_cselect_b32 s99, 1073741824, s99
    s_and_b32 s62, s56, 1
    s_lshr_b32 s60, s56, 1
    s_lshl_b32 s60, s60, 11
    s_sub_u32 s60, 286720, s60
    s_lshl_b32 s61, s62, 10
    s_add_u32 s60, s60, s61
    buffer_load_dwordx4 v[214:217], v5, s[36:39], s60 offen sc1
    s_add_u32 s60, s60, 12288
    buffer_load_dwordx4 v[218:221], v5, s[36:39], s60 offen sc1
    s_add_u32 s60, s60, 12288
    buffer_load_dwordx4 v[222:225], v5, s[36:39], s60 offen sc1
    s_add_u32 s60, s60, 12288
    buffer_load_dwordx4 v[226:229], v5, s[36:39], s60 offen sc1
    s_add_u32 s60, s60, 12288
    buffer_load_dwordx4 v[230:233], v5, s[36:39], s60 offen sc1
    s_add_u32 s60, s60, 12288
    buffer_load_dwordx4 v[234:237], v5, s[36:39], s60 offen sc1
    s_add_u32 s60, s60, 12288
    buffer_load_dwordx4 v[238:241], v5, s[36:39], s60 offen sc1
    s_add_u32 s60, s60, 12288
    buffer_load_dwordx4 v[242:245], v5, s[36:39], s60 offen sc1
    s_waitcnt vmcnt(8)
    s_waitcnt lgkmcnt(0)
    s_barrier
    s_cmp_eq_u32 s56, 0
    s_cbranch_scc0 L_a2_21
    s_and_b32 s60, s2, 7
    s_mul_i32 s60, s60, 128
    s_add_u32 s60, s60, 16384
    v_mov_b32 v2, 1
    v_mul_u32_u24 v3, 1024, v1
    s_mov_b64 exec, 0xffff
    buffer_atomic_add v2, v3, s[36:39], s60 offen sc1
    s_mov_b64 exec, -1
L_a2_21:
    s_waitcnt vmcnt(0)
    s_add_u32 s73, s98, 921600
    buffer_load_dwordx4 a[24:27], v5, s[36:39], s73 offen offset:2048 sc1
    s_add_u32 s73, s99, 921600
    buffer_load_dwordx4 a[88:91], v5, s[36:39], s73 offen offset:2048 sc1
    s_add_u32 s73, s98, 921600
    buffer_load_dwordx4 a[28:31], v5, s[36:39], s73 offen offset:3072 sc1
    s_add_u32 s73, s99, 921600
    buffer_load_dwordx4 a[92:95], v5, s[36:39], s73 offen offset:3072 sc1
    v_bfe_u32 v2, v0, 3, 4
    v_lshlrev_b32 v2, 6, v2
    v_and_b32 v3, 3, v0
    v_lshl_add_u32 v2, v3, 4, v2
    v_bfe_u32 v3, v0, 2, 1
    v_lshl_add_u32 v2, v3, 3, v2
    v_lshrrev_b32 v3, 7, v0
    v_lshl_add_u32 v2, v3, 10, v2
    v_add_u32 v2, 143360, v2
    s_cmp_lt_u32 s56, 2
    s_cselect_b32 s62, 1.0, 0
    s_mov_b32 s63, s62
    v_lshlrev_b32 v3, 4, v0
    v_add_u32 v3, 141312, v3
    v_pk_add_f32 v[214:215], v[214:215], v[230:231]
    v_pk_add_f32 v[216:217], v[216:217], v[232:233]
    v_pk_add_f32 v[218:219], v[218:219], v[234:235]
    v_pk_add_f32 v[220:221], v[220:221], v[236:237]
    v_pk_add_f32 v[222:223], v[222:223], v[238:239]
    v_pk_add_f32 v[224:225], v[224:225], v[240:241]
    v_pk_add_f32 v[226:227], v[226:227], v[242:243]
    v_pk_add_f32 v[228:229], v[228:229], v[244:245]
    v_pk_add_f32 v[214:215], v[214:215], v[222:223]
    v_pk_add_f32 v[216:217], v[216:217], v[224:225]
    v_pk_add_f32 v[218:219], v[218:219], v[226:227]
    v_pk_add_f32 v[220:221], v[220:221], v[228:229]
    v_pk_add_f32 v[214:215], v[214:215], v[218:219]
    v_pk_add_f32 v[216:217], v[216:217], v[220:221]
    v_cvt_pk_bf16_f32 v218, v214, v215
    v_cvt_pk_bf16_f32 v219, v216, v217
    v_lshlrev_b32 v214, 16, v218
    v_and_b32 v215, 0xffff0000, v218
    v_lshlrev_b32 v216, 16, v219
    v_and_b32 v217, 0xffff0000, v219
    v_pk_add_f32 v[214:215], v[214:215], s[62:63]
    v_pk_add_f32 v[216:217], v[216:217], s[62:63]
    v_cvt_pk_bf16_f32 v218, v214, v215
    v_cvt_pk_bf16_f32 v219, v216, v217
    ds_write_b64 v2, v[218:219]
    v_lshlrev_b32 v214, 16, v218
    v_and_b32 v215, 0xffff0000, v218
    v_lshlrev_b32 v216, 16, v219
    v_and_b32 v217, 0xffff0000, v219
    s_cbranch_scc0 L_cbw_22
    ds_write_b128 v3, v[214:217]
L_cbw_22:
    s_add_u32 s73, s98, 925696
    buffer_load_dwordx4 a[32:35], v5, s[36:39], s73 offen offset:0 sc1
    s_add_u32 s73, s99, 925696
    buffer_load_dwordx4 a[96:99], v5, s[36:39], s73 offen offset:0 sc1
    s_add_u32 s73, s98, 925696
    buffer_load_dwordx4 a[36:39], v5, s[36:39], s73 offen offset:1024 sc1
    s_add_u32 s73, s99, 925696
    buffer_load_dwordx4 a[100:103], v5, s[36:39], s73 offen offset:1024 sc1
    s_waitcnt lgkmcnt(0)
    s_barrier
    v_and_b32 v2, 1, v1
    v_lshlrev_b32 v11, 10, v2
    v_lshl_add_u32 v11, v7, 4, v11
    v_add_u32 v11, 143360, v11
    ds_read_b128 v[116:119], v11 offset:0
    ds_read_b128 v[120:123], v11 offset:64
    ds_read_b128 v[124:127], v11 offset:128
    ds_read_b128 v[128:131], v11 offset:192
    ds_read_b128 v[132:135], v11 offset:256
    ds_read_b128 v[136:139], v11 offset:320
    ds_read_b128 v[140:143], v11 offset:384
    ds_read_b128 v[144:147], v11 offset:448
    ds_read_b128 v[148:151], v11 offset:512
    ds_read_b128 v[152:155], v11 offset:576
    ds_read_b128 v[156:159], v11 offset:640
    ds_read_b128 v[160:163], v11 offset:704
    ds_read_b128 v[164:167], v11 offset:768
    ds_read_b128 v[168:171], v11 offset:832
    ds_read_b128 v[172:175], v11 offset:896
    ds_read_b128 v[176:179], v11 offset:960
    v_lshrrev_b32 v2, 3, v0
    v_lshlrev_b32 v2, 2, v2
    v_add_u32 v2, 141312, v2
    v_add_u32 v3, 1024, v2
    ds_read2_b32 v[92:93], v2 offset0:0 offset1:32
    ds_read2_b32 v[94:95], v2 offset0:64 offset1:96
    ds_read2_b32 v[96:97], v2 offset0:128 offset1:160
    ds_read2_b32 v[98:99], v2 offset0:192 offset1:224
    ds_read2_b32 v[100:101], v3 offset0:0 offset1:32
    ds_read2_b32 v[102:103], v3 offset0:64 offset1:96
    ds_read2_b32 v[104:105], v3 offset0:128 offset1:160
    ds_read2_b32 v[106:107], v3 offset0:192 offset1:224
    v_lshrrev_b32 v2, 3, v0
    v_and_b32 v3, 7, v0
    v_lshlrev_b32 v110, 12, v2
    v_lshl_add_u32 v110, v3, 4, v110
    v_lshlrev_b32 v111, 5, v2
    v_and_b32 v2, 1, v3
    v_lshl_add_u32 v111, v2, 4, v111
    v_lshrrev_b32 v2, 1, v3
    v_mul_u32_u24 v2, 1056, v2
    v_add_u32 v111, v111, v2
    v_add_u32 v112, 145408, v111
    s_mov_b32 s44, s20
    s_mov_b32 s45, s21
    s_mov_b32 s46, 8388608
    s_mov_b32 s47, 0x20000
    s_add_u32 s94, s56, 0
    s_and_b32 s94, s94, 3
    s_lshl_b32 s94, s94, 16
    s_lshl_b32 s72, s58, 18
    s_add_u32 s94, s94, s72
    s_lshl_b32 s72, s56, 10
    s_add_u32 s94, s94, s72
    s_add_u32 s95, s56, 1
    s_and_b32 s95, s95, 3
    s_lshl_b32 s95, s95, 16
    s_lshl_b32 s72, s58, 18
    s_add_u32 s95, s95, s72
    s_lshl_b32 s72, s56, 10
    s_add_u32 s95, s95, s72
    s_add_u32 s96, s56, 2
    s_and_b32 s96, s96, 3
    s_lshl_b32 s96, s96, 16
    s_lshl_b32 s72, s58, 18
    s_add_u32 s96, s96, s72
    s_lshl_b32 s72, s56, 10
    s_add_u32 s96, s96, s72
    s_add_u32 s97, s56, 3
    s_and_b32 s97, s97, 3
    s_lshl_b32 s97, s97, 16
    s_lshl_b32 s72, s58, 18
    s_add_u32 s97, s97, s72
    s_lshl_b32 s72, s56, 10
    s_add_u32 s97, s97, s72
    s_lshl_b32 s93, s56, 14
    s_add_u32 s93, s93, 67584
    v_lshrrev_b32 v2, 3, v1
    v_and_b32 v3, 7, v1
    v_xor_b32 v3, v3, v2
    v_lshlrev_b32 v244, 12, v2
    v_lshl_add_u32 v244, v3, 4, v244
    v_and_b32 v2, 7, v1
    v_xor_b32 v2, v2, v7
    v_lshlrev_b32 v2, 4, v2
    v_lshl_add_u32 v2, v6, 7, v2
    v_add_u32 v242, s93, v2
    v_xor_b32 v243, 64, v242
    s_lshr_b32 s91, s2, 3
    s_and_b32 s91, s91, 15
    s_mul_i32 s91, s91, 1024
    s_add_u32 s91, s91, 16384
    s_lshl_b32 s92, s57, 7
    s_add_u32 s92, s92, 32
    v_min_u32 v109, 7, v1
    v_mul_u32_u24 v109, 128, v109
    s_waitcnt lgkmcnt(0)
    s_add_u32 s73, s98, 925696
    buffer_load_dwordx4 a[40:43], v5, s[36:39], s73 offen offset:2048 sc1
    s_add_u32 s73, s99, 925696
    buffer_load_dwordx4 a[104:107], v5, s[36:39], s73 offen offset:2048 sc1
    v_mfma_f32_16x16x32_bf16 v[12:15], v[116:119], a[0:3], 0
    v_mfma_f32_16x16x32_bf16 v[16:19], v[116:119], a[64:67], 0
    s_add_u32 s73, s98, 925696
    buffer_load_dwordx4 a[44:47], v5, s[36:39], s73 offen offset:3072 sc1
    s_add_u32 s73, s99, 925696
    buffer_load_dwordx4 a[108:111], v5, s[36:39], s73 offen offset:3072 sc1
    v_mfma_f32_16x16x32_bf16 v[12:15], v[120:123], a[4:7], v[12:15]
    v_mfma_f32_16x16x32_bf16 v[16:19], v[120:123], a[68:71], v[16:19]
    s_add_u32 s73, s98, 929792
    buffer_load_dwordx4 a[48:51], v5, s[36:39], s73 offen offset:0 sc1
    s_add_u32 s73, s99, 929792
    buffer_load_dwordx4 a[112:115], v5, s[36:39], s73 offen offset:0 sc1
    v_mfma_f32_16x16x32_bf16 v[12:15], v[124:127], a[8:11], v[12:15]
    v_mfma_f32_16x16x32_bf16 v[16:19], v[124:127], a[72:75], v[16:19]
    s_add_u32 s73, s98, 929792
    buffer_load_dwordx4 a[52:55], v5, s[36:39], s73 offen offset:1024 sc1
    s_add_u32 s73, s99, 929792
    buffer_load_dwordx4 a[116:119], v5, s[36:39], s73 offen offset:1024 sc1
    v_mfma_f32_16x16x32_bf16 v[12:15], v[128:131], a[12:15], v[12:15]
    v_mfma_f32_16x16x32_bf16 v[16:19], v[128:131], a[76:79], v[16:19]
    s_add_u32 s73, s98, 929792
    buffer_load_dwordx4 a[56:59], v5, s[36:39], s73 offen offset:2048 sc1
    s_add_u32 s73, s99, 929792
    buffer_load_dwordx4 a[120:123], v5, s[36:39], s73 offen offset:2048 sc1
    v_mfma_f32_16x16x32_bf16 v[12:15], v[132:135], a[16:19], v[12:15]
    v_mfma_f32_16x16x32_bf16 v[16:19], v[132:135], a[80:83], v[16:19]
    s_add_u32 s73, s98, 929792
    buffer_load_dwordx4 a[60:63], v5, s[36:39], s73 offen offset:3072 sc1
    s_add_u32 s73, s99, 929792
    buffer_load_dwordx4 a[124:127], v5, s[36:39], s73 offen offset:3072 sc1
    v_mfma_f32_16x16x32_bf16 v[12:15], v[136:139], a[20:23], v[12:15]
    v_mfma_f32_16x16x32_bf16 v[16:19], v[136:139], a[84:87], v[16:19]
    s_waitcnt vmcnt(18)
    v_mfma_f32_16x16x32_bf16 v[12:15], v[140:143], a[24:27], v[12:15]
    v_mfma_f32_16x16x32_bf16 v[16:19], v[140:143], a[88:91], v[16:19]
    s_waitcnt vmcnt(16)
    v_mfma_f32_16x16x32_bf16 v[12:15], v[144:147], a[28:31], v[12:15]
    v_mfma_f32_16x16x32_bf16 v[16:19], v[144:147], a[92:95], v[16:19]
    s_waitcnt vmcnt(14)
    v_mfma_f32_16x16x32_bf16 v[12:15], v[148:151], a[32:35], v[12:15]
    v_mfma_f32_16x16x32_bf16 v[16:19], v[148:151], a[96:99], v[16:19]
    s_cmp_eq_u32 s56, 3
    s_cbranch_scc0 L_s2a_23
    buffer_load_dword v108, v109, s[36:39], s91 offen sc1
L_s2a_23:
    s_waitcnt vmcnt(12)
    v_mfma_f32_16x16x32_bf16 v[12:15], v[152:155], a[36:39], v[12:15]
    v_mfma_f32_16x16x32_bf16 v[16:19], v[152:155], a[100:103], v[16:19]
    s_waitcnt vmcnt(10)
    v_mfma_f32_16x16x32_bf16 v[12:15], v[156:159], a[40:43], v[12:15]
    v_mfma_f32_16x16x32_bf16 v[16:19], v[156:159], a[104:107], v[16:19]
    s_waitcnt vmcnt(8)
    v_mfma_f32_16x16x32_bf16 v[12:15], v[160:163], a[44:47], v[12:15]
    v_mfma_f32_16x16x32_bf16 v[16:19], v[160:163], a[108:111], v[16:19]
    s_waitcnt vmcnt(6)
    v_mfma_f32_16x16x32_bf16 v[12:15], v[164:167], a[48:51], v[12:15]
    v_mfma_f32_16x16x32_bf16 v[16:19], v[164:167], a[112:115], v[16:19]
    s_waitcnt vmcnt(4)
    v_mfma_f32_16x16x32_bf16 v[12:15], v[168:171], a[52:55], v[12:15]
    v_mfma_f32_16x16x32_bf16 v[16:19], v[168:171], a[116:119], v[16:19]
    s_waitcnt vmcnt(2)
    v_mfma_f32_16x16x32_bf16 v[12:15], v[172:175], a[56:59], v[12:15]
    v_mfma_f32_16x16x32_bf16 v[16:19], v[172:175], a[120:123], v[16:19]
    s_waitcnt vmcnt(0)
    v_mfma_f32_16x16x32_bf16 v[12:15], v[176:179], a[60:63], v[12:15]
    v_mfma_f32_16x16x32_bf16 v[16:19], v[176:179], a[124:127], v[16:19]
    s_cmp_eq_u32 s56, 3
    s_cbranch_scc0 L_s2_24
    s_waitcnt vmcnt(0)
    v_cmp_ne_u32 vcc, s92, v108
    s_cbranch_vccz L_s2_24
    s_mov_b32 s78, 0
    buffer_load_dword v108, v109, s[36:39], s91 offen sc1
L_qs2_25:
    s_sleep 3
    buffer_load_dword v113, v109, s[36:39], s91 offen sc1
    s_waitcnt vmcnt(1)
    v_cmp_ne_u32 vcc, s92, v108
    s_cbranch_vccz L_qds2_26
    s_sleep 3
    buffer_load_dword v108, v109, s[36:39], s91 offen sc1
    s_waitcnt vmcnt(1)
    v_cmp_ne_u32 vcc, s92, v113
    s_cbranch_vccz L_qds2_26
    s_add_u32 s78, s78, 1
    s_cmp_gt_u32 s78, 200000
    s_cbranch_scc0 L_qs2_25
L_qds2_26:
L_s2_24:
    s_lshl_b32 s60, s58, 7
    s_add_u32 s60, s60, 5373952
    s_barrier
    buffer_load_dwordx4 v[116:119], v110, s[36:39], s60 offen sc1
    s_add_u32 s60, s60, 131072
    buffer_load_dwordx4 v[120:123], v110, s[36:39], s60 offen sc1
    s_add_u32 s60, s60, 131072
    buffer_load_dwordx4 v[124:127], v110, s[36:39], s60 offen sc1
    s_add_u32 s60, s60, 131072
    buffer_load_dwordx4 v[128:131], v110, s[36:39], s60 offen sc1
    s_add_u32 s60, s60, 131072
    buffer_load_dwordx4 v[132:135], v110, s[36:39], s60 offen sc1
    s_add_u32 s60, s60, 131072
    buffer_load_dwordx4 v[136:139], v110, s[36:39], s60 offen sc1
    s_add_u32 s60, s60, 131072
    buffer_load_dwordx4 v[140:143], v110, s[36:39], s60 offen sc1
    s_add_u32 s60, s60, 131072
    buffer_load_dwordx4 v[144:147], v110, s[36:39], s60 offen sc1
    s_add_u32 s60, s60, 131072
    buffer_load_dwordx4 v[148:151], v110, s[36:39], s60 offen sc1
    s_add_u32 s60, s60, 131072
    buffer_load_dwordx4 v[152:155], v110, s[36:39], s60 offen sc1
    s_add_u32 s60, s60, 131072
    buffer_load_dwordx4 v[156:159], v110, s[36:39], s60 offen sc1
    s_add_u32 s60, s60, 131072
    buffer_load_dwordx4 v[160:163], v110, s[36:39], s60 offen sc1
    s_add_u32 s60, s60, 131072
    buffer_load_dwordx4 v[164:167], v110, s[36:39], s60 offen sc1
    s_add_u32 s60, s60, 131072
    buffer_load_dwordx4 v[168:171], v110, s[36:39], s60 offen sc1
    s_add_u32 s60, s60, 131072
    buffer_load_dwordx4 v[172:175], v110, s[36:39], s60 offen sc1
    s_add_u32 s60, s60, 131072
    buffer_load_dwordx4 v[176:179], v110, s[36:39], s60 offen sc1
    s_waitcnt vmcnt(14)
    s_cmp_eq_u32 s59, 0
    s_cbranch_scc0 L_xr_27
    ds_write_b128 v112, v[116:119]
    ds_write_b128 v112, v[120:123] offset:4224
L_xr_27:
    v_lshlrev_b32 v196, 16, v116
    v_and_b32 v197, 0xffff0000, v116
    v_lshlrev_b32 v198, 16, v117
    v_and_b32 v199, 0xffff0000, v117
    v_lshlrev_b32 v200, 16, v118
    v_and_b32 v201, 0xffff0000, v118
    v_lshlrev_b32 v202, 16, v119
    v_and_b32 v203, 0xffff0000, v119
    v_pk_mul_f32 v[188:189], v[196:197], v[196:197]
    v_pk_mul_f32 v[190:191], v[198:199], v[198:199]
    v_pk_mul_f32 v[192:193], v[200:201], v[200:201]
    v_pk_mul_f32 v[194:195], v[202:203], v[202:203]
    v_pk_add_f32 v[180:181], v[196:197], 0 op_sel_hi:[1,0]
    v_pk_add_f32 v[182:183], v[198:199], 0 op_sel_hi:[1,0]
    v_pk_add_f32 v[184:185], v[200:201], 0 op_sel_hi:[1,0]
    v_pk_add_f32 v[186:187], v[202:203], 0 op_sel_hi:[1,0]
    v_pk_mul_f32 v[196:197], v[196:197], v[92:93] op_sel:[0,0] op_sel_hi:[1,0]
    v_pk_mul_f32 v[198:199], v[198:199], v[92:93] op_sel:[0,0] op_sel_hi:[1,0]
    v_pk_mul_f32 v[200:201], v[200:201], v[92:93] op_sel:[0,0] op_sel_hi:[1,0]
    v_pk_mul_f32 v[202:203], v[202:203], v[92:93] op_sel:[0,0] op_sel_hi:[1,0]
    v_cvt_pk_bf16_f32 v204, v196, v197
    v_cvt_pk_bf16_f32 v205, v198, v199
    v_cvt_pk_bf16_f32 v206, v200, v201
    v_cvt_pk_bf16_f32 v207, v202, v203
    ds_write_b128 v111, v[204:207] offset:0
    v_lshlrev_b32 v196, 16, v120
    v_and_b32 v197, 0xffff0000, v120
    v_lshlrev_b32 v198, 16, v121
    v_and_b32 v199, 0xffff0000, v121
    v_lshlrev_b32 v200, 16, v122
    v_and_b32 v201, 0xffff0000, v122
    v_lshlrev_b32 v202, 16, v123
    v_and_b32 v203, 0xffff0000, v123
    v_pk_fma_f32 v[188:189], v[196:197], v[196:197], v[188:189]
    v_pk_fma_f32 v[190:191], v[198:199], v[198:199], v[190:191]
    v_pk_fma_f32 v[192:193], v[200:201], v[200:201], v[192:193]
    v_pk_fma_f32 v[194:195], v[202:203], v[202:203], v[194:195]
    v_pk_add_f32 v[180:181], v[180:181], v[196:197]
    v_pk_add_f32 v[182:183], v[182:183], v[198:199]
    v_pk_add_f32 v[184:185], v[184:185], v[200:201]
    v_pk_add_f32 v[186:187], v[186:187], v[202:203]
    v_pk_mul_f32 v[196:197], v[196:197], v[92:93] op_sel:[0,1] op_sel_hi:[1,1]
    v_pk_mul_f32 v[198:199], v[198:199], v[92:93] op_sel:[0,1] op_sel_hi:[1,1]
    v_pk_mul_f32 v[200:201], v[200:201], v[92:93] op_sel:[0,1] op_sel_hi:[1,1]
    v_pk_mul_f32 v[202:203], v[202:203], v[92:93] op_sel:[0,1] op_sel_hi:[1,1]
    v_cvt_pk_bf16_f32 v208, v196, v197
    v_cvt_pk_bf16_f32 v209, v198, v199
    v_cvt_pk_bf16_f32 v210, v200, v201
    v_cvt_pk_bf16_f32 v211, v202, v203
    ds_write_b128 v111, v[208:211] offset:4224
    s_waitcnt vmcnt(12)
    s_cmp_eq_u32 s59, 1
    s_cbranch_scc0 L_xr_28
    ds_write_b128 v112, v[124:127]
    ds_write_b128 v112, v[128:131] offset:4224
L_xr_28:
    v_lshlrev_b32 v196, 16, v124
    v_and_b32 v197, 0xffff0000, v124
    v_lshlrev_b32 v198, 16, v125
    v_and_b32 v199, 0xffff0000, v125
    v_lshlrev_b32 v200, 16, v126
    v_and_b32 v201, 0xffff0000, v126
    v_lshlrev_b32 v202, 16, v127
    v_and_b32 v203, 0xffff0000, v127
    s_add_u32 s101, s100, 0
    s_and_b32 s101, s101, 7
    s_lshl_b32 s101, s101, 7
    s_add_u32 s73, s94, s101
    s_add_u32 m0, s93, 0
    s_nop 0
    buffer_load_dwordx4 v244, s[44:47], s73 offen nt lds
    v_pk_fma_f32 v[188:189], v[196:197], v[196:197], v[188:189]
    v_pk_fma_f32 v[190:191], v[198:199], v[198:199], v[190:191]
    v_pk_fma_f32 v[192:193], v[200:201], v[200:201], v[192:193]
    v_pk_fma_f32 v[194:195], v[202:203], v[202:203], v[194:195]
    v_pk_add_f32 v[180:181], v[180:181], v[196:197]
    v_pk_add_f32 v[182:183], v[182:183], v[198:199]
    v_pk_add_f32 v[184:185], v[184:185], v[200:201]
    v_pk_add_f32 v[186:187], v[186:187], v[202:203]
    v_pk_mul_f32 v[196:197], v[196:197], v[94:95] op_sel:[0,0] op_sel_hi:[1,0]
    v_pk_mul_f32 v[198:199], v[198:199], v[94:95] op_sel:[0,0] op_sel_hi:[1,0]
    v_pk_mul_f32 v[200:201], v[200:201], v[94:95] op_sel:[0,0] op_sel_hi:[1,0]
    v_pk_mul_f32 v[202:203], v[202:203], v[94:95] op_sel:[0,0] op_sel_hi:[1,0]
    v_cvt_pk_bf16_f32 v204, v196, v197
    v_cvt_pk_bf16_f32 v205, v198, v199
    v_cvt_pk_bf16_f32 v206, v200, v201
    v_cvt_pk_bf16_f32 v207, v202, v203
    ds_write_b128 v111, v[204:207] offset:8448
    v_lshlrev_b32 v196, 16, v128
    v_and_b32 v197, 0xffff0000, v128
    v_lshlrev_b32 v198, 16, v129
    v_and_b32 v199, 0xffff0000, v129
    v_lshlrev_b32 v200, 16, v130
    v_and_b32 v201, 0xffff0000, v130
    v_lshlrev_b32 v202, 16, v131
    v_and_b32 v203, 0xffff0000, v131
    s_add_u32 s73, s94, s101
    s_add_u32 s73, s73, 32768
    s_add_u32 m0, s93, 1024
    s_nop 0
    buffer_load_dwordx4 v244, s[44:47], s73 offen nt lds
    v_pk_fma_f32 v[188:189], v[196:197], v[196:197], v[188:189]
    v_pk_fma_f32 v[190:191], v[198:199], v[198:199], v[190:191]
    v_pk_fma_f32 v[192:193], v[200:201], v[200:201], v[192:193]
    v_pk_fma_f32 v[194:195], v[202:203], v[202:203], v[194:195]
    v_pk_add_f32 v[180:181], v[180:181], v[196:197]
    v_pk_add_f32 v[182:183], v[182:183], v[198:199]
    v_pk_add_f32 v[184:185], v[184:185], v[200:201]
    v_pk_add_f32 v[186:187], v[186:187], v[202:203]
    v_pk_mul_f32 v[196:197], v[196:197], v[94:95] op_sel:[0,1] op_sel_hi:[1,1]
    v_pk_mul_f32 v[198:199], v[198:199], v[94:95] op_sel:[0,1] op_sel_hi:[1,1]
    v_pk_mul_f32 v[200:201], v[200:201], v[94:95] op_sel:[0,1] op_sel_hi:[1,1]
    v_pk_mul_f32 v[202:203], v[202:203], v[94:95] op_sel:[0,1] op_sel_hi:[1,1]
    v_cvt_pk_bf16_f32 v208, v196, v197
    v_cvt_pk_bf16_f32 v209, v198, v199
    v_cvt_pk_bf16_f32 v210, v200, v201
    v_cvt_pk_bf16_f32 v211, v202, v203
    ds_write_b128 v111, v[208:211] offset:12672
    s_waitcnt vmcnt(12)
    s_cmp_eq_u32 s59, 2
    s_cbranch_scc0 L_xr_29
    ds_write_b128 v112, v[132:135]
    ds_write_b128 v112, v[136:139] offset:4224
L_xr_29:
    v_lshlrev_b32 v196, 16, v132
    v_and_b32 v197, 0xffff0000, v132
    v_lshlrev_b32 v198, 16, v133
    v_and_b32 v199, 0xffff0000, v133
    v_lshlrev_b32 v200, 16, v134
    v_and_b32 v201, 0xffff0000, v134
    v_lshlrev_b32 v202, 16, v135
    v_and_b32 v203, 0xffff0000, v135
    s_add_u32 s73, s95, s101
    s_add_u32 m0, s93, 2048
    s_nop 0
    buffer_load_dwordx4 v244, s[44:47], s73 offen nt lds
    v_pk_fma_f32 v[188:189], v[196:197], v[196:197], v[188:189]
    v_pk_fma_f32 v[190:191], v[198:199], v[198:199], v[190:191]
    v_pk_fma_f32 v[192:193], v[200:201], v[200:201], v[192:193]
    v_pk_fma_f32 v[194:195], v[202:203], v[202:203], v[194:195]
    v_pk_add_f32 v[180:181], v[180:181], v[196:197]
    v_pk_add_f32 v[182:183], v[182:183], v[198:199]
    v_pk_add_f32 v[184:185], v[184:185], v[200:201]
    v_pk_add_f32 v[186:187], v[186:187], v[202:203]
    v_pk_mul_f32 v[196:197], v[196:197], v[96:97] op_sel:[0,0] op_sel_hi:[1,0]
    v_pk_mul_f32 v[198:199], v[198:199], v[96:97] op_sel:[0,0] op_sel_hi:[1,0]
    v_pk_mul_f32 v[200:201], v[200:201], v[96:97] op_sel:[0,0] op_sel_hi:[1,0]
    v_pk_mul_f32 v[202:203], v[202:203], v[96:97] op_sel:[0,0] op_sel_hi:[1,0]
    v_cvt_pk_bf16_f32 v204, v196, v197
    v_cvt_pk_bf16_f32 v205, v198, v199
    v_cvt_pk_bf16_f32 v206, v200, v201
    v_cvt_pk_bf16_f32 v207, v202, v203
    ds_write_b128 v111, v[204:207] offset:16896
    v_lshlrev_b32 v196, 16, v136
    v_and_b32 v197, 0xffff0000, v136
    v_lshlrev_b32 v198, 16, v137
    v_and_b32 v199, 0xffff0000, v137
    v_lshlrev_b32 v200, 16, v138
    v_and_b32 v201, 0xffff0000, v138
    v_lshlrev_b32 v202, 16, v139
    v_and_b32 v203, 0xffff0000, v139
    s_add_u32 s73, s95, s101
    s_add_u32 s73, s73, 32768
    s_add_u32 m0, s93, 3072
    s_nop 0
    buffer_load_dwordx4 v244, s[44:47], s73 offen nt lds
    v_pk_fma_f32 v[188:189], v[196:197], v[196:197], v[188:189]
    v_pk_fma_f32 v[190:191], v[198:199], v[198:199], v[190:191]
    v_pk_fma_f32 v[192:193], v[200:201], v[200:201], v[192:193]
    v_pk_fma_f32 v[194:195], v[202:203], v[202:203], v[194:195]
    v_pk_add_f32 v[180:181], v[180:181], v[196:197]
    v_pk_add_f32 v[182:183], v[182:183], v[198:199]
    v_pk_add_f32 v[184:185], v[184:185], v[200:201]
    v_pk_add_f32 v[186:187], v[186:187], v[202:203]
    v_pk_mul_f32 v[196:197], v[196:197], v[96:97] op_sel:[0,1] op_sel_hi:[1,1]
    v_pk_mul_f32 v[198:199], v[198:199], v[96:97] op_sel:[0,1] op_sel_hi:[1,1]
    v_pk_mul_f32 v[200:201], v[200:201], v[96:97] op_sel:[0,1] op_sel_hi:[1,1]
    v_pk_mul_f32 v[202:203], v[202:203], v[96:97] op_sel:[0,1] op_sel_hi:[1,1]
    v_cvt_pk_bf16_f32 v208, v196, v197
    v_cvt_pk_bf16_f32 v209, v198, v199
    v_cvt_pk_bf16_f32 v210, v200, v201
    v_cvt_pk_bf16_f32 v211, v202, v203
    ds_write_b128 v111, v[208:211] offset:21120
    s_waitcnt vmcnt(12)
    s_cmp_eq_u32 s59, 3
    s_cbranch_scc0 L_xr_30
    ds_write_b128 v112, v[140:143]
    ds_write_b128 v112, v[144:147] offset:4224
L_xr_30:
    v_lshlrev_b32 v196, 16, v140
    v_and_b32 v197, 0xffff0000, v140
    v_lshlrev_b32 v198, 16, v141
    v_and_b32 v199, 0xffff0000, v141
    v_lshlrev_b32 v200, 16, v142
    v_and_b32 v201, 0xffff0000, v142
    v_lshlrev_b32 v202, 16, v143
    v_and_b32 v203, 0xffff0000, v143
    s_add_u32 s73, s96, s101
    s_add_u32 m0, s93, 4096
    s_nop 0
    buffer_load_dwordx4 v244, s[44:47], s73 offen nt lds
    v_pk_fma_f32 v[188:189], v[196:197], v[196:197], v[188:189]
    v_pk_fma_f32 v[190:191], v[198:199], v[198:199], v[190:191]
    v_pk_fma_f32 v[192:193], v[200:201], v[200:201], v[192:193]
    v_pk_fma_f32 v[194:195], v[202:203], v[202:203], v[194:195]
    v_pk_add_f32 v[180:181], v[180:181], v[196:197]
    v_pk_add_f32 v[182:183], v[182:183], v[198:199]
    v_pk_add_f32 v[184:185], v[184:185], v[200:201]
    v_pk_add_f32 v[186:187], v[186:187], v[202:203]
    v_pk_mul_f32 v[196:197], v[196:197], v[98:99] op_sel:[0,0] op_sel_hi:[1,0]
    v_pk_mul_f32 v[198:199], v[198:199], v[98:99] op_sel:[0,0] op_sel_hi:[1,0]
    v_pk_mul_f32 v[200:201], v[200:201], v[98:99] op_sel:[0,0] op_sel_hi:[1,0]
    v_pk_mul_f32 v[202:203], v[202:203], v[98:99] op_sel:[0,0] op_sel_hi:[1,0]
    v_cvt_pk_bf16_f32 v204, v196, v197
    v_cvt_pk_bf16_f32 v205, v198, v199
    v_cvt_pk_bf16_f32 v206, v200, v201
    v_cvt_pk_bf16_f32 v207, v202, v203
    ds_write_b128 v111, v[204:207] offset:25344
    v_lshlrev_b32 v196, 16, v144
    v_and_b32 v197, 0xffff0000, v144
    v_lshlrev_b32 v198, 16, v145
    v_and_b32 v199, 0xffff0000, v145
    v_lshlrev_b32 v200, 16, v146
    v_and_b32 v201, 0xffff0000, v146
    v_lshlrev_b32 v202, 16, v147
    v_and_b32 v203, 0xffff0000, v147
    s_add_u32 s73, s96, s101
    s_add_u32 s73, s73, 32768
    s_add_u32 m0, s93, 5120
    s_nop 0
    buffer_load_dwordx4 v244, s[44:47], s73 offen nt lds
    v_pk_fma_f32 v[188:189], v[196:197], v[196:197], v[188:189]
    v_pk_fma_f32 v[190:191], v[198:199], v[198:199], v[190:191]
    v_pk_fma_f32 v[192:193], v[200:201], v[200:201], v[192:193]
    v_pk_fma_f32 v[194:195], v[202:203], v[202:203], v[194:195]
    v_pk_add_f32 v[180:181], v[180:181], v[196:197]
    v_pk_add_f32 v[182:183], v[182:183], v[198:199]
    v_pk_add_f32 v[184:185], v[184:185], v[200:201]
    v_pk_add_f32 v[186:187], v[186:187], v[202:203]
    v_pk_mul_f32 v[196:197], v[196:197], v[98:99] op_sel:[0,1] op_sel_hi:[1,1]
    v_pk_mul_f32 v[198:199], v[198:199], v[98:99] op_sel:[0,1] op_sel_hi:[1,1]
    v_pk_mul_f32 v[200:201], v[200:201], v[98:99] op_sel:[0,1] op_sel_hi:[1,1]
    v_pk_mul_f32 v[202:203], v[202:203], v[98:99] op_sel:[0,1] op_sel_hi:[1,1]
    v_cvt_pk_bf16_f32 v208, v196, v197
    v_cvt_pk_bf16_f32 v209, v198, v199
    v_cvt_pk_bf16_f32 v210, v200, v201
    v_cvt_pk_bf16_f32 v211, v202, v203
    ds_write_b128 v111, v[208:211] offset:29568
    s_waitcnt vmcnt(12)
    s_cmp_eq_u32 s59, 4
    s_cbranch_scc0 L_xr_31
    ds_write_b128 v112, v[148:151]
    ds_write_b128 v112, v[152:155] offset:4224
L_xr_31:
    v_lshlrev_b32 v196, 16, v148
    v_and_b32 v197, 0xffff0000, v148
    v_lshlrev_b32 v198, 16, v149
    v_and_b32 v199, 0xffff0000, v149
    v_lshlrev_b32 v200, 16, v150
    v_and_b32 v201, 0xffff0000, v150
    v_lshlrev_b32 v202, 16, v151
    v_and_b32 v203, 0xffff0000, v151
    s_add_u32 s73, s97, s101
    s_add_u32 m0, s93, 6144
    s_nop 0
    buffer_load_dwordx4 v244, s[44:47], s73 offen nt lds
    v_pk_fma_f32 v[188:189], v[196:197], v[196:197], v[188:189]
    v_pk_fma_f32 v[190:191], v[198:199], v[198:199], v[190:191]
    v_pk_fma_f32 v[192:193], v[200:201], v[200:201], v[192:193]
    v_pk_fma_f32 v[194:195], v[202:203], v[202:203], v[194:195]
    v_pk_add_f32 v[180:181], v[180:181], v[196:197]
    v_pk_add_f32 v[182:183], v[182:183], v[198:199]
    v_pk_add_f32 v[184:185], v[184:185], v[200:201]
    v_pk_add_f32 v[186:187], v[186:187], v[202:203]
    v_pk_mul_f32 v[196:197], v[196:197], v[100:101] op_sel:[0,0] op_sel_hi:[1,0]
    v_pk_mul_f32 v[198:199], v[198:199], v[100:101] op_sel:[0,0] op_sel_hi:[1,0]
    v_pk_mul_f32 v[200:201], v[200:201], v[100:101] op_sel:[0,0] op_sel_hi:[1,0]
    v_pk_mul_f32 v[202:203], v[202:203], v[100:101] op_sel:[0,0] op_sel_hi:[1,0]
    v_cvt_pk_bf16_f32 v204, v196, v197
    v_cvt_pk_bf16_f32 v205, v198, v199
    v_cvt_pk_bf16_f32 v206, v200, v201
    v_cvt_pk_bf16_f32 v207, v202, v203
    ds_write_b128 v111, v[204:207] offset:33792
    v_lshlrev_b32 v196, 16, v152
    v_and_b32 v197, 0xffff0000, v152
    v_lshlrev_b32 v198, 16, v153
    v_and_b32 v199, 0xffff0000, v153
    v_lshlrev_b32 v200, 16, v154
    v_and_b32 v201, 0xffff0000, v154
    v_lshlrev_b32 v202, 16, v155
    v_and_b32 v203, 0xffff0000, v155
    s_cmp_eq_u32 s56, 3
    s_cbranch_scc0 L_pf_32
    s_mov_b32 s44, s20
    s_mov_b32 s45, s21
    s_mov_b32 s46, 8388608
    s_mov_b32 s47, 0x20000
    v_lshlrev_b32 v212, 12, v7
    v_bfe_u32 v213, v1, 2, 2
    v_lshl_add_u32 v212, v213, 10, v212
    v_and_b32 v213, 3, v1
    v_lshl_add_u32 v212, v213, 7, v212
    s_lshl_b32 s64, s58, 18
    s_lshl_b32 s65, s59, 15
    s_add_u32 s64, s64, s65
    s_add_u32 s64, s64, 0
    buffer_load_dword v213, v212, s[44:47], s64 offen offset:512
L_pf_32:
    s_add_u32 s73, s97, s101
    s_add_u32 s73, s73, 32768
    s_add_u32 m0, s93, 7168
    s_nop 0
    buffer_load_dwordx4 v244, s[44:47], s73 offen nt lds
    v_pk_fma_f32 v[188:189], v[196:197], v[196:197], v[188:189]
    v_pk_fma_f32 v[190:191], v[198:199], v[198:199], v[190:191]
    v_pk_fma_f32 v[192:193], v[200:201], v[200:201], v[192:193]
    v_pk_fma_f32 v[194:195], v[202:203], v[202:203], v[194:195]
    v_pk_add_f32 v[180:181], v[180:181], v[196:197]
    v_pk_add_f32 v[182:183], v[182:183], v[198:199]
    v_pk_add_f32 v[184:185], v[184:185], v[200:201]
    v_pk_add_f32 v[186:187], v[186:187], v[202:203]
    v_pk_mul_f32 v[196:197], v[196:197], v[100:101] op_sel:[0,1] op_sel_hi:[1,1]
    v_pk_mul_f32 v[198:199], v[198:199], v[100:101] op_sel:[0,1] op_sel_hi:[1,1]
    v_pk_mul_f32 v[200:201], v[200:201], v[100:101] op_sel:[0,1] op_sel_hi:[1,1]
    v_pk_mul_f32 v[202:203], v[202:203], v[100:101] op_sel:[0,1] op_sel_hi:[1,1]
    v_cvt_pk_bf16_f32 v208, v196, v197
    v_cvt_pk_bf16_f32 v209, v198, v199
    v_cvt_pk_bf16_f32 v210, v200, v201
    v_cvt_pk_bf16_f32 v211, v202, v203
    ds_write_b128 v111, v[208:211] offset:38016
    s_waitcnt vmcnt(12)
    s_cmp_eq_u32 s59, 5
    s_cbranch_scc0 L_xr_33
    ds_write_b128 v112, v[156:159]
    ds_write_b128 v112, v[160:163] offset:4224
L_xr_33:
    v_lshlrev_b32 v196, 16, v156
    v_and_b32 v197, 0xffff0000, v156
    v_lshlrev_b32 v198, 16, v157
    v_and_b32 v199, 0xffff0000, v157
    v_lshlrev_b32 v200, 16, v158
    v_and_b32 v201, 0xffff0000, v158
    v_lshlrev_b32 v202, 16, v159
    v_and_b32 v203, 0xffff0000, v159
    s_add_u32 s101, s100, 1
    s_and_b32 s101, s101, 7
    s_lshl_b32 s101, s101, 7
    s_add_u32 s73, s94, s101
    s_add_u32 m0, s93, 8192
    s_nop 0
    buffer_load_dwordx4 v244, s[44:47], s73 offen nt lds
    v_pk_fma_f32 v[188:189], v[196:197], v[196:197], v[188:189]
    v_pk_fma_f32 v[190:191], v[198:199], v[198:199], v[190:191]
    v_pk_fma_f32 v[192:193], v[200:201], v[200:201], v[192:193]
    v_pk_fma_f32 v[194:195], v[202:203], v[202:203], v[194:195]
    v_pk_add_f32 v[180:181], v[180:181], v[196:197]
    v_pk_add_f32 v[182:183], v[182:183], v[198:199]
    v_pk_add_f32 v[184:185], v[184:185], v[200:201]
    v_pk_add_f32 v[186:187], v[186:187], v[202:203]
    v_pk_mul_f32 v[196:197], v[196:197], v[102:103] op_sel:[0,0] op_sel_hi:[1,0]
    v_pk_mul_f32 v[198:199], v[198:199], v[102:103] op_sel:[0,0] op_sel_hi:[1,0]
    v_pk_mul_f32 v[200:201], v[200:201], v[102:103] op_sel:[0,0] op_sel_hi:[1,0]
    v_pk_mul_f32 v[202:203], v[202:203], v[102:103] op_sel:[0,0] op_sel_hi:[1,0]
    v_cvt_pk_bf16_f32 v204, v196, v197
    v_cvt_pk_bf16_f32 v205, v198, v199
    v_cvt_pk_bf16_f32 v206, v200, v201
    v_cvt_pk_bf16_f32 v207, v202, v203
    ds_write_b128 v111, v[204:207] offset:42240
    v_lshlrev_b32 v196, 16, v160
    v_and_b32 v197, 0xffff0000, v160
    v_lshlrev_b32 v198, 16, v161
    v_and_b32 v199, 0xffff0000, v161
    v_lshlrev_b32 v200, 16, v162
    v_and_b32 v201, 0xffff0000, v162
    v_lshlrev_b32 v202, 16, v163
    v_and_b32 v203, 0xffff0000, v163
    s_add_u32 s73, s94, s101
    s_add_u32 s73, s73, 32768
    s_add_u32 m0, s93, 9216
    s_nop 0
    buffer_load_dwordx4 v244, s[44:47], s73 offen nt lds
    v_pk_fma_f32 v[188:189], v[196:197], v[196:197], v[188:189]
    v_pk_fma_f32 v[190:191], v[198:199], v[198:199], v[190:191]
    v_pk_fma_f32 v[192:193], v[200:201], v[200:201], v[192:193]
    v_pk_fma_f32 v[194:195], v[202:203], v[202:203], v[194:195]
    v_pk_add_f32 v[180:181], v[180:181], v[196:197]
    v_pk_add_f32 v[182:183], v[182:183], v[198:199]
    v_pk_add_f32 v[184:185], v[184:185], v[200:201]
    v_pk_add_f32 v[186:187], v[186:187], v[202:203]
    v_pk_mul_f32 v[196:197], v[196:197], v[102:103] op_sel:[0,1] op_sel_hi:[1,1]
    v_pk_mul_f32 v[198:199], v[198:199], v[102:103] op_sel:[0,1] op_sel_hi:[1,1]
    v_pk_mul_f32 v[200:201], v[200:201], v[102:103] op_sel:[0,1] op_sel_hi:[1,1]
    v_pk_mul_f32 v[202:203], v[202:203], v[102:103] op_sel:[0,1] op_sel_hi:[1,1]
    v_cvt_pk_bf16_f32 v208, v196, v197
    v_cvt_pk_bf16_f32 v209, v198, v199
    v_cvt_pk_bf16_f32 v210, v200, v201
    v_cvt_pk_bf16_f32 v211, v202, v203
    ds_write_b128 v111, v[208:211] offset:46464
    s_waitcnt vmcnt(12)
    s_cmp_eq_u32 s59, 6
    s_cbranch_scc0 L_xr_34
    ds_write_b128 v112, v[164:167]
    ds_write_b128 v112, v[168:171] offset:4224
L_xr_34:
    v_lshlrev_b32 v196, 16, v164
    v_and_b32 v197, 0xffff0000, v164
    v_lshlrev_b32 v198, 16, v165
    v_and_b32 v199, 0xffff0000, v165
    v_lshlrev_b32 v200, 16, v166
    v_and_b32 v201, 0xffff0000, v166
    v_lshlrev_b32 v202, 16, v167
    v_and_b32 v203, 0xffff0000, v167
    s_add_u32 s73, s95, s101
    s_add_u32 m0, s93, 10240
    s_nop 0
    buffer_load_dwordx4 v244, s[44:47], s73 offen nt lds
    v_pk_fma_f32 v[188:189], v[196:197], v[196:197], v[188:189]
    v_pk_fma_f32 v[190:191], v[198:199], v[198:199], v[190:191]
    v_pk_fma_f32 v[192:193], v[200:201], v[200:201], v[192:193]
    v_pk_fma_f32 v[194:195], v[202:203], v[202:203], v[194:195]
    v_pk_add_f32 v[180:181], v[180:181], v[196:197]
    v_pk_add_f32 v[182:183], v[182:183], v[198:199]
    v_pk_add_f32 v[184:185], v[184:185], v[200:201]
    v_pk_add_f32 v[186:187], v[186:187], v[202:203]
    v_pk_mul_f32 v[196:197], v[196:197], v[104:105] op_sel:[0,0] op_sel_hi:[1,0]
    v_pk_mul_f32 v[198:199], v[198:199], v[104:105] op_sel:[0,0] op_sel_hi:[1,0]
    v_pk_mul_f32 v[200:201], v[200:201], v[104:105] op_sel:[0,0] op_sel_hi:[1,0]
    v_pk_mul_f32 v[202:203], v[202:203], v[104:105] op_sel:[0,0] op_sel_hi:[1,0]
    v_cvt_pk_bf16_f32 v204, v196, v197
    v_cvt_pk_bf16_f32 v205, v198, v199
    v_cvt_pk_bf16_f32 v206, v200, v201
    v_cvt_pk_bf16_f32 v207, v202, v203
    ds_write_b128 v111, v[204:207] offset:50688
    v_lshlrev_b32 v196, 16, v168
    v_and_b32 v197, 0xffff0000, v168
    v_lshlrev_b32 v198, 16, v169
    v_and_b32 v199, 0xffff0000, v169
    v_lshlrev_b32 v200, 16, v170
    v_and_b32 v201, 0xffff0000, v170
    v_lshlrev_b32 v202, 16, v171
    v_and_b32 v203, 0xffff0000, v171
    s_add_u32 s73, s95, s101
    s_add_u32 s73, s73, 32768
    s_add_u32 m0, s93, 11264
    s_nop 0
    buffer_load_dwordx4 v244, s[44:47], s73 offen nt lds
    v_pk_fma_f32 v[188:189], v[196:197], v[196:197], v[188:189]
    v_pk_fma_f32 v[190:191], v[198:199], v[198:199], v[190:191]
    v_pk_fma_f32 v[192:193], v[200:201], v[200:201], v[192:193]
    v_pk_fma_f32 v[194:195], v[202:203], v[202:203], v[194:195]
    v_pk_add_f32 v[180:181], v[180:181], v[196:197]
    v_pk_add_f32 v[182:183], v[182:183], v[198:199]
    v_pk_add_f32 v[184:185], v[184:185], v[200:201]
    v_pk_add_f32 v[186:187], v[186:187], v[202:203]
    v_pk_mul_f32 v[196:197], v[196:197], v[104:105] op_sel:[0,1] op_sel_hi:[1,1]
    v_pk_mul_f32 v[198:199], v[198:199], v[104:105] op_sel:[0,1] op_sel_hi:[1,1]
    v_pk_mul_f32 v[200:201], v[200:201], v[104:105] op_sel:[0,1] op_sel_hi:[1,1]
    v_pk_mul_f32 v[202:203], v[202:203], v[104:105] op_sel:[0,1] op_sel_hi:[1,1]
    v_cvt_pk_bf16_f32 v208, v196, v197
    v_cvt_pk_bf16_f32 v209, v198, v199
    v_cvt_pk_bf16_f32 v210, v200, v201
    v_cvt_pk_bf16_f32 v211, v202, v203
    ds_write_b128 v111, v[208:211] offset:54912
    s_waitcnt vmcnt(12)
    s_cmp_eq_u32 s59, 7
    s_cbranch_scc0 L_xr_35
    ds_write_b128 v112, v[172:175]
    ds_write_b128 v112, v[176:179] offset:4224
L_xr_35:
    v_lshlrev_b32 v196, 16, v172
    v_and_b32 v197, 0xffff0000, v172
    v_lshlrev_b32 v198, 16, v173
    v_and_b32 v199, 0xffff0000, v173
    v_lshlrev_b32 v200, 16, v174
    v_and_b32 v201, 0xffff0000, v174
    v_lshlrev_b32 v202, 16, v175
    v_and_b32 v203, 0xffff0000, v175
    s_add_u32 s73, s96, s101
    s_add_u32 m0, s93, 12288
    s_nop 0
    buffer_load_dwordx4 v244, s[44:47], s73 offen nt lds
    v_pk_fma_f32 v[188:189], v[196:197], v[196:197], v[188:189]
    v_pk_fma_f32 v[190:191], v[198:199], v[198:199], v[190:191]
    v_pk_fma_f32 v[192:193], v[200:201], v[200:201], v[192:193]
    v_pk_fma_f32 v[194:195], v[202:203], v[202:203], v[194:195]
    v_pk_add_f32 v[180:181], v[180:181], v[196:197]
    v_pk_add_f32 v[182:183], v[182:183], v[198:199]
    v_pk_add_f32 v[184:185], v[184:185], v[200:201]
    v_pk_add_f32 v[186:187], v[186:187], v[202:203]
    v_pk_mul_f32 v[196:197], v[196:197], v[106:107] op_sel:[0,0] op_sel_hi:[1,0]
    v_pk_mul_f32 v[198:199], v[198:199], v[106:107] op_sel:[0,0] op_sel_hi:[1,0]
    v_pk_mul_f32 v[200:201], v[200:201], v[106:107] op_sel:[0,0] op_sel_hi:[1,0]
    v_pk_mul_f32 v[202:203], v[202:203], v[106:107] op_sel:[0,0] op_sel_hi:[1,0]
    v_cvt_pk_bf16_f32 v204, v196, v197
    v_cvt_pk_bf16_f32 v205, v198, v199
    v_cvt_pk_bf16_f32 v206, v200, v201
    v_cvt_pk_bf16_f32 v207, v202, v203
    ds_write_b128 v111, v[204:207] offset:59136
    v_lshlrev_b32 v196, 16, v176
    v_and_b32 v197, 0xffff0000, v176
    v_lshlrev_b32 v198, 16, v177
    v_and_b32 v199, 0xffff0000, v177
    v_lshlrev_b32 v200, 16, v178
    v_and_b32 v201, 0xffff0000, v178
    v_lshlrev_b32 v202, 16, v179
    v_and_b32 v203, 0xffff0000, v179
    s_cmp_eq_u32 s56, 0
    s_cbranch_scc0 L_pf_36
    s_mov_b32 s44, s20
    s_mov_b32 s45, s21
    s_mov_b32 s46, 8388608
    s_mov_b32 s47, 0x20000
    v_lshlrev_b32 v212, 12, v7
    v_bfe_u32 v213, v1, 2, 2
    v_lshl_add_u32 v212, v213, 10, v212
    v_and_b32 v213, 3, v1
    v_lshl_add_u32 v212, v213, 7, v212
    s_lshl_b32 s64, s58, 18
    s_lshl_b32 s65, s59, 15
    s_add_u32 s64, s64, s65
    s_add_u32 s64, s64, 16384
    buffer_load_dword v213, v212, s[44:47], s64 offen offset:512
L_pf_36:
    s_add_u32 s73, s96, s101
    s_add_u32 s73, s73, 32768
    s_add_u32 m0, s93, 13312
    s_nop 0
    buffer_load_dwordx4 v244, s[44:47], s73 offen nt lds
    v_pk_fma_f32 v[188:189], v[196:197], v[196:197], v[188:189]
    v_pk_fma_f32 v[190:191], v[198:199], v[198:199], v[190:191]
    v_pk_fma_f32 v[192:193], v[200:201], v[200:201], v[192:193]
    v_pk_fma_f32 v[194:195], v[202:203], v[202:203], v[194:195]
    v_pk_add_f32 v[180:181], v[180:181], v[196:197]
    v_pk_add_f32 v[182:183], v[182:183], v[198:199]
    v_pk_add_f32 v[184:185], v[184:185], v[200:201]
    v_pk_add_f32 v[186:187], v[186:187], v[202:203]
    v_pk_mul_f32 v[196:197], v[196:197], v[106:107] op_sel:[0,1] op_sel_hi:[1,1]
    v_pk_mul_f32 v[198:199], v[198:199], v[106:107] op_sel:[0,1] op_sel_hi:[1,1]
    v_pk_mul_f32 v[200:201], v[200:201], v[106:107] op_sel:[0,1] op_sel_hi:[1,1]
    v_pk_mul_f32 v[202:203], v[202:203], v[106:107] op_sel:[0,1] op_sel_hi:[1,1]
    v_cvt_pk_bf16_f32 v208, v196, v197
    v_cvt_pk_bf16_f32 v209, v198, v199
    v_cvt_pk_bf16_f32 v210, v200, v201
    v_cvt_pk_bf16_f32 v211, v202, v203
    ds_write_b128 v111, v[208:211] offset:63360
    v_add_f32_dpp v180, v180, v180 row_ror:8 row_mask:0xf bank_mask:0xf
    v_add_f32_dpp v181, v181, v181 row_ror:8 row_mask:0xf bank_mask:0xf
    v_add_f32_dpp v182, v182, v182 row_ror:8 row_mask:0xf bank_mask:0xf
    v_add_f32_dpp v183, v183, v183 row_ror:8 row_mask:0xf bank_mask:0xf
    v_add_f32_dpp v184, v184, v184 row_ror:8 row_mask:0xf bank_mask:0xf
    v_add_f32_dpp v185, v185, v185 row_ror:8 row_mask:0xf bank_mask:0xf
    v_add_f32_dpp v186, v186, v186 row_ror:8 row_mask:0xf bank_mask:0xf
    v_add_f32_dpp v187, v187, v187 row_ror:8 row_mask:0xf bank_mask:0xf
    v_add_f32_dpp v188, v188, v188 row_ror:8 row_mask:0xf bank_mask:0xf
    v_add_f32_dpp v189, v189, v189 row_ror:8 row_mask:0xf bank_mask:0xf
    v_add_f32_dpp v190, v190, v190 row_ror:8 row_mask:0xf bank_mask:0xf
    v_add_f32_dpp v191, v191, v191 row_ror:8 row_mask:0xf bank_mask:0xf
    v_add_f32_dpp v192, v192, v192 row_ror:8 row_mask:0xf bank_mask:0xf
    v_add_f32_dpp v193, v193, v193 row_ror:8 row_mask:0xf bank_mask:0xf
    v_add_f32_dpp v194, v194, v194 row_ror:8 row_mask:0xf bank_mask:0xf
    v_add_f32_dpp v195, v195, v195 row_ror:8 row_mask:0xf bank_mask:0xf
    v_permlane16_swap_b32 v180, v188
    v_permlane16_swap_b32 v181, v189
    v_permlane16_swap_b32 v182, v190
    v_permlane16_swap_b32 v183, v191
    v_permlane16_swap_b32 v184, v192
    v_permlane16_swap_b32 v185, v193
    v_permlane16_swap_b32 v186, v194
    v_permlane16_swap_b32 v187, v195
    v_add_f32 v180, v180, v188
    v_add_f32 v181, v181, v189
    v_add_f32 v182, v182, v190
    v_add_f32 v183, v183, v191
    v_add_f32 v184, v184, v192
    v_add_f32 v185, v185, v193
    v_add_f32 v186, v186, v194
    v_add_f32 v187, v187, v195
    v_permlane32_swap_b32 v180, v184
    v_permlane32_swap_b32 v181, v185
    v_permlane32_swap_b32 v182, v186
    v_permlane32_swap_b32 v183, v187
    v_add_f32 v180, v180, v184
    v_add_f32 v181, v181, v185
    v_add_f32 v182, v182, v186
    v_add_f32 v183, v183, v187
    v_and_b32 v2, 1, v7
    v_lshlrev_b32 v2, 8, v2
    v_and_b32 v3, 7, v1
    v_lshl_add_u32 v2, v3, 5, v2
    v_lshrrev_b32 v3, 1, v7
    v_lshl_add_u32 v2, v3, 4, v2
    s_add_u32 s60, s90, 133120
    v_add_u32 v2, s60, v2
    ds_write_b128 v2, v[180:183]
    s_waitcnt lgkmcnt(0)
    s_barrier
    v_add_u32 v148, 33792, v8
    ds_read_b64_tr_b16 v[100:101], v8 offset:0
    ds_read_b64_tr_b16 v[102:103], v8 offset:512
    ds_read_b64_tr_b16 v[104:105], v8 offset:1056
    ds_read_b64_tr_b16 v[106:107], v8 offset:1568
    ds_read_b64_tr_b16 v[108:109], v8 offset:2112
    ds_read_b64_tr_b16 v[110:111], v8 offset:2624
    ds_read_b64_tr_b16 v[112:113], v8 offset:3168
    ds_read_b64_tr_b16 v[114:115], v8 offset:3680
    v_add_u32 v2, 133120, v9
    ds_read2st64_b32 v[92:93], v2 offset0:0 offset1:1
    ds_read2st64_b32 v[94:95], v2 offset0:2 offset1:3
    ds_read2st64_b32 v[96:97], v2 offset0:4 offset1:5
    ds_read2st64_b32 v[98:99], v2 offset0:6 offset1:7
    s_add_u32 s60, s90, 135168
    v_add_u32 v149, s60, v9
    v_lshlrev_b32 v150, 4, v7
    v_add_u32 v150, s60, v150
    ds_read_b64_tr_b16 v[116:117], v8 offset:4224
    ds_read_b64_tr_b16 v[118:119], v8 offset:4736
    ds_read_b64_tr_b16 v[120:121], v8 offset:5280
    ds_read_b64_tr_b16 v[122:123], v8 offset:5792
    s_waitcnt lgkmcnt(14)
    v_mfma_f32_16x16x32_bf16 v[28:31], v[100:103], a[0:3], 0
    ds_read_b64_tr_b16 v[124:125], v8 offset:6336
    v_mfma_f32_16x16x32_bf16 v[44:47], v[100:103], a[64:67], 0
    ds_read_b64_tr_b16 v[126:127], v8 offset:6848
    s_waitcnt lgkmcnt(14)
    v_mfma_f32_16x16x32_bf16 v[32:35], v[104:107], a[0:3], 0
    ds_read_b64_tr_b16 v[128:129], v8 offset:7392
    s_add_u32 s73, s97, s101
    s_add_u32 m0, s93, 14336
    s_nop 0
    buffer_load_dwordx4 v244, s[44:47], s73 offen nt lds
    v_mfma_f32_16x16x32_bf16 v[48:51], v[104:107], a[64:67], 0
    ds_read_b64_tr_b16 v[130:131], v8 offset:7904
    s_waitcnt lgkmcnt(14)
    v_mfma_f32_16x16x32_bf16 v[36:39], v[108:111], a[0:3], 0
    ds_read_b64_tr_b16 v[132:133], v8 offset:8448
    v_mfma_f32_16x16x32_bf16 v[52:55], v[108:111], a[64:67], 0
    ds_read_b64_tr_b16 v[134:135], v8 offset:8960
    s_add_u32 s73, s97, s101
    s_add_u32 s73, s73, 32768
    s_add_u32 m0, s93, 15360
    s_nop 0
    buffer_load_dwordx4 v244, s[44:47], s73 offen nt lds
    s_waitcnt lgkmcnt(14)
    v_mfma_f32_16x16x32_bf16 v[40:43], v[112:115], a[0:3], 0
    ds_read_b64_tr_b16 v[136:137], v8 offset:9504
    v_mfma_f32_16x16x32_bf16 v[56:59], v[112:115], a[64:67], 0
    ds_read_b64_tr_b16 v[138:139], v8 offset:10016
    s_waitcnt lgkmcnt(12)
    v_pk_add_f32 v[92:93], v[92:93], v[94:95]
    v_pk_add_f32 v[96:97], v[96:97], v[98:99]
    v_pk_add_f32 v[92:93], v[92:93], v[96:97]
    v_mul_f32 v92, -0.001953125, v92
    v_mul_f32 v93, 0.001953125, v93
    v_fma_f32 v93, -v92, v92, v93
    v_max_f32 v93, 0, v93
    v_add_f32 v93, 1e-5, v93
    v_rsq_f32 v94, v93
    s_nop 0
    v_mul_f32 v95, v92, v94
    ds_write2st64_b32 v149, v94, v95 offset0:0 offset1:1
    s_mul_i32 s60, s56, 1056
    s_add_u32 s60, s60, 145408
    v_add_u32 v3, s60, v8
    ds_read_b64_tr_b16 v[246:247], v3 offset:0
    ds_read_b64_tr_b16 v[248:249], v3 offset:512
    ds_read_b64_tr_b16 v[250:251], v3 offset:4224
    ds_read_b64_tr_b16 v[252:253], v3 offset:4736
    s_waitcnt lgkmcnt(15)
    v_mfma_f32_16x16x32_bf16 v[28:31], v[116:119], a[4:7], v[28:31]
    ds_read_b64_tr_b16 v[140:141], v8 offset:10560
    s_add_u32 s73, s98, 0
    buffer_load_dwordx4 a[128:131], v5, s[36:39], s73 offen offset:0 sc1
    v_mfma_f32_16x16x32_bf16 v[44:47], v[116:119], a[68:71], v[44:47]
    ds_read_b64_tr_b16 v[142:143], v8 offset:11072
    s_waitcnt lgkmcnt(15)
    v_mfma_f32_16x16x32_bf16 v[32:35], v[120:123], a[4:7], v[32:35]
    ds_read_b64_tr_b16 v[144:145], v8 offset:11616
    v_mfma_f32_16x16x32_bf16 v[48:51], v[120:123], a[68:71], v[48:51]
    ds_read_b64_tr_b16 v[146:147], v8 offset:12128
    s_add_u32 s73, s99, 0
    buffer_load_dwordx4 a[192:195], v5, s[36:39], s73 offen offset:0 sc1
    s_waitcnt lgkmcnt(15)
    v_mfma_f32_16x16x32_bf16 v[36:39], v[124:127], a[4:7], v[36:39]
    ds_read_b64_tr_b16 v[100:101], v8 offset:12672
    v_mfma_f32_16x16x32_bf16 v[52:55], v[124:127], a[68:71], v[52:55]
    ds_read_b64_tr_b16 v[102:103], v8 offset:13184
    s_waitcnt lgkmcnt(15)
    v_mfma_f32_16x16x32_bf16 v[40:43], v[128:131], a[4:7], v[40:43]
    ds_read_b64_tr_b16 v[104:105], v8 offset:13728
    s_add_u32 s73, s98, 0
    buffer_load_dwordx4 a[132:135], v5, s[36:39], s73 offen offset:1024 sc1
    v_mfma_f32_16x16x32_bf16 v[56:59], v[128:131], a[68:71], v[56:59]
    ds_read_b64_tr_b16 v[106:107], v8 offset:14240
    s_waitcnt lgkmcnt(15)
    v_mfma_f32_16x16x32_bf16 v[28:31], v[132:135], a[8:11], v[28:31]
    ds_read_b64_tr_b16 v[108:109], v8 offset:14784
    v_mfma_f32_16x16x32_bf16 v[44:47], v[132:135], a[72:75], v[44:47]
    ds_read_b64_tr_b16 v[110:111], v8 offset:15296
    s_add_u32 s73, s99, 0
    buffer_load_dwordx4 a[196:199], v5, s[36:39], s73 offen offset:1024 sc1
    s_waitcnt lgkmcnt(15)
    v_mfma_f32_16x16x32_bf16 v[32:35], v[136:139], a[8:11], v[32:35]
    ds_read_b64_tr_b16 v[112:113], v8 offset:15840
    v_mfma_f32_16x16x32_bf16 v[48:51], v[136:139], a[72:75], v[48:51]
    ds_read_b64_tr_b16 v[114:115], v8 offset:16352
    s_waitcnt lgkmcnt(10)
    v_mfma_f32_16x16x32_bf16 v[36:39], v[140:143], a[8:11], v[36:39]
    ds_read_b64_tr_b16 v[116:117], v8 offset:16896
    s_add_u32 s73, s98, 0
    buffer_load_dwordx4 a[136:139], v5, s[36:39], s73 offen offset:2048 sc1
    v_mfma_f32_16x16x32_bf16 v[52:55], v[140:143], a[72:75], v[52:55]
    ds_read_b64_tr_b16 v[118:119], v8 offset:17408
    s_waitcnt lgkmcnt(10)
    v_mfma_f32_16x16x32_bf16 v[40:43], v[144:147], a[8:11], v[40:43]
    ds_read_b64_tr_b16 v[120:121], v8 offset:17952
    v_mfma_f32_16x16x32_bf16 v[56:59], v[144:147], a[72:75], v[56:59]
    ds_read_b64_tr_b16 v[122:123], v8 offset:18464
    s_add_u32 s73, s99, 0
    buffer_load_dwordx4 a[200:203], v5, s[36:39], s73 offen offset:2048 sc1
    s_waitcnt lgkmcnt(10)
    v_mfma_f32_16x16x32_bf16 v[28:31], v[100:103], a[12:15], v[28:31]
    ds_read_b64_tr_b16 v[124:125], v8 offset:19008
    v_mfma_f32_16x16x32_bf16 v[44:47], v[100:103], a[76:79], v[44:47]
    ds_read_b64_tr_b16 v[126:127], v8 offset:19520
    s_waitcnt lgkmcnt(10)
    v_mfma_f32_16x16x32_bf16 v[32:35], v[104:107], a[12:15], v[32:35]
    ds_read_b64_tr_b16 v[128:129], v8 offset:20064
    s_add_u32 s73, s98, 0
    buffer_load_dwordx4 a[140:143], v5, s[36:39], s73 offen offset:3072 sc1
    v_mfma_f32_16x16x32_bf16 v[48:51], v[104:107], a[76:79], v[48:51]
    ds_read_b64_tr_b16 v[130:131], v8 offset:20576
    s_waitcnt lgkmcnt(10)
    v_mfma_f32_16x16x32_bf16 v[36:39], v[108:111], a[12:15], v[36:39]
    ds_read_b64_tr_b16 v[132:133], v8 offset:21120
    v_mfma_f32_16x16x32_bf16 v[52:55], v[108:111], a[76:79], v[52:55]
    ds_read_b64_tr_b16 v[134:135], v8 offset:21632
    s_add_u32 s73, s99, 0
    buffer_load_dwordx4 a[204:207], v5, s[36:39], s73 offen offset:3072 sc1
    s_waitcnt lgkmcnt(10)
    v_mfma_f32_16x16x32_bf16 v[40:43], v[112:115], a[12:15], v[40:43]
    ds_read_b64_tr_b16 v[136:137], v8 offset:22176
    v_mfma_f32_16x16x32_bf16 v[56:59], v[112:115], a[76:79], v[56:59]
    ds_read_b64_tr_b16 v[138:139], v8 offset:22688
    s_waitcnt lgkmcnt(10)
    v_mfma_f32_16x16x32_bf16 v[28:31], v[116:119], a[16:19], v[28:31]
    ds_read_b64_tr_b16 v[140:141], v8 offset:23232
    s_add_u32 s73, s98, 4096
    buffer_load_dwordx4 a[144:147], v5, s[36:39], s73 offen offset:0 sc1
    v_mfma_f32_16x16x32_bf16 v[44:47], v[116:119], a[80:83], v[44:47]
    ds_read_b64_tr_b16 v[142:143], v8 offset:23744
    s_waitcnt lgkmcnt(10)
    v_mfma_f32_16x16x32_bf16 v[32:35], v[120:123], a[16:19], v[32:35]
    ds_read_b64_tr_b16 v[144:145], v8 offset:24288
    v_mfma_f32_16x16x32_bf16 v[48:51], v[120:123], a[80:83], v[48:51]
    ds_read_b64_tr_b16 v[146:147], v8 offset:24800
    s_add_u32 s73, s99, 4096
    buffer_load_dwordx4 a[208:211], v5, s[36:39], s73 offen offset:0 sc1
    s_waitcnt lgkmcnt(10)
    v_mfma_f32_16x16x32_bf16 v[36:39], v[124:127], a[16:19], v[36:39]
    ds_read_b64_tr_b16 v[100:101], v8 offset:25344
    v_mfma_f32_16x16x32_bf16 v[52:55], v[124:127], a[80:83], v[52:55]
    ds_read_b64_tr_b16 v[102:103], v8 offset:25856
    s_waitcnt lgkmcnt(10)
    v_mfma_f32_16x16x32_bf16 v[40:43], v[128:131], a[16:19], v[40:43]
    ds_read_b64_tr_b16 v[104:105], v8 offset:26400
    s_add_u32 s73, s98, 4096
    buffer_load_dwordx4 a[148:151], v5, s[36:39], s73 offen offset:1024 sc1
    v_mfma_f32_16x16x32_bf16 v[56:59], v[128:131], a[80:83], v[56:59]
    ds_read_b64_tr_b16 v[106:107], v8 offset:26912
    s_waitcnt lgkmcnt(10)
    v_mfma_f32_16x16x32_bf16 v[28:31], v[132:135], a[20:23], v[28:31]
    ds_read_b64_tr_b16 v[108:109], v8 offset:27456
    v_mfma_f32_16x16x32_bf16 v[44:47], v[132:135], a[84:87], v[44:47]
    ds_read_b64_tr_b16 v[110:111], v8 offset:27968
    s_add_u32 s73, s99, 4096
    buffer_load_dwordx4 a[212:215], v5, s[36:39], s73 offen offset:1024 sc1
    s_waitcnt lgkmcnt(10)
    v_mfma_f32_16x16x32_bf16 v[32:35], v[136:139], a[20:23], v[32:35]
    ds_read_b64_tr_b16 v[112:113], v8 offset:28512
    v_mfma_f32_16x16x32_bf16 v[48:51], v[136:139], a[84:87], v[48:51]
    ds_read_b64_tr_b16 v[114:115], v8 offset:29024
    s_waitcnt lgkmcnt(10)
    v_mfma_f32_16x16x32_bf16 v[36:39], v[140:143], a[20:23], v[36:39]
    ds_read_b64_tr_b16 v[116:117], v8 offset:29568
    s_add_u32 s73, s98, 4096
    buffer_load_dwordx4 a[152:155], v5, s[36:39], s73 offen offset:2048 sc1
    v_mfma_f32_16x16x32_bf16 v[52:55], v[140:143], a[84:87], v[52:55]
    ds_read_b64_tr_b16 v[118:119], v8 offset:30080
    s_waitcnt lgkmcnt(10)
    v_mfma_f32_16x16x32_bf16 v[40:43], v[144:147], a[20:23], v[40:43]
    ds_read_b64_tr_b16 v[120:121], v8 offset:30624
    v_mfma_f32_16x16x32_bf16 v[56:59], v[144:147], a[84:87], v[56:59]
    ds_read_b64_tr_b16 v[122:123], v8 offset:31136
    s_add_u32 s73, s99, 4096
    buffer_load_dwordx4 a[216:219], v5, s[36:39], s73 offen offset:2048 sc1
    s_waitcnt lgkmcnt(10)
    v_mfma_f32_16x16x32_bf16 v[28:31], v[100:103], a[24:27], v[28:31]
    ds_read_b64_tr_b16 v[124:125], v8 offset:31680
    v_mfma_f32_16x16x32_bf16 v[44:47], v[100:103], a[88:91], v[44:47]
    ds_read_b64_tr_b16 v[126:127], v8 offset:32192
    s_waitcnt lgkmcnt(10)
    v_mfma_f32_16x16x32_bf16 v[32:35], v[104:107], a[24:27], v[32:35]
    ds_read_b64_tr_b16 v[128:129], v8 offset:32736
    s_add_u32 s73, s98, 4096
    buffer_load_dwordx4 a[156:159], v5, s[36:39], s73 offen offset:3072 sc1
    v_mfma_f32_16x16x32_bf16 v[48:51], v[104:107], a[88:91], v[48:51]
    ds_read_b64_tr_b16 v[130:131], v8 offset:33248
    s_waitcnt lgkmcnt(10)
    v_mfma_f32_16x16x32_bf16 v[36:39], v[108:111], a[24:27], v[36:39]
    ds_read_b64_tr_b16 v[132:133], v148 offset:0
    v_mfma_f32_16x16x32_bf16 v[52:55], v[108:111], a[88:91], v[52:55]
    ds_read_b64_tr_b16 v[134:135], v148 offset:512
    s_add_u32 s73, s99, 4096
    buffer_load_dwordx4 a[220:223], v5, s[36:39], s73 offen offset:3072 sc1
    s_waitcnt lgkmcnt(10)
    v_mfma_f32_16x16x32_bf16 v[40:43], v[112:115], a[24:27], v[40:43]
    ds_read_b64_tr_b16 v[136:137], v148 offset:1056
    v_mfma_f32_16x16x32_bf16 v[56:59], v[112:115], a[88:91], v[56:59]
    ds_read_b64_tr_b16 v[138:139], v148 offset:1568
    s_waitcnt lgkmcnt(10)
    v_mfma_f32_16x16x32_bf16 v[28:31], v[116:119], a[28:31], v[28:31]
    ds_read_b64_tr_b16 v[140:141], v148 offset:2112
    s_add_u32 s73, s98, 8192
    buffer_load_dwordx4 a[160:163], v5, s[36:39], s73 offen offset:0 sc1
    v_mfma_f32_16x16x32_bf16 v[44:47], v[116:119], a[92:95], v[44:47]
    ds_read_b64_tr_b16 v[142:143], v148 offset:2624
    s_waitcnt lgkmcnt(10)
    v_mfma_f32_16x16x32_bf16 v[32:35], v[120:123], a[28:31], v[32:35]
    ds_read_b64_tr_b16 v[144:145], v148 offset:3168
    v_mfma_f32_16x16x32_bf16 v[48:51], v[120:123], a[92:95], v[48:51]
    ds_read_b64_tr_b16 v[146:147], v148 offset:3680
    s_add_u32 s73, s99, 8192
    buffer_load_dwordx4 a[224:227], v5, s[36:39], s73 offen offset:0 sc1
    s_waitcnt lgkmcnt(10)
    v_mfma_f32_16x16x32_bf16 v[36:39], v[124:127], a[28:31], v[36:39]
    ds_read_b64_tr_b16 v[100:101], v148 offset:4224
    v_mfma_f32_16x16x32_bf16 v[52:55], v[124:127], a[92:95], v[52:55]
    ds_read_b64_tr_b16 v[102:103], v148 offset:4736
    s_waitcnt lgkmcnt(10)
    v_mfma_f32_16x16x32_bf16 v[40:43], v[128:131], a[28:31], v[40:43]
    ds_read_b64_tr_b16 v[104:105], v148 offset:5280
    s_add_u32 s73, s98, 8192
    buffer_load_dwordx4 a[164:167], v5, s[36:39], s73 offen offset:1024 sc1
    v_mfma_f32_16x16x32_bf16 v[56:59], v[128:131], a[92:95], v[56:59]
    ds_read_b64_tr_b16 v[106:107], v148 offset:5792
    s_waitcnt lgkmcnt(10)
    v_mfma_f32_16x16x32_bf16 v[28:31], v[132:135], a[32:35], v[28:31]
    ds_read_b64_tr_b16 v[108:109], v148 offset:6336
    v_mfma_f32_16x16x32_bf16 v[44:47], v[132:135], a[96:99], v[44:47]
    ds_read_b64_tr_b16 v[110:111], v148 offset:6848
    s_add_u32 s73, s99, 8192
    buffer_load_dwordx4 a[228:231], v5, s[36:39], s73 offen offset:1024 sc1
    s_waitcnt lgkmcnt(10)
    v_mfma_f32_16x16x32_bf16 v[32:35], v[136:139], a[32:35], v[32:35]
    ds_read_b64_tr_b16 v[112:113], v148 offset:7392
    v_mfma_f32_16x16x32_bf16 v[48:51], v[136:139], a[96:99], v[48:51]
    ds_read_b64_tr_b16 v[114:115], v148 offset:7904
    s_waitcnt lgkmcnt(10)
    v_mfma_f32_16x16x32_bf16 v[36:39], v[140:143], a[32:35], v[36:39]
    ds_read_b64_tr_b16 v[116:117], v148 offset:8448
    s_add_u32 s73, s98, 8192
    buffer_load_dwordx4 a[168:171], v5, s[36:39], s73 offen offset:2048 sc1
    v_mfma_f32_16x16x32_bf16 v[52:55], v[140:143], a[96:99], v[52:55]
    ds_read_b64_tr_b16 v[118:119], v148 offset:8960
    s_waitcnt lgkmcnt(10)
    v_mfma_f32_16x16x32_bf16 v[40:43], v[144:147], a[32:35], v[40:43]
    ds_read_b64_tr_b16 v[120:121], v148 offset:9504
    v_mfma_f32_16x16x32_bf16 v[56:59], v[144:147], a[96:99], v[56:59]
    ds_read_b64_tr_b16 v[122:123], v148 offset:10016
    s_add_u32 s73, s99, 8192
    buffer_load_dwordx4 a[232:235], v5, s[36:39], s73 offen offset:2048 sc1
    s_waitcnt lgkmcnt(10)
    v_mfma_f32_16x16x32_bf16 v[28:31], v[100:103], a[36:39], v[28:31]
    ds_read_b64_tr_b16 v[124:125], v148 offset:10560
    v_mfma_f32_16x16x32_bf16 v[44:47], v[100:103], a[100:103], v[44:47]
    ds_read_b64_tr_b16 v[126:127], v148 offset:11072
    s_waitcnt lgkmcnt(10)
    v_mfma_f32_16x16x32_bf16 v[32:35], v[104:107], a[36:39], v[32:35]
    ds_read_b64_tr_b16 v[128:129], v148 offset:11616
    s_add_u32 s73, s98, 8192
    buffer_load_dwordx4 a[172:175], v5, s[36:39], s73 offen offset:3072 sc1
    v_mfma_f32_16x16x32_bf16 v[48:51], v[104:107], a[100:103], v[48:51]
    ds_read_b64_tr_b16 v[130:131], v148 offset:12128
    s_waitcnt lgkmcnt(10)
    v_mfma_f32_16x16x32_bf16 v[36:39], v[108:111], a[36:39], v[36:39]
    ds_read_b64_tr_b16 v[132:133], v148 offset:12672
    v_mfma_f32_16x16x32_bf16 v[52:55], v[108:111], a[100:103], v[52:55]
    ds_read_b64_tr_b16 v[134:135], v148 offset:13184
    s_add_u32 s73, s99, 8192
    buffer_load_dwordx4 a[236:239], v5, s[36:39], s73 offen offset:3072 sc1
    s_waitcnt lgkmcnt(10)
    v_mfma_f32_16x16x32_bf16 v[40:43], v[112:115], a[36:39], v[40:43]
    ds_read_b64_tr_b16 v[136:137], v148 offset:13728
    v_mfma_f32_16x16x32_bf16 v[56:59], v[112:115], a[100:103], v[56:59]
    ds_read_b64_tr_b16 v[138:139], v148 offset:14240
    s_waitcnt lgkmcnt(10)
    v_mfma_f32_16x16x32_bf16 v[28:31], v[116:119], a[40:43], v[28:31]
    ds_read_b64_tr_b16 v[140:141], v148 offset:14784
    s_add_u32 s73, s98, 12288
    buffer_load_dwordx4 a[176:179], v5, s[36:39], s73 offen offset:0 sc1
    v_mfma_f32_16x16x32_bf16 v[44:47], v[116:119], a[104:107], v[44:47]
    ds_read_b64_tr_b16 v[142:143], v148 offset:15296
    s_waitcnt lgkmcnt(10)
    v_mfma_f32_16x16x32_bf16 v[32:35], v[120:123], a[40:43], v[32:35]
    ds_read_b64_tr_b16 v[144:145], v148 offset:15840
    v_mfma_f32_16x16x32_bf16 v[48:51], v[120:123], a[104:107], v[48:51]
    ds_read_b64_tr_b16 v[146:147], v148 offset:16352
    s_add_u32 s73, s99, 12288
    buffer_load_dwordx4 a[240:243], v5, s[36:39], s73 offen offset:0 sc1
    s_waitcnt lgkmcnt(10)
    v_mfma_f32_16x16x32_bf16 v[36:39], v[124:127], a[40:43], v[36:39]
    ds_read_b64_tr_b16 v[100:101], v148 offset:16896
    v_mfma_f32_16x16x32_bf16 v[52:55], v[124:127], a[104:107], v[52:55]
    ds_read_b64_tr_b16 v[102:103], v148 offset:17408
    s_waitcnt lgkmcnt(10)
    v_mfma_f32_16x16x32_bf16 v[40:43], v[128:131], a[40:43], v[40:43]
    ds_read_b64_tr_b16 v[104:105], v148 offset:17952
    s_add_u32 s73, s98, 12288
    buffer_load_dwordx4 a[180:183], v5, s[36:39], s73 offen offset:1024 sc1
    v_mfma_f32_16x16x32_bf16 v[56:59], v[128:131], a[104:107], v[56:59]
    ds_read_b64_tr_b16 v[106:107], v148 offset:18464
    s_waitcnt lgkmcnt(10)
    v_mfma_f32_16x16x32_bf16 v[28:31], v[132:135], a[44:47], v[28:31]
    ds_read_b64_tr_b16 v[108:109], v148 offset:19008
    v_mfma_f32_16x16x32_bf16 v[44:47], v[132:135], a[108:111], v[44:47]
    ds_read_b64_tr_b16 v[110:111], v148 offset:19520
    s_add_u32 s73, s99, 12288
    buffer_load_dwordx4 a[244:247], v5, s[36:39], s73 offen offset:1024 sc1
    s_waitcnt lgkmcnt(10)
    v_mfma_f32_16x16x32_bf16 v[32:35], v[136:139], a[44:47], v[32:35]
    ds_read_b64_tr_b16 v[112:113], v148 offset:20064
    v_mfma_f32_16x16x32_bf16 v[48:51], v[136:139], a[108:111], v[48:51]
    ds_read_b64_tr_b16 v[114:115], v148 offset:20576
    s_waitcnt lgkmcnt(10)
    v_mfma_f32_16x16x32_bf16 v[36:39], v[140:143], a[44:47], v[36:39]
    ds_read_b64_tr_b16 v[116:117], v148 offset:21120
    s_add_u32 s73, s98, 12288
    buffer_load_dwordx4 a[184:187], v5, s[36:39], s73 offen offset:2048 sc1
    v_mfma_f32_16x16x32_bf16 v[52:55], v[140:143], a[108:111], v[52:55]
    ds_read_b64_tr_b16 v[118:119], v148 offset:21632
    s_waitcnt lgkmcnt(10)
    v_mfma_f32_16x16x32_bf16 v[40:43], v[144:147], a[44:47], v[40:43]
    ds_read_b64_tr_b16 v[120:121], v148 offset:22176
    v_mfma_f32_16x16x32_bf16 v[56:59], v[144:147], a[108:111], v[56:59]
    ds_read_b64_tr_b16 v[122:123], v148 offset:22688
    s_add_u32 s73, s99, 12288
    buffer_load_dwordx4 a[248:251], v5, s[36:39], s73 offen offset:2048 sc1
    s_waitcnt lgkmcnt(10)
    v_mfma_f32_16x16x32_bf16 v[28:31], v[100:103], a[48:51], v[28:31]
    ds_read_b64_tr_b16 v[124:125], v148 offset:23232
    v_mfma_f32_16x16x32_bf16 v[44:47], v[100:103], a[112:115], v[44:47]
    ds_read_b64_tr_b16 v[126:127], v148 offset:23744
    s_waitcnt lgkmcnt(10)
    v_mfma_f32_16x16x32_bf16 v[32:35], v[104:107], a[48:51], v[32:35]
    ds_read_b64_tr_b16 v[128:129], v148 offset:24288
    s_add_u32 s73, s98, 12288
    buffer_load_dwordx4 a[188:191], v5, s[36:39], s73 offen offset:3072 sc1
    v_mfma_f32_16x16x32_bf16 v[48:51], v[104:107], a[112:115], v[48:51]
    ds_read_b64_tr_b16 v[130:131], v148 offset:24800
    s_waitcnt lgkmcnt(10)
    v_mfma_f32_16x16x32_bf16 v[36:39], v[108:111], a[48:51], v[36:39]
    ds_read_b64_tr_b16 v[132:133], v148 offset:25344
    v_mfma_f32_16x16x32_bf16 v[52:55], v[108:111], a[112:115], v[52:55]
    ds_read_b64_tr_b16 v[134:135], v148 offset:25856
    s_add_u32 s73, s99, 12288
    buffer_load_dwordx4 a[252:255], v5, s[36:39], s73 offen offset:3072 sc1
    s_waitcnt lgkmcnt(10)
    v_mfma_f32_16x16x32_bf16 v[40:43], v[112:115], a[48:51], v[40:43]
    ds_read_b64_tr_b16 v[136:137], v148 offset:26400
    v_mfma_f32_16x16x32_bf16 v[56:59], v[112:115], a[112:115], v[56:59]
    ds_read_b64_tr_b16 v[138:139], v148 offset:26912
    s_waitcnt lgkmcnt(10)
    v_mfma_f32_16x16x32_bf16 v[28:31], v[116:119], a[52:55], v[28:31]
    ds_read_b64_tr_b16 v[140:141], v148 offset:27456
    v_mfma_f32_16x16x32_bf16 v[44:47], v[116:119], a[116:119], v[44:47]
    ds_read_b64_tr_b16 v[142:143], v148 offset:27968
    s_waitcnt lgkmcnt(10)
    v_mfma_f32_16x16x32_bf16 v[32:35], v[120:123], a[52:55], v[32:35]
    ds_read_b64_tr_b16 v[144:145], v148 offset:28512
    v_mfma_f32_16x16x32_bf16 v[48:51], v[120:123], a[116:119], v[48:51]
    ds_read_b64_tr_b16 v[146:147], v148 offset:29024
    s_waitcnt lgkmcnt(10)
    v_mfma_f32_16x16x32_bf16 v[36:39], v[124:127], a[52:55], v[36:39]
    ds_read_b64_tr_b16 v[100:101], v148 offset:29568
    v_mfma_f32_16x16x32_bf16 v[52:55], v[124:127], a[116:119], v[52:55]
    ds_read_b64_tr_b16 v[102:103], v148 offset:30080
    s_waitcnt lgkmcnt(10)
    v_mfma_f32_16x16x32_bf16 v[40:43], v[128:131], a[52:55], v[40:43]
    ds_read_b64_tr_b16 v[104:105], v148 offset:30624
    v_mfma_f32_16x16x32_bf16 v[56:59], v[128:131], a[116:119], v[56:59]
    ds_read_b64_tr_b16 v[106:107], v148 offset:31136
    s_waitcnt lgkmcnt(10)
    v_mfma_f32_16x16x32_bf16 v[28:31], v[132:135], a[56:59], v[28:31]
    ds_read_b64_tr_b16 v[108:109], v148 offset:31680
    v_mfma_f32_16x16x32_bf16 v[44:47], v[132:135], a[120:123], v[44:47]
    ds_read_b64_tr_b16 v[110:111], v148 offset:32192
    s_waitcnt lgkmcnt(10)
    v_mfma_f32_16x16x32_bf16 v[32:35], v[136:139], a[56:59], v[32:35]
    ds_read_b64_tr_b16 v[112:113], v148 offset:32736
    v_mfma_f32_16x16x32_bf16 v[48:51], v[136:139], a[120:123], v[48:51]
    ds_read_b64_tr_b16 v[114:115], v148 offset:33248
    s_waitcnt lgkmcnt(10)
    v_mfma_f32_16x16x32_bf16 v[36:39], v[140:143], a[56:59], v[36:39]
    v_mfma_f32_16x16x32_bf16 v[52:55], v[140:143], a[120:123], v[52:55]
    s_waitcnt lgkmcnt(8)
    v_mfma_f32_16x16x32_bf16 v[40:43], v[144:147], a[56:59], v[40:43]
    v_mfma_f32_16x16x32_bf16 v[56:59], v[144:147], a[120:123], v[56:59]
    ds_read_b128 v[152:155], v150 offset:0
    ds_read_b128 v[168:171], v150 offset:256
    ds_read_b128 v[156:159], v150 offset:64
    ds_read_b128 v[172:175], v150 offset:320
    ds_read_b128 v[160:163], v150 offset:128
    ds_read_b128 v[176:179], v150 offset:384
    ds_read_b128 v[164:167], v150 offset:192
    ds_read_b128 v[180:183], v150 offset:448
    s_waitcnt lgkmcnt(14)
    v_mfma_f32_16x16x32_bf16 v[28:31], v[100:103], a[60:63], v[28:31]
    v_mfma_f32_16x16x32_bf16 v[44:47], v[100:103], a[124:127], v[44:47]
    s_waitcnt lgkmcnt(12)
    v_mfma_f32_16x16x32_bf16 v[32:35], v[104:107], a[60:63], v[32:35]
    v_mfma_f32_16x16x32_bf16 v[48:51], v[104:107], a[124:127], v[48:51]
    s_waitcnt lgkmcnt(10)
    v_mfma_f32_16x16x32_bf16 v[36:39], v[108:111], a[60:63], v[36:39]
    v_mfma_f32_16x16x32_bf16 v[52:55], v[108:111], a[124:127], v[52:55]
    s_waitcnt lgkmcnt(8)
    v_mfma_f32_16x16x32_bf16 v[40:43], v[112:115], a[60:63], v[40:43]
    v_mfma_f32_16x16x32_bf16 v[56:59], v[112:115], a[124:127], v[56:59]
    ds_read_b64_tr_b16 v[100:101], v8 offset:0
    ds_read_b64_tr_b16 v[102:103], v8 offset:512
    ds_read_b64_tr_b16 v[104:105], v8 offset:1056
    ds_read_b64_tr_b16 v[106:107], v8 offset:1568
    ds_read_b64_tr_b16 v[108:109], v8 offset:2112
    ds_read_b64_tr_b16 v[110:111], v8 offset:2624
    ds_read_b64_tr_b16 v[112:113], v8 offset:3168
    ds_read_b64_tr_b16 v[114:115], v8 offset:3680
    s_waitcnt lgkmcnt(8)
    v_pk_fma_f32 v[216:217], v[168:169], v[12:13], v[12:13] op_sel:[0,0,1] op_sel_hi:[1,0,1]
    v_pk_fma_f32 v[218:219], v[170:171], v[12:13], v[12:13] op_sel:[0,0,1] op_sel_hi:[1,0,1]
    v_pk_fma_f32 v[220:221], v[172:173], v[12:13], v[12:13] op_sel:[0,0,1] op_sel_hi:[1,0,1]
    v_pk_fma_f32 v[222:223], v[174:175], v[12:13], v[12:13] op_sel:[0,0,1] op_sel_hi:[1,0,1]
    v_pk_fma_f32 v[224:225], v[176:177], v[12:13], v[12:13] op_sel:[0,0,1] op_sel_hi:[1,0,1]
    v_pk_fma_f32 v[226:227], v[178:179], v[12:13], v[12:13] op_sel:[0,0,1] op_sel_hi:[1,0,1]
    v_pk_fma_f32 v[228:229], v[180:181], v[12:13], v[12:13] op_sel:[0,0,1] op_sel_hi:[1,0,1]
    v_pk_fma_f32 v[230:231], v[182:183], v[12:13], v[12:13] op_sel:[0,0,1] op_sel_hi:[1,0,1]
    v_pk_fma_f32 v[28:29], v[28:29], v[152:153], v[216:217]
    v_pk_fma_f32 v[30:31], v[30:31], v[154:155], v[218:219]
    v_pk_fma_f32 v[32:33], v[32:33], v[156:157], v[220:221]
    v_pk_fma_f32 v[34:35], v[34:35], v[158:159], v[222:223]
    v_pk_fma_f32 v[36:37], v[36:37], v[160:161], v[224:225]
    v_pk_fma_f32 v[38:39], v[38:39], v[162:163], v[226:227]
    v_pk_fma_f32 v[40:41], v[40:41], v[164:165], v[228:229]
    v_pk_fma_f32 v[42:43], v[42:43], v[166:167], v[230:231]
    v_pk_mul_f32 v[216:217], v[28:29], v[28:29]
    v_pk_mul_f32 v[218:219], v[30:31], v[30:31]
    s_waitcnt vmcnt(40)
    ds_read_b128 a[0:3], v242 offset:0
    v_pk_mul_f32 v[220:221], v[32:33], v[32:33]
    v_pk_mul_f32 v[222:223], v[34:35], v[34:35]
    v_pk_mul_f32 v[224:225], v[36:37], v[36:37]
    v_pk_mul_f32 v[226:227], v[38:39], v[38:39]
    v_pk_mul_f32 v[228:229], v[40:41], v[40:41]
    v_pk_mul_f32 v[230:231], v[42:43], v[42:43]
    ds_read_b128 a[4:7], v242 offset:2048
    v_pk_fma_f32 v[216:217], v[216:217], s[16:17], v[10:11] op_sel:[0,0,0] op_sel_hi:[1,0,0]
    v_pk_fma_f32 v[218:219], v[218:219], s[16:17], v[10:11] op_sel:[0,0,0] op_sel_hi:[1,0,0]
    v_pk_fma_f32 v[220:221], v[220:221], s[16:17], v[10:11] op_sel:[0,0,0] op_sel_hi:[1,0,0]
    v_pk_fma_f32 v[222:223], v[222:223], s[16:17], v[10:11] op_sel:[0,0,0] op_sel_hi:[1,0,0]
    v_pk_fma_f32 v[224:225], v[224:225], s[16:17], v[10:11] op_sel:[0,0,0] op_sel_hi:[1,0,0]
    v_pk_fma_f32 v[226:227], v[226:227], s[16:17], v[10:11] op_sel:[0,0,0] op_sel_hi:[1,0,0]
    ds_read_b128 a[8:11], v242 offset:4096
    v_pk_fma_f32 v[228:229], v[228:229], s[16:17], v[10:11] op_sel:[0,0,0] op_sel_hi:[1,0,0]
    v_pk_fma_f32 v[230:231], v[230:231], s[16:17], v[10:11] op_sel:[0,0,0] op_sel_hi:[1,0,0]
    v_pk_mul_f32 v[216:217], v[216:217], v[28:29]
    v_pk_mul_f32 v[218:219], v[218:219], v[30:31]
    v_pk_mul_f32 v[220:221], v[220:221], v[32:33]
    v_pk_mul_f32 v[222:223], v[222:223], v[34:35]
    ds_read_b128 a[12:15], v242 offset:6144
    v_pk_mul_f32 v[224:225], v[224:225], v[36:37]
    v_pk_mul_f32 v[226:227], v[226:227], v[38:39]
    v_pk_mul_f32 v[228:229], v[228:229], v[40:41]
    v_pk_mul_f32 v[230:231], v[230:231], v[42:43]
    v_exp_f32 v216, v216
    v_exp_f32 v217, v217
    ds_read_b128 a[16:19], v243 offset:0
    v_exp_f32 v218, v218
    v_exp_f32 v219, v219
    v_exp_f32 v220, v220
    v_exp_f32 v221, v221
    v_exp_f32 v222, v222
    v_exp_f32 v223, v223
    ds_read_b128 a[20:23], v243 offset:2048
    v_exp_f32 v224, v224
    v_exp_f32 v225, v225
    v_exp_f32 v226, v226
    v_exp_f32 v227, v227
    v_exp_f32 v228, v228
    v_exp_f32 v229, v229
    ds_read_b128 a[24:27], v243 offset:4096
    v_exp_f32 v230, v230
    v_exp_f32 v231, v231
    v_pk_add_f32 v[216:217], v[216:217], 1.0 op_sel_hi:[1,0]
    v_pk_add_f32 v[218:219], v[218:219], 1.0 op_sel_hi:[1,0]
    v_pk_add_f32 v[220:221], v[220:221], 1.0 op_sel_hi:[1,0]
    v_pk_add_f32 v[222:223], v[222:223], 1.0 op_sel_hi:[1,0]
    ds_read_b128 a[28:31], v243 offset:6144
    v_pk_add_f32 v[224:225], v[224:225], 1.0 op_sel_hi:[1,0]
    v_pk_add_f32 v[226:227], v[226:227], 1.0 op_sel_hi:[1,0]
    v_pk_add_f32 v[228:229], v[228:229], 1.0 op_sel_hi:[1,0]
    v_pk_add_f32 v[230:231], v[230:231], 1.0 op_sel_hi:[1,0]
    v_rcp_f32 v216, v216
    v_rcp_f32 v217, v217
    s_waitcnt vmcnt(32)
    ds_read_b128 a[32:35], v242 offset:8192
    v_rcp_f32 v218, v218
    v_rcp_f32 v219, v219
    v_rcp_f32 v220, v220
    v_rcp_f32 v221, v221
    v_rcp_f32 v222, v222
    v_rcp_f32 v223, v223
    ds_read_b128 a[36:39], v242 offset:10240
    v_rcp_f32 v224, v224
    v_rcp_f32 v225, v225
    v_rcp_f32 v226, v226
    v_rcp_f32 v227, v227
    v_rcp_f32 v228, v228
    v_rcp_f32 v229, v229
    ds_read_b128 a[40:43], v242 offset:12288
    v_rcp_f32 v230, v230
    v_rcp_f32 v231, v231
    v_pk_mul_f32 v[28:29], v[28:29], v[216:217]
    v_pk_mul_f32 v[30:31], v[30:31], v[218:219]
    v_pk_mul_f32 v[32:33], v[32:33], v[220:221]
    v_pk_mul_f32 v[34:35], v[34:35], v[222:223]
    ds_read_b128 a[44:47], v242 offset:14336
    v_pk_mul_f32 v[36:37], v[36:37], v[224:225]
    v_pk_mul_f32 v[38:39], v[38:39], v[226:227]
    v_pk_mul_f32 v[40:41], v[40:41], v[228:229]
    v_pk_mul_f32 v[42:43], v[42:43], v[230:231]
    v_pk_mul_f32 v[200:201], v[28:29], v[28:29]
    v_pk_mul_f32 v[202:203], v[30:31], v[30:31]
    ds_read_b128 a[48:51], v243 offset:8192
    v_pk_mul_f32 v[204:205], v[32:33], v[32:33]
    v_pk_mul_f32 v[206:207], v[34:35], v[34:35]
    v_pk_mul_f32 v[208:209], v[36:37], v[36:37]
    v_pk_mul_f32 v[210:211], v[38:39], v[38:39]
    v_pk_mul_f32 v[212:213], v[40:41], v[40:41]
    v_pk_mul_f32 v[214:215], v[42:43], v[42:43]
    ds_read_b128 a[52:55], v243 offset:10240
    v_pk_fma_f32 v[216:217], v[168:169], v[16:17], v[16:17] op_sel:[0,0,1] op_sel_hi:[1,0,1]
    v_pk_fma_f32 v[218:219], v[170:171], v[16:17], v[16:17] op_sel:[0,0,1] op_sel_hi:[1,0,1]
    v_pk_fma_f32 v[220:221], v[172:173], v[16:17], v[16:17] op_sel:[0,0,1] op_sel_hi:[1,0,1]
    v_pk_fma_f32 v[222:223], v[174:175], v[16:17], v[16:17] op_sel:[0,0,1] op_sel_hi:[1,0,1]
    v_pk_fma_f32 v[224:225], v[176:177], v[16:17], v[16:17] op_sel:[0,0,1] op_sel_hi:[1,0,1]
    v_pk_fma_f32 v[226:227], v[178:179], v[16:17], v[16:17] op_sel:[0,0,1] op_sel_hi:[1,0,1]
    ds_read_b128 a[56:59], v243 offset:12288
    v_pk_fma_f32 v[228:229], v[180:181], v[16:17], v[16:17] op_sel:[0,0,1] op_sel_hi:[1,0,1]
    v_pk_fma_f32 v[230:231], v[182:183], v[16:17], v[16:17] op_sel:[0,0,1] op_sel_hi:[1,0,1]
    v_pk_fma_f32 v[44:45], v[44:45], v[152:153], v[216:217]
    v_pk_fma_f32 v[46:47], v[46:47], v[154:155], v[218:219]
    v_pk_fma_f32 v[48:49], v[48:49], v[156:157], v[220:221]
    v_pk_fma_f32 v[50:51], v[50:51], v[158:159], v[222:223]
    ds_read_b128 a[60:63], v243 offset:14336
    v_pk_fma_f32 v[52:53], v[52:53], v[160:161], v[224:225]
    v_pk_fma_f32 v[54:55], v[54:55], v[162:163], v[226:227]
    v_pk_fma_f32 v[56:57], v[56:57], v[164:165], v[228:229]
    v_pk_fma_f32 v[58:59], v[58:59], v[166:167], v[230:231]
    v_pk_mul_f32 v[216:217], v[44:45], v[44:45]
    v_pk_mul_f32 v[218:219], v[46:47], v[46:47]
    s_waitcnt lgkmcnt(8)
    s_add_u32 s101, s100, 2
    s_and_b32 s101, s101, 7
    s_lshl_b32 s101, s101, 7
    s_add_u32 s73, s94, s101
    s_add_u32 m0, s93, 0
    s_nop 0
    buffer_load_dwordx4 v244, s[44:47], s73 offen nt lds
    v_pk_mul_f32 v[220:221], v[48:49], v[48:49]
    v_pk_mul_f32 v[222:223], v[50:51], v[50:51]
    v_pk_mul_f32 v[224:225], v[52:53], v[52:53]
    v_pk_mul_f32 v[226:227], v[54:55], v[54:55]
    v_pk_mul_f32 v[228:229], v[56:57], v[56:57]
    v_pk_mul_f32 v[230:231], v[58:59], v[58:59]
    s_add_u32 s73, s94, s101
    s_add_u32 s73, s73, 32768
    s_add_u32 m0, s93, 1024
    s_nop 0
    buffer_load_dwordx4 v244, s[44:47], s73 offen nt lds
    v_pk_fma_f32 v[216:217], v[216:217], s[16:17], v[10:11] op_sel:[0,0,0] op_sel_hi:[1,0,0]
    v_pk_fma_f32 v[218:219], v[218:219], s[16:17], v[10:11] op_sel:[0,0,0] op_sel_hi:[1,0,0]
    v_pk_fma_f32 v[220:221], v[220:221], s[16:17], v[10:11] op_sel:[0,0,0] op_sel_hi:[1,0,0]
    v_pk_fma_f32 v[222:223], v[222:223], s[16:17], v[10:11] op_sel:[0,0,0] op_sel_hi:[1,0,0]
    v_pk_fma_f32 v[224:225], v[224:225], s[16:17], v[10:11] op_sel:[0,0,0] op_sel_hi:[1,0,0]
    v_pk_fma_f32 v[226:227], v[226:227], s[16:17], v[10:11] op_sel:[0,0,0] op_sel_hi:[1,0,0]
    s_add_u32 s73, s95, s101
    s_add_u32 m0, s93, 2048
    s_nop 0
    buffer_load_dwordx4 v244, s[44:47], s73 offen nt lds
    v_pk_fma_f32 v[228:229], v[228:229], s[16:17], v[10:11] op_sel:[0,0,0] op_sel_hi:[1,0,0]
    v_pk_fma_f32 v[230:231], v[230:231], s[16:17], v[10:11] op_sel:[0,0,0] op_sel_hi:[1,0,0]
    v_pk_mul_f32 v[216:217], v[216:217], v[44:45]
    v_pk_mul_f32 v[218:219], v[218:219], v[46:47]
    v_pk_mul_f32 v[220:221], v[220:221], v[48:49]
    v_pk_mul_f32 v[222:223], v[222:223], v[50:51]
    s_add_u32 s73, s95, s101
    s_add_u32 s73, s73, 32768
    s_add_u32 m0, s93, 3072
    s_nop 0
    buffer_load_dwordx4 v244, s[44:47], s73 offen nt lds
    v_pk_mul_f32 v[224:225], v[224:225], v[52:53]
    v_pk_mul_f32 v[226:227], v[226:227], v[54:55]
    v_pk_mul_f32 v[228:229], v[228:229], v[56:57]
    v_pk_mul_f32 v[230:231], v[230:231], v[58:59]
    v_exp_f32 v216, v216
    v_exp_f32 v217, v217
    s_add_u32 s73, s96, s101
    s_add_u32 m0, s93, 4096
    s_nop 0
    buffer_load_dwordx4 v244, s[44:47], s73 offen nt lds
    v_exp_f32 v218, v218
    v_exp_f32 v219, v219
    v_exp_f32 v220, v220
    v_exp_f32 v221, v221
    v_exp_f32 v222, v222
    v_exp_f32 v223, v223
    s_add_u32 s73, s96, s101
    s_add_u32 s73, s73, 32768
    s_add_u32 m0, s93, 5120
    s_nop 0
    buffer_load_dwordx4 v244, s[44:47], s73 offen nt lds
    v_exp_f32 v224, v224
    v_exp_f32 v225, v225
    v_exp_f32 v226, v226
    v_exp_f32 v227, v227
    v_exp_f32 v228, v228
    v_exp_f32 v229, v229
    s_add_u32 s73, s97, s101
    s_add_u32 m0, s93, 6144
    s_nop 0
    buffer_load_dwordx4 v244, s[44:47], s73 offen nt lds
    v_exp_f32 v230, v230
    v_exp_f32 v231, v231
    v_pk_add_f32 v[216:217], v[216:217], 1.0 op_sel_hi:[1,0]
    v_pk_add_f32 v[218:219], v[218:219], 1.0 op_sel_hi:[1,0]
    v_pk_add_f32 v[220:221], v[220:221], 1.0 op_sel_hi:[1,0]
    v_pk_add_f32 v[222:223], v[222:223], 1.0 op_sel_hi:[1,0]
    s_add_u32 s73, s97, s101
    s_add_u32 s73, s73, 32768
    s_add_u32 m0, s93, 7168
    s_nop 0
    buffer_load_dwordx4 v244, s[44:47], s73 offen nt lds
    v_pk_add_f32 v[224:225], v[224:225], 1.0 op_sel_hi:[1,0]
    v_pk_add_f32 v[226:227], v[226:227], 1.0 op_sel_hi:[1,0]
    v_pk_add_f32 v[228:229], v[228:229], 1.0 op_sel_hi:[1,0]
    v_pk_add_f32 v[230:231], v[230:231], 1.0 op_sel_hi:[1,0]
    v_rcp_f32 v216, v216
    v_rcp_f32 v217, v217
    s_waitcnt lgkmcnt(0)
    s_add_u32 s101, s100, 3
    s_and_b32 s101, s101, 7
    s_lshl_b32 s101, s101, 7
    s_add_u32 s73, s94, s101
    s_add_u32 m0, s93, 8192
    s_nop 0
    buffer_load_dwordx4 v244, s[44:47], s73 offen nt lds
    v_rcp_f32 v218, v218
    v_rcp_f32 v219, v219
    v_rcp_f32 v220, v220
    v_rcp_f32 v221, v221
    v_rcp_f32 v222, v222
    v_rcp_f32 v223, v223
    s_add_u32 s73, s94, s101
    s_add_u32 s73, s73, 32768
    s_add_u32 m0, s93, 9216
    s_nop 0
    buffer_load_dwordx4 v244, s[44:47], s73 offen nt lds
    v_rcp_f32 v224, v224
    v_rcp_f32 v225, v225
    v_rcp_f32 v226, v226
    v_rcp_f32 v227, v227
    v_rcp_f32 v228, v228
    v_rcp_f32 v229, v229
    s_add_u32 s73, s95, s101
    s_add_u32 m0, s93, 10240
    s_nop 0
    buffer_load_dwordx4 v244, s[44:47], s73 offen nt lds
    v_rcp_f32 v230, v230
    v_rcp_f32 v231, v231
    v_pk_mul_f32 v[44:45], v[44:45], v[216:217]
    v_pk_mul_f32 v[46:47], v[46:47], v[218:219]
    v_pk_mul_f32 v[48:49], v[48:49], v[220:221]
    v_pk_mul_f32 v[50:51], v[50:51], v[222:223]
    s_add_u32 s73, s95, s101
    s_add_u32 s73, s73, 32768
    s_add_u32 m0, s93, 11264
    s_nop 0
    buffer_load_dwordx4 v244, s[44:47], s73 offen nt lds
    v_pk_mul_f32 v[52:53], v[52:53], v[224:225]
    v_pk_mul_f32 v[54:55], v[54:55], v[226:227]
    v_pk_mul_f32 v[56:57], v[56:57], v[228:229]
    v_pk_mul_f32 v[58:59], v[58:59], v[230:231]
    v_pk_fma_f32 v[200:201], v[44:45], v[44:45], v[200:201]
    v_pk_add_f32 v[184:185], v[44:45], v[28:29]
    s_add_u32 s73, s96, s101
    s_add_u32 m0, s93, 12288
    s_nop 0
    buffer_load_dwordx4 v244, s[44:47], s73 offen nt lds
    v_pk_fma_f32 v[202:203], v[46:47], v[46:47], v[202:203]
    v_pk_add_f32 v[186:187], v[46:47], v[30:31]
    v_pk_fma_f32 v[204:205], v[48:49], v[48:49], v[204:205]
    v_pk_add_f32 v[188:189], v[48:49], v[32:33]
    v_pk_fma_f32 v[206:207], v[50:51], v[50:51], v[206:207]
    v_pk_add_f32 v[190:191], v[50:51], v[34:35]
    s_add_u32 s73, s96, s101
    s_add_u32 s73, s73, 32768
    s_add_u32 m0, s93, 13312
    s_nop 0
    buffer_load_dwordx4 v244, s[44:47], s73 offen nt lds
    v_pk_fma_f32 v[208:209], v[52:53], v[52:53], v[208:209]
    v_pk_add_f32 v[192:193], v[52:53], v[36:37]
    v_pk_fma_f32 v[210:211], v[54:55], v[54:55], v[210:211]
    v_pk_add_f32 v[194:195], v[54:55], v[38:39]
    v_pk_fma_f32 v[212:213], v[56:57], v[56:57], v[212:213]
    v_pk_add_f32 v[196:197], v[56:57], v[40:41]
    s_add_u32 s73, s97, s101
    s_add_u32 m0, s93, 14336
    s_nop 0
    buffer_load_dwordx4 v244, s[44:47], s73 offen nt lds
    v_pk_fma_f32 v[214:215], v[58:59], v[58:59], v[214:215]
    v_pk_add_f32 v[198:199], v[58:59], v[42:43]
    v_add_f32_dpp v184, v184, v184 row_ror:8 row_mask:0xf bank_mask:0x3
    v_add_f32_dpp v185, v185, v185 row_ror:8 row_mask:0xf bank_mask:0x3
    v_add_f32_dpp v186, v186, v186 row_ror:8 row_mask:0xf bank_mask:0x3
    v_add_f32_dpp v187, v187, v187 row_ror:8 row_mask:0xf bank_mask:0x3
    s_add_u32 s73, s97, s101
    s_add_u32 s73, s73, 32768
    s_add_u32 m0, s93, 15360
    s_nop 0
    buffer_load_dwordx4 v244, s[44:47], s73 offen nt lds
    v_add_f32_dpp v188, v188, v188 row_ror:8 row_mask:0xf bank_mask:0x3
    v_add_f32_dpp v189, v189, v189 row_ror:8 row_mask:0xf bank_mask:0x3
    v_add_f32_dpp v190, v190, v190 row_ror:8 row_mask:0xf bank_mask:0x3
    v_add_f32_dpp v191, v191, v191 row_ror:8 row_mask:0xf bank_mask:0x3
    v_add_f32_dpp v192, v192, v192 row_ror:8 row_mask:0xf bank_mask:0x3
    v_add_f32_dpp v193, v193, v193 row_ror:8 row_mask:0xf bank_mask:0x3
    v_add_f32_dpp v194, v194, v194 row_ror:8 row_mask:0xf bank_mask:0x3
    v_add_f32_dpp v195, v195, v195 row_ror:8 row_mask:0xf bank_mask:0x3
    v_add_f32_dpp v196, v196, v196 row_ror:8 row_mask:0xf bank_mask:0x3
    v_add_f32_dpp v197, v197, v197 row_ror:8 row_mask:0xf bank_mask:0x3
    v_add_f32_dpp v198, v198, v198 row_ror:8 row_mask:0xf bank_mask:0x3
    v_add_f32_dpp v199, v199, v199 row_ror:8 row_mask:0xf bank_mask:0x3
    v_add_f32_dpp v184, v200, v200 row_ror:8 row_mask:0xf bank_mask:0xc
    v_add_f32_dpp v185, v201, v201 row_ror:8 row_mask:0xf bank_mask:0xc
    v_add_f32_dpp v186, v202, v202 row_ror:8 row_mask:0xf bank_mask:0xc
    v_add_f32_dpp v187, v203, v203 row_ror:8 row_mask:0xf bank_mask:0xc
    v_add_f32_dpp v188, v204, v204 row_ror:8 row_mask:0xf bank_mask:0xc
    v_add_f32_dpp v189, v205, v205 row_ror:8 row_mask:0xf bank_mask:0xc
    v_add_f32_dpp v190, v206, v206 row_ror:8 row_mask:0xf bank_mask:0xc
    v_add_f32_dpp v191, v207, v207 row_ror:8 row_mask:0xf bank_mask:0xc
    v_add_f32_dpp v192, v208, v208 row_ror:8 row_mask:0xf bank_mask:0xc
    v_add_f32_dpp v193, v209, v209 row_ror:8 row_mask:0xf bank_mask:0xc
    v_add_f32_dpp v194, v210, v210 row_ror:8 row_mask:0xf bank_mask:0xc
    v_add_f32_dpp v195, v211, v211 row_ror:8 row_mask:0xf bank_mask:0xc
    v_add_f32_dpp v196, v212, v212 row_ror:8 row_mask:0xf bank_mask:0xc
    v_add_f32_dpp v197, v213, v213 row_ror:8 row_mask:0xf bank_mask:0xc
    v_add_f32_dpp v198, v214, v214 row_ror:8 row_mask:0xf bank_mask:0xc
    v_add_f32_dpp v199, v215, v215 row_ror:8 row_mask:0xf bank_mask:0xc
    v_add_f32_dpp v184, v184, v184 row_half_mirror row_mask:0xf bank_mask:0x5
    v_add_f32_dpp v185, v185, v185 row_half_mirror row_mask:0xf bank_mask:0x5
    v_add_f32_dpp v186, v186, v186 row_half_mirror row_mask:0xf bank_mask:0x5
    v_add_f32_dpp v187, v187, v187 row_half_mirror row_mask:0xf bank_mask:0x5
    v_add_f32_dpp v188, v188, v188 row_half_mirror row_mask:0xf bank_mask:0x5
    v_add_f32_dpp v189, v189, v189 row_half_mirror row_mask:0xf bank_mask:0x5
    v_add_f32_dpp v190, v190, v190 row_half_mirror row_mask:0xf bank_mask:0x5
    v_add_f32_dpp v191, v191, v191 row_half_mirror row_mask:0xf bank_mask:0x5
    v_add_f32_dpp v184, v192, v192 row_half_mirror row_mask:0xf bank_mask:0xa
    v_add_f32_dpp v185, v193, v193 row_half_mirror row_mask:0xf bank_mask:0xa
    v_add_f32_dpp v186, v194, v194 row_half_mirror row_mask:0xf bank_mask:0xa
    v_add_f32_dpp v187, v195, v195 row_half_mirror row_mask:0xf bank_mask:0xa
    v_add_f32_dpp v188, v196, v196 row_half_mirror row_mask:0xf bank_mask:0xa
    v_add_f32_dpp v189, v197, v197 row_half_mirror row_mask:0xf bank_mask:0xa
    v_add_f32_dpp v190, v198, v198 row_half_mirror row_mask:0xf bank_mask:0xa
    v_add_f32_dpp v191, v199, v199 row_half_mirror row_mask:0xf bank_mask:0xa
    v_add_f32_dpp v184, v184, v184 quad_perm:[1,0,3,2] row_mask:0xf bank_mask:0xf
    v_add_f32_dpp v185, v185, v185 quad_perm:[1,0,3,2] row_mask:0xf bank_mask:0xf
    v_add_f32_dpp v186, v186, v186 quad_perm:[1,0,3,2] row_mask:0xf bank_mask:0xf
    v_add_f32_dpp v187, v187, v187 quad_perm:[1,0,3,2] row_mask:0xf bank_mask:0xf
    v_add_f32_dpp v188, v188, v188 quad_perm:[1,0,3,2] row_mask:0xf bank_mask:0xf
    v_add_f32_dpp v189, v189, v189 quad_perm:[1,0,3,2] row_mask:0xf bank_mask:0xf
    v_add_f32_dpp v190, v190, v190 quad_perm:[1,0,3,2] row_mask:0xf bank_mask:0xf
    v_add_f32_dpp v191, v191, v191 quad_perm:[1,0,3,2] row_mask:0xf bank_mask:0xf
    v_add_f32_dpp v184, v184, v184 quad_perm:[2,3,0,1] row_mask:0xf bank_mask:0xf
    v_add_f32_dpp v185, v185, v185 quad_perm:[2,3,0,1] row_mask:0xf bank_mask:0xf
    v_add_f32_dpp v186, v186, v186 quad_perm:[2,3,0,1] row_mask:0xf bank_mask:0xf
    v_add_f32_dpp v187, v187, v187 quad_perm:[2,3,0,1] row_mask:0xf bank_mask:0xf
    v_add_f32_dpp v188, v188, v188 quad_perm:[2,3,0,1] row_mask:0xf bank_mask:0xf
    v_add_f32_dpp v189, v189, v189 quad_perm:[2,3,0,1] row_mask:0xf bank_mask:0xf
    v_add_f32_dpp v190, v190, v190 quad_perm:[2,3,0,1] row_mask:0xf bank_mask:0xf
    v_add_f32_dpp v191, v191, v191 quad_perm:[2,3,0,1] row_mask:0xf bank_mask:0xf
    v_bfe_u32 v2, v1, 2, 2
    v_lshlrev_b32 v2, 7, v2
    v_lshl_add_u32 v2, v7, 4, v2
    s_add_u32 s60, s90, 137216
    v_add_u32 v2, s60, v2
    ds_write_b128 v2, v[184:187]
    ds_write_b128 v2, v[188:191] offset:64
    s_waitcnt lgkmcnt(0)
    s_barrier
    s_cmp_eq_u32 s56, 0
    s_cbranch_scc0 L_g3_37
    v_add_u32 v2, 137216, v9
    ds_read2st64_b32 v[92:93], v2 offset0:0 offset1:1
    ds_read2st64_b32 v[94:95], v2 offset0:2 offset1:3
    ds_read2st64_b32 v[96:97], v2 offset0:4 offset1:5
    ds_read2st64_b32 v[98:99], v2 offset0:6 offset1:7
    s_lshl_b32 s60, s58, 3
    s_add_u32 s60, s60, s59
    s_lshl_b32 s60, s60, 10
    s_add_u32 s60, s60, 524288
    s_waitcnt lgkmcnt(0)
    v_pk_add_f32 v[92:93], v[92:93], v[94:95]
    v_pk_add_f32 v[96:97], v[96:97], v[98:99]
    v_add_f32 v94, v93, v97
    v_add_f32 v92, v92, v96
    v_mov_b32 v93, s57
    v_mov_b32 v95, s57
    buffer_store_dwordx4 v[92:95], v5, s[36:39], s60 offen sc1
L_g3_37:
    s_lshl_b32 s91, s58, 13
    s_add_u32 s91, s91, 524288
    s_add_u32 s92, s91, 4096
    ds_read_b64_tr_b16 v[116:117], v8 offset:4224
    ds_read_b64_tr_b16 v[118:119], v8 offset:4736
    ds_read_b64_tr_b16 v[120:121], v8 offset:5280
    ds_read_b64_tr_b16 v[122:123], v8 offset:5792
    s_waitcnt vmcnt(46)
    v_mfma_f32_16x16x32_bf16 v[60:63], a[128:131], v[100:103], 0
    ds_read_b64_tr_b16 v[124:125], v8 offset:6336
    v_mfma_f32_16x16x32_bf16 v[76:79], a[192:195], v[100:103], 0
    ds_read_b64_tr_b16 v[126:127], v8 offset:6848
    v_mfma_f32_16x16x32_bf16 v[64:67], a[128:131], v[104:107], 0
    ds_read_b64_tr_b16 v[128:129], v8 offset:7392
    v_mfma_f32_16x16x32_bf16 v[80:83], a[192:195], v[104:107], 0
    ds_read_b64_tr_b16 v[130:131], v8 offset:7904
    v_mfma_f32_16x16x32_bf16 v[68:71], a[128:131], v[108:111], 0
    ds_read_b64_tr_b16 v[132:133], v8 offset:8448
    v_mfma_f32_16x16x32_bf16 v[84:87], a[192:195], v[108:111], 0
    ds_read_b64_tr_b16 v[134:135], v8 offset:8960
    v_mfma_f32_16x16x32_bf16 v[72:75], a[128:131], v[112:115], 0
    ds_read_b64_tr_b16 v[136:137], v8 offset:9504
    v_mfma_f32_16x16x32_bf16 v[88:91], a[192:195], v[112:115], 0
    ds_read_b64_tr_b16 v[138:139], v8 offset:10016
    s_waitcnt vmcnt(44)
    s_waitcnt lgkmcnt(10)
    v_mfma_f32_16x16x32_bf16 v[60:63], a[132:135], v[116:119], v[60:63]
    ds_read_b64_tr_b16 v[140:141], v8 offset:10560
    v_mfma_f32_16x16x32_bf16 v[76:79], a[196:199], v[116:119], v[76:79]
    ds_read_b64_tr_b16 v[142:143], v8 offset:11072
    s_waitcnt lgkmcnt(10)
    v_mfma_f32_16x16x32_bf16 v[64:67], a[132:135], v[120:123], v[64:67]
    ds_read_b64_tr_b16 v[144:145], v8 offset:11616
    v_mfma_f32_16x16x32_bf16 v[80:83], a[196:199], v[120:123], v[80:83]
    ds_read_b64_tr_b16 v[146:147], v8 offset:12128
    s_waitcnt lgkmcnt(10)
    v_mfma_f32_16x16x32_bf16 v[68:71], a[132:135], v[124:127], v[68:71]
    ds_read_b64_tr_b16 v[100:101], v8 offset:12672
    v_mfma_f32_16x16x32_bf16 v[84:87], a[196:199], v[124:127], v[84:87]
    ds_read_b64_tr_b16 v[102:103], v8 offset:13184
    s_waitcnt lgkmcnt(10)
    v_mfma_f32_16x16x32_bf16 v[72:75], a[132:135], v[128:131], v[72:75]
    ds_read_b64_tr_b16 v[104:105], v8 offset:13728
    v_mfma_f32_16x16x32_bf16 v[88:91], a[196:199], v[128:131], v[88:91]
    ds_read_b64_tr_b16 v[106:107], v8 offset:14240
    s_waitcnt vmcnt(42)
    s_waitcnt lgkmcnt(10)
    v_mfma_f32_16x16x32_bf16 v[60:63], a[136:139], v[132:135], v[60:63]
    ds_read_b64_tr_b16 v[108:109], v8 offset:14784
    v_mfma_f32_16x16x32_bf16 v[76:79], a[200:203], v[132:135], v[76:79]
    ds_read_b64_tr_b16 v[110:111], v8 offset:15296
    s_waitcnt lgkmcnt(10)
    v_mfma_f32_16x16x32_bf16 v[64:67], a[136:139], v[136:139], v[64:67]
    ds_read_b64_tr_b16 v[112:113], v8 offset:15840
    v_mfma_f32_16x16x32_bf16 v[80:83], a[200:203], v[136:139], v[80:83]
    ds_read_b64_tr_b16 v[114:115], v8 offset:16352
    s_waitcnt lgkmcnt(10)
    v_mfma_f32_16x16x32_bf16 v[68:71], a[136:139], v[140:143], v[68:71]
    ds_read_b64_tr_b16 v[116:117], v8 offset:16896
    v_mfma_f32_16x16x32_bf16 v[84:87], a[200:203], v[140:143], v[84:87]
    ds_read_b64_tr_b16 v[118:119], v8 offset:17408
    s_waitcnt lgkmcnt(10)
    v_mfma_f32_16x16x32_bf16 v[72:75], a[136:139], v[144:147], v[72:75]
    ds_read_b64_tr_b16 v[120:121], v8 offset:17952
    v_mfma_f32_16x16x32_bf16 v[88:91], a[200:203], v[144:147], v[88:91]
    ds_read_b64_tr_b16 v[122:123], v8 offset:18464
    s_waitcnt vmcnt(40)
    s_waitcnt lgkmcnt(10)
    v_mfma_f32_16x16x32_bf16 v[60:63], a[140:143], v[100:103], v[60:63]
    ds_read_b64_tr_b16 v[124:125], v8 offset:19008
    v_mfma_f32_16x16x32_bf16 v[76:79], a[204:207], v[100:103], v[76:79]
    ds_read_b64_tr_b16 v[126:127], v8 offset:19520
    s_waitcnt vmcnt(8)
    ds_read_b128 a[64:67], v242 offset:0
    s_waitcnt lgkmcnt(11)
    v_mfma_f32_16x16x32_bf16 v[64:67], a[140:143], v[104:107], v[64:67]
    ds_read_b64_tr_b16 v[128:129], v8 offset:20064
    v_mfma_f32_16x16x32_bf16 v[80:83], a[204:207], v[104:107], v[80:83]
    ds_read_b64_tr_b16 v[130:131], v8 offset:20576
    ds_read_b128 a[68:71], v242 offset:2048
    s_waitcnt lgkmcnt(12)
    v_mfma_f32_16x16x32_bf16 v[68:71], a[140:143], v[108:111], v[68:71]
    ds_read_b64_tr_b16 v[132:133], v8 offset:21120
    v_mfma_f32_16x16x32_bf16 v[84:87], a[204:207], v[108:111], v[84:87]
    ds_read_b64_tr_b16 v[134:135], v8 offset:21632
    ds_read_b128 a[72:75], v242 offset:4096
    s_waitcnt lgkmcnt(13)
    v_mfma_f32_16x16x32_bf16 v[72:75], a[140:143], v[112:115], v[72:75]
    ds_read_b64_tr_b16 v[136:137], v8 offset:22176
    v_mfma_f32_16x16x32_bf16 v[88:91], a[204:207], v[112:115], v[88:91]
    ds_read_b64_tr_b16 v[138:139], v8 offset:22688
    ds_read_b128 a[76:79], v242 offset:6144
    s_waitcnt lgkmcnt(14)
    v_mfma_f32_16x16x32_bf16 v[60:63], a[144:147], v[116:119], v[60:63]
    ds_read_b64_tr_b16 v[140:141], v8 offset:23232
    v_mfma_f32_16x16x32_bf16 v[76:79], a[208:211], v[116:119], v[76:79]
    ds_read_b64_tr_b16 v[142:143], v8 offset:23744
    ds_read_b128 a[80:83], v243 offset:0
    s_waitcnt lgkmcnt(15)
    v_mfma_f32_16x16x32_bf16 v[64:67], a[144:147], v[120:123], v[64:67]
    ds_read_b64_tr_b16 v[144:145], v8 offset:24288
    v_mfma_f32_16x16x32_bf16 v[80:83], a[208:211], v[120:123], v[80:83]
    ds_read_b64_tr_b16 v[146:147], v8 offset:24800
    ds_read_b128 a[84:87], v243 offset:2048
    s_waitcnt lgkmcnt(15)
    v_mfma_f32_16x16x32_bf16 v[68:71], a[144:147], v[124:127], v[68:71]
    ds_read_b64_tr_b16 v[100:101], v8 offset:25344
    v_mfma_f32_16x16x32_bf16 v[84:87], a[208:211], v[124:127], v[84:87]
    ds_read_b64_tr_b16 v[102:103], v8 offset:25856
    ds_read_b128 a[88:91], v243 offset:4096
    s_waitcnt lgkmcnt(15)
    v_mfma_f32_16x16x32_bf16 v[72:75], a[144:147], v[128:131], v[72:75]
    ds_read_b64_tr_b16 v[104:105], v8 offset:26400
    v_mfma_f32_16x16x32_bf16 v[88:91], a[208:211], v[128:131], v[88:91]
    ds_read_b64_tr_b16 v[106:107], v8 offset:26912
    ds_read_b128 a[92:95], v243 offset:6144
    s_waitcnt lgkmcnt(15)
    v_mfma_f32_16x16x32_bf16 v[60:63], a[148:151], v[132:135], v[60:63]
    ds_read_b64_tr_b16 v[108:109], v8 offset:27456
    v_mfma_f32_16x16x32_bf16 v[76:79], a[212:215], v[132:135], v[76:79]
    ds_read_b64_tr_b16 v[110:111], v8 offset:27968
    s_waitcnt lgkmcnt(2)
    s_add_u32 s101, s100, 4
    s_and_b32 s101, s101, 7
    s_lshl_b32 s101, s101, 7
    s_add_u32 s73, s94, s101
    s_add_u32 m0, s93, 0
    s_nop 0
    buffer_load_dwordx4 v244, s[44:47], s73 offen nt lds
    v_mfma_f32_16x16x32_bf16 v[64:67], a[148:151], v[136:139], v[64:67]
    ds_read_b64_tr_b16 v[112:113], v8 offset:28512
    v_mfma_f32_16x16x32_bf16 v[80:83], a[212:215], v[136:139], v[80:83]
    ds_read_b64_tr_b16 v[114:115], v8 offset:29024
    s_add_u32 s73, s94, s101
    s_add_u32 s73, s73, 32768
    s_add_u32 m0, s93, 1024
    s_nop 0
    buffer_load_dwordx4 v244, s[44:47], s73 offen nt lds
    v_mfma_f32_16x16x32_bf16 v[68:71], a[148:151], v[140:143], v[68:71]
    ds_read_b64_tr_b16 v[116:117], v8 offset:29568
    v_mfma_f32_16x16x32_bf16 v[84:87], a[212:215], v[140:143], v[84:87]
    ds_read_b64_tr_b16 v[118:119], v8 offset:30080
    s_add_u32 s73, s95, s101
    s_add_u32 m0, s93, 2048
    s_nop 0
    buffer_load_dwordx4 v244, s[44:47], s73 offen nt lds
    v_mfma_f32_16x16x32_bf16 v[72:75], a[148:151], v[144:147], v[72:75]
    ds_read_b64_tr_b16 v[120:121], v8 offset:30624
    v_mfma_f32_16x16x32_bf16 v[88:91], a[212:215], v[144:147], v[88:91]
    ds_read_b64_tr_b16 v[122:123], v8 offset:31136
    s_add_u32 s73, s95, s101
    s_add_u32 s73, s73, 32768
    s_add_u32 m0, s93, 3072
    s_nop 0
    buffer_load_dwordx4 v244, s[44:47], s73 offen nt lds
    ds_read_b128 v[184:187], v11 offset:0
    ds_read_b128 v[188:191], v11 offset:64
    ds_read_b128 v[192:195], v11 offset:128
    ds_read_b128 v[196:199], v11 offset:192
    ds_read_b128 v[200:203], v11 offset:256
    ds_read_b128 v[204:207], v11 offset:320
    ds_read_b128 v[208:211], v11 offset:384
    ds_read_b128 v[212:215], v11 offset:448
    v_mfma_f32_16x16x32_bf16 v[60:63], a[152:155], v[100:103], v[60:63]
    ds_read_b64_tr_b16 v[124:125], v8 offset:31680
    v_mfma_f32_16x16x32_bf16 v[76:79], a[216:219], v[100:103], v[76:79]
    ds_read_b64_tr_b16 v[126:127], v8 offset:32192
    s_add_u32 s73, s96, s101
    s_add_u32 m0, s93, 4096
    s_nop 0
    buffer_load_dwordx4 v244, s[44:47], s73 offen nt lds
    v_mfma_f32_16x16x32_bf16 v[64:67], a[152:155], v[104:107], v[64:67]
    ds_read_b64_tr_b16 v[128:129], v8 offset:32736
    v_mfma_f32_16x16x32_bf16 v[80:83], a[216:219], v[104:107], v[80:83]
    ds_read_b64_tr_b16 v[130:131], v8 offset:33248
    s_add_u32 s73, s96, s101
    s_add_u32 s73, s73, 32768
    s_add_u32 m0, s93, 5120
    s_nop 0
    buffer_load_dwordx4 v244, s[44:47], s73 offen nt lds
    s_waitcnt lgkmcnt(15)
    v_mfma_f32_16x16x32_bf16 v[68:71], a[152:155], v[108:111], v[68:71]
    ds_read_b64_tr_b16 v[132:133], v148 offset:0
    v_mfma_f32_16x16x32_bf16 v[84:87], a[216:219], v[108:111], v[84:87]
    ds_read_b64_tr_b16 v[134:135], v148 offset:512
    s_add_u32 s73, s97, s101
    s_add_u32 m0, s93, 6144
    s_nop 0
    buffer_load_dwordx4 v244, s[44:47], s73 offen nt lds
    v_mfma_f32_16x16x32_bf16 v[72:75], a[152:155], v[112:115], v[72:75]
    ds_read_b64_tr_b16 v[136:137], v148 offset:1056
    v_mfma_f32_16x16x32_bf16 v[88:91], a[216:219], v[112:115], v[88:91]
    ds_read_b64_tr_b16 v[138:139], v148 offset:1568
    s_add_u32 s73, s97, s101
    s_add_u32 s73, s73, 32768
    s_add_u32 m0, s93, 7168
    s_nop 0
    buffer_load_dwordx4 v244, s[44:47], s73 offen nt lds
    s_waitcnt lgkmcnt(15)
    v_mfma_f32_16x16x32_bf16 v[60:63], a[156:159], v[116:119], v[60:63]
    ds_read_b64_tr_b16 v[140:141], v148 offset:2112
    v_mfma_f32_16x16x32_bf16 v[76:79], a[220:223], v[116:119], v[76:79]
    ds_read_b64_tr_b16 v[142:143], v148 offset:2624
    s_waitcnt vmcnt(8)
    ds_read_b128 a[96:99], v242 offset:8192
    v_mfma_f32_16x16x32_bf16 v[64:67], a[156:159], v[120:123], v[64:67]
    ds_read_b64_tr_b16 v[144:145], v148 offset:3168
    v_mfma_f32_16x16x32_bf16 v[80:83], a[220:223], v[120:123], v[80:83]
    ds_read_b64_tr_b16 v[146:147], v148 offset:3680
    ds_read_b128 a[100:103], v242 offset:10240
    s_waitcnt lgkmcnt(12)
    v_mfma_f32_16x16x32_bf16 v[68:71], a[156:159], v[124:127], v[68:71]
    ds_read_b64_tr_b16 v[100:101], v148 offset:4224
    v_mfma_f32_16x16x32_bf16 v[84:87], a[220:223], v[124:127], v[84:87]
    ds_read_b64_tr_b16 v[102:103], v148 offset:4736
    ds_read_b128 a[104:107], v242 offset:12288
    s_waitcnt lgkmcnt(13)
    v_mfma_f32_16x16x32_bf16 v[72:75], a[156:159], v[128:131], v[72:75]
    ds_read_b64_tr_b16 v[104:105], v148 offset:5280
    v_mfma_f32_16x16x32_bf16 v[88:91], a[220:223], v[128:131], v[88:91]
    ds_read_b64_tr_b16 v[106:107], v148 offset:5792
    ds_read_b128 a[108:111], v242 offset:14336
    v_mfma_f32_16x16x32_bf16 v[20:23], a[128:131], v[184:187], 0
    v_mfma_f32_16x16x32_bf16 v[24:27], a[192:195], v[184:187], 0
    v_mfma_f32_16x16x32_bf16 v[20:23], a[132:135], v[188:191], v[20:23]
    v_mfma_f32_16x16x32_bf16 v[24:27], a[196:199], v[188:191], v[24:27]
    v_mfma_f32_16x16x32_bf16 v[20:23], a[136:139], v[192:195], v[20:23]
    v_mfma_f32_16x16x32_bf16 v[24:27], a[200:203], v[192:195], v[24:27]
    v_mfma_f32_16x16x32_bf16 v[20:23], a[140:143], v[196:199], v[20:23]
    v_mfma_f32_16x16x32_bf16 v[24:27], a[204:207], v[196:199], v[24:27]
    v_mfma_f32_16x16x32_bf16 v[20:23], a[144:147], v[200:203], v[20:23]
    v_mfma_f32_16x16x32_bf16 v[24:27], a[208:211], v[200:203], v[24:27]
    v_mfma_f32_16x16x32_bf16 v[20:23], a[148:151], v[204:207], v[20:23]
    v_mfma_f32_16x16x32_bf16 v[24:27], a[212:215], v[204:207], v[24:27]
    v_mfma_f32_16x16x32_bf16 v[20:23], a[152:155], v[208:211], v[20:23]
    v_mfma_f32_16x16x32_bf16 v[24:27], a[216:219], v[208:211], v[24:27]
    v_mfma_f32_16x16x32_bf16 v[20:23], a[156:159], v[212:215], v[20:23]
    v_mfma_f32_16x16x32_bf16 v[24:27], a[220:223], v[212:215], v[24:27]
    s_waitcnt lgkmcnt(14)
    v_mfma_f32_16x16x32_bf16 v[60:63], a[160:163], v[132:135], v[60:63]
    ds_read_b64_tr_b16 v[108:109], v148 offset:6336
    v_mfma_f32_16x16x32_bf16 v[76:79], a[224:227], v[132:135], v[76:79]
    ds_read_b64_tr_b16 v[110:111], v148 offset:6848
    ds_read_b128 a[112:115], v243 offset:8192
    s_waitcnt lgkmcnt(15)
    v_mfma_f32_16x16x32_bf16 v[64:67], a[160:163], v[136:139], v[64:67]
    ds_read_b64_tr_b16 v[112:113], v148 offset:7392
    v_mfma_f32_16x16x32_bf16 v[80:83], a[224:227], v[136:139], v[80:83]
    ds_read_b64_tr_b16 v[114:115], v148 offset:7904
    ds_read_b128 a[116:119], v243 offset:10240
    s_waitcnt lgkmcnt(15)
    v_mfma_f32_16x16x32_bf16 v[68:71], a[160:163], v[140:143], v[68:71]
    ds_read_b64_tr_b16 v[116:117], v148 offset:8448
    v_mfma_f32_16x16x32_bf16 v[84:87], a[224:227], v[140:143], v[84:87]
    ds_read_b64_tr_b16 v[118:119], v148 offset:8960
    ds_read_b128 a[120:123], v243 offset:12288
    s_waitcnt lgkmcnt(15)
    v_mfma_f32_16x16x32_bf16 v[72:75], a[160:163], v[144:147], v[72:75]
    ds_read_b64_tr_b16 v[120:121], v148 offset:9504
    v_mfma_f32_16x16x32_bf16 v[88:91], a[224:227], v[144:147], v[88:91]
    ds_read_b64_tr_b16 v[122:123], v148 offset:10016
    ds_read_b128 a[124:127], v243 offset:14336
    s_waitcnt lgkmcnt(15)
    v_mfma_f32_16x16x32_bf16 v[60:63], a[164:167], v[100:103], v[60:63]
    ds_read_b64_tr_b16 v[124:125], v148 offset:10560
    v_mfma_f32_16x16x32_bf16 v[76:79], a[228:231], v[100:103], v[76:79]
    ds_read_b64_tr_b16 v[126:127], v148 offset:11072
    s_waitcnt lgkmcnt(2)
    s_add_u32 s101, s100, 5
    s_and_b32 s101, s101, 7
    s_lshl_b32 s101, s101, 7
    s_add_u32 s73, s94, s101
    s_add_u32 m0, s93, 8192
    s_nop 0
    buffer_load_dwordx4 v244, s[44:47], s73 offen nt lds
    v_mfma_f32_16x16x32_bf16 v[64:67], a[164:167], v[104:107], v[64:67]
    ds_read_b64_tr_b16 v[128:129], v148 offset:11616
    v_mfma_f32_16x16x32_bf16 v[80:83], a[228:231], v[104:107], v[80:83]
    ds_read_b64_tr_b16 v[130:131], v148 offset:12128
    s_add_u32 s73, s94, s101
    s_add_u32 s73, s73, 32768
    s_add_u32 m0, s93, 9216
    s_nop 0
    buffer_load_dwordx4 v244, s[44:47], s73 offen nt lds
    v_mfma_f32_16x16x32_bf16 v[68:71], a[164:167], v[108:111], v[68:71]
    ds_read_b64_tr_b16 v[132:133], v148 offset:12672
    v_mfma_f32_16x16x32_bf16 v[84:87], a[228:231], v[108:111], v[84:87]
    ds_read_b64_tr_b16 v[134:135], v148 offset:13184
    s_add_u32 s73, s95, s101
    s_add_u32 m0, s93, 10240
    s_nop 0
    buffer_load_dwordx4 v244, s[44:47], s73 offen nt lds
    v_mfma_f32_16x16x32_bf16 v[72:75], a[164:167], v[112:115], v[72:75]
    ds_read_b64_tr_b16 v[136:137], v148 offset:13728
    v_mfma_f32_16x16x32_bf16 v[88:91], a[228:231], v[112:115], v[88:91]
    ds_read_b64_tr_b16 v[138:139], v148 offset:14240
    s_add_u32 s73, s95, s101
    s_add_u32 s73, s73, 32768
    s_add_u32 m0, s93, 11264
    s_nop 0
    buffer_load_dwordx4 v244, s[44:47], s73 offen nt lds
    v_mfma_f32_16x16x32_bf16 v[60:63], a[168:171], v[116:119], v[60:63]
    ds_read_b64_tr_b16 v[140:141], v148 offset:14784
    v_mfma_f32_16x16x32_bf16 v[76:79], a[232:235], v[116:119], v[76:79]
    ds_read_b64_tr_b16 v[142:143], v148 offset:15296
    s_add_u32 s73, s96, s101
    s_add_u32 m0, s93, 12288
    s_nop 0
    buffer_load_dwordx4 v244, s[44:47], s73 offen nt lds
    v_mfma_f32_16x16x32_bf16 v[64:67], a[168:171], v[120:123], v[64:67]
    ds_read_b64_tr_b16 v[144:145], v148 offset:15840
    v_mfma_f32_16x16x32_bf16 v[80:83], a[232:235], v[120:123], v[80:83]
    ds_read_b64_tr_b16 v[146:147], v148 offset:16352
    s_add_u32 s73, s96, s101
    s_add_u32 s73, s73, 32768
    s_add_u32 m0, s93, 13312
    s_nop 0
    buffer_load_dwordx4 v244, s[44:47], s73 offen nt lds
    s_waitcnt lgkmcnt(10)
    v_mfma_f32_16x16x32_bf16 v[68:71], a[168:171], v[124:127], v[68:71]
    ds_read_b64_tr_b16 v[100:101], v148 offset:16896
    v_mfma_f32_16x16x32_bf16 v[84:87], a[232:235], v[124:127], v[84:87]
    ds_read_b64_tr_b16 v[102:103], v148 offset:17408
    s_add_u32 s73, s97, s101
    s_add_u32 m0, s93, 14336
    s_nop 0
    buffer_load_dwordx4 v244, s[44:47], s73 offen nt lds
    s_waitcnt lgkmcnt(10)
    v_mfma_f32_16x16x32_bf16 v[72:75], a[168:171], v[128:131], v[72:75]
    ds_read_b64_tr_b16 v[104:105], v148 offset:17952
    v_mfma_f32_16x16x32_bf16 v[88:91], a[232:235], v[128:131], v[88:91]
    ds_read_b64_tr_b16 v[106:107], v148 offset:18464
    s_add_u32 s73, s97, s101
    s_add_u32 s73, s73, 32768
    s_add_u32 m0, s93, 15360
    s_nop 0
    buffer_load_dwordx4 v244, s[44:47], s73 offen nt lds
    s_waitcnt lgkmcnt(10)
    v_mfma_f32_16x16x32_bf16 v[60:63], a[172:175], v[132:135], v[60:63]
    ds_read_b64_tr_b16 v[108:109], v148 offset:19008
    v_mfma_f32_16x16x32_bf16 v[76:79], a[236:239], v[132:135], v[76:79]
    ds_read_b64_tr_b16 v[110:111], v148 offset:19520
    s_waitcnt lgkmcnt(10)
    v_mfma_f32_16x16x32_bf16 v[64:67], a[172:175], v[136:139], v[64:67]
    ds_read_b64_tr_b16 v[112:113], v148 offset:20064
    v_mfma_f32_16x16x32_bf16 v[80:83], a[236:239], v[136:139], v[80:83]
    ds_read_b64_tr_b16 v[114:115], v148 offset:20576
    s_waitcnt lgkmcnt(10)
    v_mfma_f32_16x16x32_bf16 v[68:71], a[172:175], v[140:143], v[68:71]
    ds_read_b64_tr_b16 v[116:117], v148 offset:21120
    v_mfma_f32_16x16x32_bf16 v[84:87], a[236:239], v[140:143], v[84:87]
    ds_read_b64_tr_b16 v[118:119], v148 offset:21632
    s_waitcnt lgkmcnt(10)
    v_mfma_f32_16x16x32_bf16 v[72:75], a[172:175], v[144:147], v[72:75]
    ds_read_b64_tr_b16 v[120:121], v148 offset:22176
    v_mfma_f32_16x16x32_bf16 v[88:91], a[236:239], v[144:147], v[88:91]
    ds_read_b64_tr_b16 v[122:123], v148 offset:22688
    s_waitcnt lgkmcnt(10)
    v_mfma_f32_16x16x32_bf16 v[60:63], a[176:179], v[100:103], v[60:63]
    ds_read_b64_tr_b16 v[124:125], v148 offset:23232
    v_mfma_f32_16x16x32_bf16 v[76:79], a[240:243], v[100:103], v[76:79]
    ds_read_b64_tr_b16 v[126:127], v148 offset:23744
    buffer_load_dwordx4 v[152:155], v5, s[36:39], s91 offen offset:0 sc1
    s_waitcnt lgkmcnt(10)
    v_mfma_f32_16x16x32_bf16 v[64:67], a[176:179], v[104:107], v[64:67]
    ds_read_b64_tr_b16 v[128:129], v148 offset:24288
    v_mfma_f32_16x16x32_bf16 v[80:83], a[240:243], v[104:107], v[80:83]
    ds_read_b64_tr_b16 v[130:131], v148 offset:24800
    buffer_load_dwordx4 v[156:159], v5, s[36:39], s91 offen offset:1024 sc1
    s_waitcnt lgkmcnt(10)
    v_mfma_f32_16x16x32_bf16 v[68:71], a[176:179], v[108:111], v[68:71]
    ds_read_b64_tr_b16 v[132:133], v148 offset:25344
    v_mfma_f32_16x16x32_bf16 v[84:87], a[240:243], v[108:111], v[84:87]
    ds_read_b64_tr_b16 v[134:135], v148 offset:25856
    buffer_load_dwordx4 v[160:163], v5, s[36:39], s91 offen offset:2048 sc1
    s_waitcnt lgkmcnt(10)
    v_mfma_f32_16x16x32_bf16 v[72:75], a[176:179], v[112:115], v[72:75]
    ds_read_b64_tr_b16 v[136:137], v148 offset:26400
    v_mfma_f32_16x16x32_bf16 v[88:91], a[240:243], v[112:115], v[88:91]
    ds_read_b64_tr_b16 v[138:139], v148 offset:26912
    buffer_load_dwordx4 v[164:167], v5, s[36:39], s91 offen offset:3072 sc1
    s_waitcnt lgkmcnt(10)
    v_mfma_f32_16x16x32_bf16 v[60:63], a[180:183], v[116:119], v[60:63]
    ds_read_b64_tr_b16 v[140:141], v148 offset:27456
    v_mfma_f32_16x16x32_bf16 v[76:79], a[244:247], v[116:119], v[76:79]
    ds_read_b64_tr_b16 v[142:143], v148 offset:27968
    buffer_load_dwordx4 v[168:171], v5, s[36:39], s92 offen offset:0 sc1
    s_waitcnt lgkmcnt(10)
    v_mfma_f32_16x16x32_bf16 v[64:67], a[180:183], v[120:123], v[64:67]
    ds_read_b64_tr_b16 v[144:145], v148 offset:28512
    v_mfma_f32_16x16x32_bf16 v[80:83], a[244:247], v[120:123], v[80:83]
    ds_read_b64_tr_b16 v[146:147], v148 offset:29024
    buffer_load_dwordx4 v[172:175], v5, s[36:39], s92 offen offset:1024 sc1
    s_waitcnt lgkmcnt(10)
    v_mfma_f32_16x16x32_bf16 v[68:71], a[180:183], v[124:127], v[68:71]
    ds_read_b64_tr_b16 v[100:101], v148 offset:29568
    v_mfma_f32_16x16x32_bf16 v[84:87], a[244:247], v[124:127], v[84:87]
    ds_read_b64_tr_b16 v[102:103], v148 offset:30080
    buffer_load_dwordx4 v[176:179], v5, s[36:39], s92 offen offset:2048 sc1
    s_waitcnt lgkmcnt(10)
    v_mfma_f32_16x16x32_bf16 v[72:75], a[180:183], v[128:131], v[72:75]
    ds_read_b64_tr_b16 v[104:105], v148 offset:30624
    v_mfma_f32_16x16x32_bf16 v[88:91], a[244:247], v[128:131], v[88:91]
    ds_read_b64_tr_b16 v[106:107], v148 offset:31136
    buffer_load_dwordx4 v[180:183], v5, s[36:39], s92 offen offset:3072 sc1
    ds_read_b128 v[184:187], v11 offset:512
    ds_read_b128 v[188:191], v11 offset:576
    ds_read_b128 v[192:195], v11 offset:640
    ds_read_b128 v[196:199], v11 offset:704
    ds_read_b128 v[200:203], v11 offset:768
    ds_read_b128 v[204:207], v11 offset:832
    ds_read_b128 v[208:211], v11 offset:896
    ds_read_b128 v[212:215], v11 offset:960
    s_waitcnt lgkmcnt(15)
    v_mfma_f32_16x16x32_bf16 v[60:63], a[184:187], v[132:135], v[60:63]
    ds_read_b64_tr_b16 v[108:109], v148 offset:31680
    v_mfma_f32_16x16x32_bf16 v[76:79], a[248:251], v[132:135], v[76:79]
    ds_read_b64_tr_b16 v[110:111], v148 offset:32192
    v_mfma_f32_16x16x32_bf16 v[64:67], a[184:187], v[136:139], v[64:67]
    ds_read_b64_tr_b16 v[112:113], v148 offset:32736
    v_mfma_f32_16x16x32_bf16 v[80:83], a[248:251], v[136:139], v[80:83]
    ds_read_b64_tr_b16 v[114:115], v148 offset:33248
    s_waitcnt lgkmcnt(15)
    v_mfma_f32_16x16x32_bf16 v[68:71], a[184:187], v[140:143], v[68:71]
    v_mfma_f32_16x16x32_bf16 v[84:87], a[248:251], v[140:143], v[84:87]
    v_mfma_f32_16x16x32_bf16 v[72:75], a[184:187], v[144:147], v[72:75]
    v_mfma_f32_16x16x32_bf16 v[88:91], a[248:251], v[144:147], v[88:91]
    s_waitcnt lgkmcnt(14)
    v_mfma_f32_16x16x32_bf16 v[60:63], a[188:191], v[100:103], v[60:63]
    v_mfma_f32_16x16x32_bf16 v[76:79], a[252:255], v[100:103], v[76:79]
    s_waitcnt lgkmcnt(12)
    v_mfma_f32_16x16x32_bf16 v[64:67], a[188:191], v[104:107], v[64:67]
    v_mfma_f32_16x16x32_bf16 v[80:83], a[252:255], v[104:107], v[80:83]
    s_waitcnt lgkmcnt(2)
    v_mfma_f32_16x16x32_bf16 v[68:71], a[188:191], v[108:111], v[68:71]
    v_mfma_f32_16x16x32_bf16 v[84:87], a[252:255], v[108:111], v[84:87]
    s_waitcnt lgkmcnt(0)
    v_mfma_f32_16x16x32_bf16 v[72:75], a[188:191], v[112:115], v[72:75]
    v_mfma_f32_16x16x32_bf16 v[88:91], a[252:255], v[112:115], v[88:91]
    v_mfma_f32_16x16x32_bf16 v[20:23], a[160:163], v[184:187], v[20:23]
    v_mfma_f32_16x16x32_bf16 v[24:27], a[224:227], v[184:187], v[24:27]
    v_mfma_f32_16x16x32_bf16 v[20:23], a[164:167], v[188:191], v[20:23]
    v_mfma_f32_16x16x32_bf16 v[24:27], a[228:231], v[188:191], v[24:27]
    v_mfma_f32_16x16x32_bf16 v[20:23], a[168:171], v[192:195], v[20:23]
    v_mfma_f32_16x16x32_bf16 v[24:27], a[232:235], v[192:195], v[24:27]
    v_mfma_f32_16x16x32_bf16 v[20:23], a[172:175], v[196:199], v[20:23]
    v_mfma_f32_16x16x32_bf16 v[24:27], a[236:239], v[196:199], v[24:27]
    v_mfma_f32_16x16x32_bf16 v[20:23], a[176:179], v[200:203], v[20:23]
    v_mfma_f32_16x16x32_bf16 v[24:27], a[240:243], v[200:203], v[24:27]
    v_mfma_f32_16x16x32_bf16 v[20:23], a[180:183], v[204:207], v[20:23]
    v_mfma_f32_16x16x32_bf16 v[24:27], a[244:247], v[204:207], v[24:27]
    v_mfma_f32_16x16x32_bf16 v[20:23], a[184:187], v[208:211], v[20:23]
    v_mfma_f32_16x16x32_bf16 v[24:27], a[248:251], v[208:211], v[24:27]
    v_mfma_f32_16x16x32_bf16 v[20:23], a[188:191], v[212:215], v[20:23]
    v_mfma_f32_16x16x32_bf16 v[24:27], a[252:255], v[212:215], v[24:27]
    v_and_b32 v2, 1, v7
    v_lshlrev_b32 v151, 9, v2
    v_lshrrev_b32 v2, 1, v7
    v_lshl_add_u32 v151, v2, 8, v151
    v_lshl_add_u32 v151, v6, 4, v151
    s_mul_i32 s64, s58, 14
    s_lshl_b32 s65, s56, 1
    s_add_u32 s64, s64, s65
    s_lshl_b32 s64, s64, 10
    s_mul_i32 s65, s59, 459776
    s_add_u32 s64, s64, s65
    s_add_u32 s64, s64, 9437184
    s_add_u32 s65, s64, 7168
    s_add_u32 s66, s64, 1024
    s_add_u32 s67, s65, 1024
    s_cmp_eq_u32 s56, 3
    s_cselect_b32 s66, 1073741824, s66
    s_cselect_b32 s67, 1073741824, s67
    s_mov_b32 s78, 0
    s_waitcnt vmcnt(0)
    s_branch L_pcs3_39
L_polls3_38:
    buffer_load_dwordx4 v[152:155], v5, s[36:39], s91 offen offset:0 sc1
    buffer_load_dwordx4 v[156:159], v5, s[36:39], s91 offen offset:1024 sc1
    buffer_load_dwordx4 v[160:163], v5, s[36:39], s91 offen offset:2048 sc1
    buffer_load_dwordx4 v[164:167], v5, s[36:39], s91 offen offset:3072 sc1
    buffer_load_dwordx4 v[168:171], v5, s[36:39], s92 offen offset:0 sc1
    buffer_load_dwordx4 v[172:175], v5, s[36:39], s92 offen offset:1024 sc1
    buffer_load_dwordx4 v[176:179], v5, s[36:39], s92 offen offset:2048 sc1
    buffer_load_dwordx4 v[180:183], v5, s[36:39], s92 offen offset:3072 sc1
    s_waitcnt vmcnt(0)
L_pcs3_39:
    v_xor_b32 v2, s57, v153
    v_xor_b32 v3, s57, v155
    v_or_b32 v2, v2, v3
    v_xor_b32 v3, s57, v157
    v_or_b32 v2, v2, v3
    v_xor_b32 v3, s57, v159
    v_or_b32 v2, v2, v3
    v_xor_b32 v3, s57, v161
    v_or_b32 v2, v2, v3
    v_xor_b32 v3, s57, v163
    v_or_b32 v2, v2, v3
    v_xor_b32 v3, s57, v165
    v_or_b32 v2, v2, v3
    v_xor_b32 v3, s57, v167
    v_or_b32 v2, v2, v3
    v_xor_b32 v3, s57, v169
    v_or_b32 v2, v2, v3
    v_xor_b32 v3, s57, v171
    v_or_b32 v2, v2, v3
    v_xor_b32 v3, s57, v173
    v_or_b32 v2, v2, v3
    v_xor_b32 v3, s57, v175
    v_or_b32 v2, v2, v3
    v_xor_b32 v3, s57, v177
    v_or_b32 v2, v2, v3
    v_xor_b32 v3, s57, v179
    v_or_b32 v2, v2, v3
    v_xor_b32 v3, s57, v181
    v_or_b32 v2, v2, v3
    v_xor_b32 v3, s57, v183
    v_or_b32 v2, v2, v3
    v_cmp_ne_u32 vcc, 0, v2
    s_cbranch_vccz L_pds3_40
    s_add_u32 s78, s78, 1
    s_cmp_gt_u32 s78, 200000
    s_cbranch_scc1 L_pds3_40
    s_sleep 2
    s_branch L_polls3_38
L_pds3_40:
    v_add_f32 v152, v152, v168
    v_add_f32 v154, v154, v170
    v_add_f32 v156, v156, v172
    v_add_f32 v158, v158, v174
    v_add_f32 v160, v160, v176
    v_add_f32 v162, v162, v178
    v_add_f32 v164, v164, v180
    v_add_f32 v166, v166, v182
    v_add_f32 v152, v152, v160
    v_add_f32 v154, v154, v162
    v_add_f32 v156, v156, v164
    v_add_f32 v158, v158, v166
    v_add_f32 v152, v152, v156
    v_add_f32 v154, v154, v158
    v_mul_f32 v152, -0.001116071429, v152
    v_mul_f32 v154, 0.001116071429, v154
    v_fma_f32 v154, -v152, v152, v154
    v_max_f32 v154, 0, v154
    v_add_f32 v154, 1e-5, v154
    v_rsq_f32 v156, v154
    s_nop 0
    v_mul_f32 v157, v152, v156
    v_add_u32 v2, 4096, v149
    ds_write2st64_b32 v2, v156, v157 offset0:0 offset1:1
    s_waitcnt lgkmcnt(0)
    ds_read_b128 v[152:155], v150 offset:4096
    ds_read_b128 v[168:171], v150 offset:4352
    ds_read_b128 v[156:159], v150 offset:4160
    ds_read_b128 v[172:175], v150 offset:4416
    ds_read_b128 v[160:163], v150 offset:4224
    ds_read_b128 v[176:179], v150 offset:4480
    ds_read_b128 v[164:167], v150 offset:4288
    ds_read_b128 v[180:183], v150 offset:4544
    s_waitcnt lgkmcnt(0)
    v_pk_fma_f32 v[28:29], v[28:29], v[152:153], v[168:169]
    v_pk_fma_f32 v[30:31], v[30:31], v[154:155], v[170:171]
    v_pk_fma_f32 v[32:33], v[32:33], v[156:157], v[172:173]
    v_pk_fma_f32 v[34:35], v[34:35], v[158:159], v[174:175]
    v_pk_fma_f32 v[36:37], v[36:37], v[160:161], v[176:177]
    v_pk_fma_f32 v[38:39], v[38:39], v[162:163], v[178:179]
    v_pk_fma_f32 v[40:41], v[40:41], v[164:165], v[180:181]
    v_pk_fma_f32 v[42:43], v[42:43], v[166:167], v[182:183]
    v_cvt_pk_bf16_f32 v216, v28, v29
    v_cvt_pk_bf16_f32 v217, v30, v31
    v_cvt_pk_bf16_f32 v218, v32, v33
    v_cvt_pk_bf16_f32 v219, v34, v35
    v_cvt_pk_bf16_f32 v220, v36, v37
    v_cvt_pk_bf16_f32 v221, v38, v39
    v_cvt_pk_bf16_f32 v222, v40, v41
    v_cvt_pk_bf16_f32 v223, v42, v43
    v_permlane16_swap_b32 v216, v218
    v_permlane16_swap_b32 v217, v219
    buffer_store_dwordx4 v[216:219], v151, s[36:39], s64 offen sc1
    v_permlane16_swap_b32 v220, v222
    v_permlane16_swap_b32 v221, v223
    buffer_store_dwordx4 v[220:223], v151, s[36:39], s65 offen sc1
    v_pk_fma_f32 v[44:45], v[44:45], v[152:153], v[168:169]
    v_pk_fma_f32 v[46:47], v[46:47], v[154:155], v[170:171]
    v_pk_fma_f32 v[48:49], v[48:49], v[156:157], v[172:173]
    v_pk_fma_f32 v[50:51], v[50:51], v[158:159], v[174:175]
    v_pk_fma_f32 v[52:53], v[52:53], v[160:161], v[176:177]
    v_pk_fma_f32 v[54:55], v[54:55], v[162:163], v[178:179]
    v_pk_fma_f32 v[56:57], v[56:57], v[164:165], v[180:181]
    v_pk_fma_f32 v[58:59], v[58:59], v[166:167], v[182:183]
    v_cvt_pk_bf16_f32 v224, v44, v45
    v_cvt_pk_bf16_f32 v225, v46, v47
    v_cvt_pk_bf16_f32 v226, v48, v49
    v_cvt_pk_bf16_f32 v227, v50, v51
    v_cvt_pk_bf16_f32 v228, v52, v53
    v_cvt_pk_bf16_f32 v229, v54, v55
    v_cvt_pk_bf16_f32 v230, v56, v57
    v_cvt_pk_bf16_f32 v231, v58, v59
    v_permlane16_swap_b32 v224, v226
    v_permlane16_swap_b32 v225, v227
    buffer_store_dwordx4 v[224:227], v151, s[36:39], s66 offen sc1
    v_permlane16_swap_b32 v228, v230
    v_permlane16_swap_b32 v229, v231
    buffer_store_dwordx4 v[228:231], v151, s[36:39], s67 offen sc1
    ds_read_b128 a[128:131], v242 offset:0
    ds_read_b128 a[132:135], v242 offset:2048
    ds_read_b128 a[136:139], v242 offset:4096
    ds_read_b128 a[140:143], v242 offset:6144
    ds_read_b128 a[144:147], v243 offset:0
    ds_read_b128 a[148:151], v243 offset:2048
    ds_read_b128 a[152:155], v243 offset:4096
    ds_read_b128 a[156:159], v243 offset:6144
    ds_read_b128 a[160:163], v242 offset:8192
    ds_read_b128 a[164:167], v242 offset:10240
    ds_read_b128 a[168:171], v242 offset:12288
    ds_read_b128 a[172:175], v242 offset:14336
    ds_read_b128 a[176:179], v243 offset:8192
    ds_read_b128 a[180:183], v243 offset:10240
    ds_read_b128 a[184:187], v243 offset:12288
    ds_read_b128 a[188:191], v243 offset:14336
    v_lshlrev_b32 v2, 2, v6
    s_add_u32 s60, s90, 135168
    v_add_u32 v2, s60, v2
    ds_read_b32 v152, v2 offset:0
    ds_read_b32 v156, v2 offset:256
    ds_read_b32 v153, v2 offset:64
    ds_read_b32 v157, v2 offset:320
    ds_read_b32 v154, v2 offset:128
    ds_read_b32 v158, v2 offset:384
    ds_read_b32 v155, v2 offset:192
    ds_read_b32 v159, v2 offset:448
    v_mov_b32_dpp v100, v20 quad_perm:[0,0,2,2] row_mask:0xf bank_mask:0xf
    v_mov_b32_dpp v108, v20 quad_perm:[1,1,3,3] row_mask:0xf bank_mask:0xf
    v_mov_b32_dpp v101, v21 quad_perm:[0,0,2,2] row_mask:0xf bank_mask:0xf
    v_mov_b32_dpp v109, v21 quad_perm:[1,1,3,3] row_mask:0xf bank_mask:0xf
    v_mov_b32_dpp v102, v22 quad_perm:[0,0,2,2] row_mask:0xf bank_mask:0xf
    v_mov_b32_dpp v110, v22 quad_perm:[1,1,3,3] row_mask:0xf bank_mask:0xf
    v_mov_b32_dpp v103, v23 quad_perm:[0,0,2,2] row_mask:0xf bank_mask:0xf
    v_mov_b32_dpp v111, v23 quad_perm:[1,1,3,3] row_mask:0xf bank_mask:0xf
    v_mov_b32_dpp v104, v24 quad_perm:[0,0,2,2] row_mask:0xf bank_mask:0xf
    v_mov_b32_dpp v112, v24 quad_perm:[1,1,3,3] row_mask:0xf bank_mask:0xf
    v_mov_b32_dpp v105, v25 quad_perm:[0,0,2,2] row_mask:0xf bank_mask:0xf
    v_mov_b32_dpp v113, v25 quad_perm:[1,1,3,3] row_mask:0xf bank_mask:0xf
    v_mov_b32_dpp v106, v26 quad_perm:[0,0,2,2] row_mask:0xf bank_mask:0xf
    v_mov_b32_dpp v114, v26 quad_perm:[1,1,3,3] row_mask:0xf bank_mask:0xf
    v_mov_b32_dpp v107, v27 quad_perm:[0,0,2,2] row_mask:0xf bank_mask:0xf
    v_mov_b32_dpp v115, v27 quad_perm:[1,1,3,3] row_mask:0xf bank_mask:0xf
    s_lshl_b32 s60, s59, 5
    s_add_u32 s60, s60, s58
    s_lshl_b32 s60, s60, 2
    s_add_u32 s60, s60, s56
    s_lshl_b32 s60, s60, 6
    s_add_u32 s60, s60, 196608
    s_waitcnt lgkmcnt(0)
    s_lshl_b32 s61, s56, 12
    s_add_u32 s61, s61, 145408
    v_add_u32 v151, s61, v8
    s_waitcnt vmcnt(0)
    v_mov_b32 v2, s57
    s_mov_b64 exec, 1
    buffer_store_dword v2, v4, s[36:39], s60 offen sc1
    s_mov_b64 exec, -1
    v_pk_fma_f32 v[184:185], v[100:101], v[156:157], v[108:109] op_sel:[0,0,0] op_sel_hi:[1,0,1]
    v_pk_fma_f32 v[186:187], v[102:103], v[156:157], v[110:111] op_sel:[0,0,0] op_sel_hi:[1,0,1]
    v_pk_fma_f32 v[188:189], v[100:101], v[156:157], v[108:109] op_sel:[0,1,0] op_sel_hi:[1,1,1]
    v_pk_fma_f32 v[190:191], v[102:103], v[156:157], v[110:111] op_sel:[0,1,0] op_sel_hi:[1,1,1]
    v_pk_fma_f32 v[192:193], v[100:101], v[158:159], v[108:109] op_sel:[0,0,0] op_sel_hi:[1,0,1]
    s_add_u32 s101, s100, 6
    s_and_b32 s101, s101, 7
    s_lshl_b32 s101, s101, 7
    s_add_u32 s73, s94, s101
    s_add_u32 m0, s93, 0
    s_nop 0
    buffer_load_dwordx4 v244, s[44:47], s73 offen nt lds
    v_pk_fma_f32 v[194:195], v[102:103], v[158:159], v[110:111] op_sel:[0,0,0] op_sel_hi:[1,0,1]
    v_pk_fma_f32 v[196:197], v[100:101], v[158:159], v[108:109] op_sel:[0,1,0] op_sel_hi:[1,1,1]
    v_pk_fma_f32 v[198:199], v[102:103], v[158:159], v[110:111] op_sel:[0,1,0] op_sel_hi:[1,1,1]
    v_pk_fma_f32 v[60:61], v[60:61], v[152:153], v[184:185] op_sel:[0,0,0] op_sel_hi:[1,0,1]
    v_pk_fma_f32 v[62:63], v[62:63], v[152:153], v[186:187] op_sel:[0,0,0] op_sel_hi:[1,0,1]
    s_add_u32 s73, s94, s101
    s_add_u32 s73, s73, 32768
    s_add_u32 m0, s93, 1024
    s_nop 0
    buffer_load_dwordx4 v244, s[44:47], s73 offen nt lds
    v_pk_fma_f32 v[64:65], v[64:65], v[152:153], v[188:189] op_sel:[0,1,0] op_sel_hi:[1,1,1]
    v_pk_fma_f32 v[66:67], v[66:67], v[152:153], v[190:191] op_sel:[0,1,0] op_sel_hi:[1,1,1]
    v_pk_fma_f32 v[68:69], v[68:69], v[154:155], v[192:193] op_sel:[0,0,0] op_sel_hi:[1,0,1]
    v_pk_fma_f32 v[70:71], v[70:71], v[154:155], v[194:195] op_sel:[0,0,0] op_sel_hi:[1,0,1]
    v_pk_fma_f32 v[72:73], v[72:73], v[154:155], v[196:197] op_sel:[0,1,0] op_sel_hi:[1,1,1]
    s_add_u32 s73, s95, s101
    s_add_u32 m0, s93, 2048
    s_nop 0
    buffer_load_dwordx4 v244, s[44:47], s73 offen nt lds
    v_pk_fma_f32 v[74:75], v[74:75], v[154:155], v[198:199] op_sel:[0,1,0] op_sel_hi:[1,1,1]
    v_pk_mul_f32 v[184:185], v[60:61], v[60:61]
    v_pk_mul_f32 v[186:187], v[62:63], v[62:63]
    v_pk_mul_f32 v[188:189], v[64:65], v[64:65]
    v_pk_mul_f32 v[190:191], v[66:67], v[66:67]
    s_add_u32 s73, s95, s101
    s_add_u32 s73, s73, 32768
    s_add_u32 m0, s93, 3072
    s_nop 0
    buffer_load_dwordx4 v244, s[44:47], s73 offen nt lds
    v_pk_mul_f32 v[192:193], v[68:69], v[68:69]
    v_pk_mul_f32 v[194:195], v[70:71], v[70:71]
    v_pk_mul_f32 v[196:197], v[72:73], v[72:73]
    v_pk_mul_f32 v[198:199], v[74:75], v[74:75]
    v_pk_fma_f32 v[184:185], v[184:185], s[16:17], v[10:11] op_sel:[0,0,0] op_sel_hi:[1,0,0]
    s_add_u32 s73, s96, s101
    s_add_u32 m0, s93, 4096
    s_nop 0
    buffer_load_dwordx4 v244, s[44:47], s73 offen nt lds
    v_pk_fma_f32 v[186:187], v[186:187], s[16:17], v[10:11] op_sel:[0,0,0] op_sel_hi:[1,0,0]
    v_pk_fma_f32 v[188:189], v[188:189], s[16:17], v[10:11] op_sel:[0,0,0] op_sel_hi:[1,0,0]
    v_pk_fma_f32 v[190:191], v[190:191], s[16:17], v[10:11] op_sel:[0,0,0] op_sel_hi:[1,0,0]
    v_pk_fma_f32 v[192:193], v[192:193], s[16:17], v[10:11] op_sel:[0,0,0] op_sel_hi:[1,0,0]
    v_pk_fma_f32 v[194:195], v[194:195], s[16:17], v[10:11] op_sel:[0,0,0] op_sel_hi:[1,0,0]
    s_add_u32 s73, s96, s101
    s_add_u32 s73, s73, 32768
    s_add_u32 m0, s93, 5120
    s_nop 0
    buffer_load_dwordx4 v244, s[44:47], s73 offen nt lds
    v_pk_fma_f32 v[196:197], v[196:197], s[16:17], v[10:11] op_sel:[0,0,0] op_sel_hi:[1,0,0]
    v_pk_fma_f32 v[198:199], v[198:199], s[16:17], v[10:11] op_sel:[0,0,0] op_sel_hi:[1,0,0]
    v_pk_mul_f32 v[184:185], v[184:185], v[60:61]
    v_pk_mul_f32 v[186:187], v[186:187], v[62:63]
    v_pk_mul_f32 v[188:189], v[188:189], v[64:65]
    s_add_u32 s73, s97, s101
    s_add_u32 m0, s93, 6144
    s_nop 0
    buffer_load_dwordx4 v244, s[44:47], s73 offen nt lds
    v_pk_mul_f32 v[190:191], v[190:191], v[66:67]
    v_pk_mul_f32 v[192:193], v[192:193], v[68:69]
    v_pk_mul_f32 v[194:195], v[194:195], v[70:71]
    v_pk_mul_f32 v[196:197], v[196:197], v[72:73]
    v_pk_mul_f32 v[198:199], v[198:199], v[74:75]
    s_add_u32 s73, s97, s101
    s_add_u32 s73, s73, 32768
    s_add_u32 m0, s93, 7168
    s_nop 0
    buffer_load_dwordx4 v244, s[44:47], s73 offen nt lds
    v_exp_f32 v184, v184
    v_exp_f32 v185, v185
    v_exp_f32 v186, v186
    v_exp_f32 v187, v187
    v_exp_f32 v188, v188
    s_add_u32 s101, s100, 7
    s_and_b32 s101, s101, 7
    s_lshl_b32 s101, s101, 7
    s_add_u32 s73, s94, s101
    s_add_u32 m0, s93, 8192
    s_nop 0
    buffer_load_dwordx4 v244, s[44:47], s73 offen nt lds
    v_exp_f32 v189, v189
    v_exp_f32 v190, v190
    v_exp_f32 v191, v191
    v_exp_f32 v192, v192
    v_exp_f32 v193, v193
    s_add_u32 s73, s94, s101
    s_add_u32 s73, s73, 32768
    s_add_u32 m0, s93, 9216
    s_nop 0
    buffer_load_dwordx4 v244, s[44:47], s73 offen nt lds
    v_exp_f32 v194, v194
    v_exp_f32 v195, v195
    v_exp_f32 v196, v196
    v_exp_f32 v197, v197
    v_exp_f32 v198, v198
    s_add_u32 s73, s95, s101
    s_add_u32 m0, s93, 10240
    s_nop 0
    buffer_load_dwordx4 v244, s[44:47], s73 offen nt lds
    v_exp_f32 v199, v199
    v_pk_add_f32 v[184:185], v[184:185], 1.0 op_sel_hi:[1,0]
    v_pk_add_f32 v[186:187], v[186:187], 1.0 op_sel_hi:[1,0]
    v_pk_add_f32 v[188:189], v[188:189], 1.0 op_sel_hi:[1,0]
    v_pk_add_f32 v[190:191], v[190:191], 1.0 op_sel_hi:[1,0]
    s_add_u32 s73, s95, s101
    s_add_u32 s73, s73, 32768
    s_add_u32 m0, s93, 11264
    s_nop 0
    buffer_load_dwordx4 v244, s[44:47], s73 offen nt lds
    v_pk_add_f32 v[192:193], v[192:193], 1.0 op_sel_hi:[1,0]
    v_pk_add_f32 v[194:195], v[194:195], 1.0 op_sel_hi:[1,0]
    v_pk_add_f32 v[196:197], v[196:197], 1.0 op_sel_hi:[1,0]
    v_pk_add_f32 v[198:199], v[198:199], 1.0 op_sel_hi:[1,0]
    v_rcp_f32 v184, v184
    s_add_u32 s73, s96, s101
    s_add_u32 m0, s93, 12288
    s_nop 0
    buffer_load_dwordx4 v244, s[44:47], s73 offen nt lds
    v_rcp_f32 v185, v185
    v_rcp_f32 v186, v186
    v_rcp_f32 v187, v187
    v_rcp_f32 v188, v188
    v_rcp_f32 v189, v189
    s_add_u32 s73, s96, s101
    s_add_u32 s73, s73, 32768
    s_add_u32 m0, s93, 13312
    s_nop 0
    buffer_load_dwordx4 v244, s[44:47], s73 offen nt lds
    v_rcp_f32 v190, v190
    v_rcp_f32 v191, v191
    v_rcp_f32 v192, v192
    v_rcp_f32 v193, v193
    v_rcp_f32 v194, v194
    s_add_u32 s73, s97, s101
    s_add_u32 m0, s93, 14336
    s_nop 0
    buffer_load_dwordx4 v244, s[44:47], s73 offen nt lds
    v_rcp_f32 v195, v195
    v_rcp_f32 v196, v196
    v_rcp_f32 v197, v197
    v_rcp_f32 v198, v198
    v_rcp_f32 v199, v199
    s_add_u32 s73, s97, s101
    s_add_u32 s73, s73, 32768
    s_add_u32 m0, s93, 15360
    s_nop 0
    buffer_load_dwordx4 v244, s[44:47], s73 offen nt lds
    v_pk_mul_f32 v[60:61], v[60:61], v[184:185]
    v_pk_mul_f32 v[62:63], v[62:63], v[186:187]
    v_pk_mul_f32 v[64:65], v[64:65], v[188:189]
    v_pk_mul_f32 v[66:67], v[66:67], v[190:191]
    v_pk_mul_f32 v[68:69], v[68:69], v[192:193]
    v_pk_mul_f32 v[70:71], v[70:71], v[194:195]
    v_pk_mul_f32 v[72:73], v[72:73], v[196:197]
    v_pk_mul_f32 v[74:75], v[74:75], v[198:199]
    v_cvt_pk_bf16_f32 v168, v60, v61
    v_cvt_pk_bf16_f32 v169, v62, v63
    v_cvt_pk_bf16_f32 v170, v64, v65
    v_cvt_pk_bf16_f32 v171, v66, v67
    v_cvt_pk_bf16_f32 v172, v68, v69
    v_cvt_pk_bf16_f32 v173, v70, v71
    v_cvt_pk_bf16_f32 v174, v72, v73
    v_cvt_pk_bf16_f32 v175, v74, v75
    ds_write_b64 v151, v[168:169] offset:0
    ds_write_b64 v151, v[170:171] offset:512
    ds_write_b64 v151, v[172:173] offset:1024
    ds_write_b64 v151, v[174:175] offset:1536
    v_pk_fma_f32 v[184:185], v[104:105], v[156:157], v[112:113] op_sel:[0,0,0] op_sel_hi:[1,0,1]
    v_pk_fma_f32 v[186:187], v[106:107], v[156:157], v[114:115] op_sel:[0,0,0] op_sel_hi:[1,0,1]
    v_pk_fma_f32 v[188:189], v[104:105], v[156:157], v[112:113] op_sel:[0,1,0] op_sel_hi:[1,1,1]
    v_pk_fma_f32 v[190:191], v[106:107], v[156:157], v[114:115] op_sel:[0,1,0] op_sel_hi:[1,1,1]
    v_pk_fma_f32 v[192:193], v[104:105], v[158:159], v[112:113] op_sel:[0,0,0] op_sel_hi:[1,0,1]
    v_pk_fma_f32 v[194:195], v[106:107], v[158:159], v[114:115] op_sel:[0,0,0] op_sel_hi:[1,0,1]
    v_pk_fma_f32 v[196:197], v[104:105], v[158:159], v[112:113] op_sel:[0,1,0] op_sel_hi:[1,1,1]
    v_pk_fma_f32 v[198:199], v[106:107], v[158:159], v[114:115] op_sel:[0,1,0] op_sel_hi:[1,1,1]
    v_pk_fma_f32 v[76:77], v[76:77], v[152:153], v[184:185] op_sel:[0,0,0] op_sel_hi:[1,0,1]
    v_pk_fma_f32 v[78:79], v[78:79], v[152:153], v[186:187] op_sel:[0,0,0] op_sel_hi:[1,0,1]
    v_pk_fma_f32 v[80:81], v[80:81], v[152:153], v[188:189] op_sel:[0,1,0] op_sel_hi:[1,1,1]
    v_pk_fma_f32 v[82:83], v[82:83], v[152:153], v[190:191] op_sel:[0,1,0] op_sel_hi:[1,1,1]
    v_pk_fma_f32 v[84:85], v[84:85], v[154:155], v[192:193] op_sel:[0,0,0] op_sel_hi:[1,0,1]
    v_pk_fma_f32 v[86:87], v[86:87], v[154:155], v[194:195] op_sel:[0,0,0] op_sel_hi:[1,0,1]
    v_pk_fma_f32 v[88:89], v[88:89], v[154:155], v[196:197] op_sel:[0,1,0] op_sel_hi:[1,1,1]
    v_and_b32 v241, 31, v1
    v_lshlrev_b32 v241, 6, v241
    s_lshl_b32 s92, s59, 13
    s_lshl_b32 s61, s56, 11
    s_add_u32 s92, s92, s61
    s_add_u32 s92, s92, 196608
    buffer_load_dword v240, v241, s[36:39], s92 offen sc1
    v_pk_fma_f32 v[90:91], v[90:91], v[154:155], v[198:199] op_sel:[0,1,0] op_sel_hi:[1,1,1]
    v_pk_mul_f32 v[184:185], v[76:77], v[76:77]
    v_pk_mul_f32 v[186:187], v[78:79], v[78:79]
    v_pk_mul_f32 v[188:189], v[80:81], v[80:81]
    v_pk_mul_f32 v[190:191], v[82:83], v[82:83]
    v_pk_mul_f32 v[192:193], v[84:85], v[84:85]
    v_pk_mul_f32 v[194:195], v[86:87], v[86:87]
    v_pk_mul_f32 v[196:197], v[88:89], v[88:89]
    v_pk_mul_f32 v[198:199], v[90:91], v[90:91]
    v_pk_fma_f32 v[184:185], v[184:185], s[16:17], v[10:11] op_sel:[0,0,0] op_sel_hi:[1,0,0]
    v_pk_fma_f32 v[186:187], v[186:187], s[16:17], v[10:11] op_sel:[0,0,0] op_sel_hi:[1,0,0]
    v_pk_fma_f32 v[188:189], v[188:189], s[16:17], v[10:11] op_sel:[0,0,0] op_sel_hi:[1,0,0]
    v_pk_fma_f32 v[190:191], v[190:191], s[16:17], v[10:11] op_sel:[0,0,0] op_sel_hi:[1,0,0]
    v_pk_fma_f32 v[192:193], v[192:193], s[16:17], v[10:11] op_sel:[0,0,0] op_sel_hi:[1,0,0]
    v_pk_fma_f32 v[194:195], v[194:195], s[16:17], v[10:11] op_sel:[0,0,0] op_sel_hi:[1,0,0]
    v_pk_fma_f32 v[196:197], v[196:197], s[16:17], v[10:11] op_sel:[0,0,0] op_sel_hi:[1,0,0]
    v_pk_fma_f32 v[198:199], v[198:199], s[16:17], v[10:11] op_sel:[0,0,0] op_sel_hi:[1,0,0]
    v_pk_mul_f32 v[184:185], v[184:185], v[76:77]
    v_pk_mul_f32 v[186:187], v[186:187], v[78:79]
    v_pk_mul_f32 v[188:189], v[188:189], v[80:81]
    v_pk_mul_f32 v[190:191], v[190:191], v[82:83]
    v_pk_mul_f32 v[192:193], v[192:193], v[84:85]
    v_pk_mul_f32 v[194:195], v[194:195], v[86:87]
    v_pk_mul_f32 v[196:197], v[196:197], v[88:89]
    v_pk_mul_f32 v[198:199], v[198:199], v[90:91]
    v_exp_f32 v184, v184
    v_exp_f32 v185, v185
    v_exp_f32 v186, v186
    v_exp_f32 v187, v187
    v_exp_f32 v188, v188
    v_exp_f32 v189, v189
    v_exp_f32 v190, v190
    v_exp_f32 v191, v191
    v_exp_f32 v192, v192
    v_exp_f32 v193, v193
    v_exp_f32 v194, v194
    v_exp_f32 v195, v195
    v_exp_f32 v196, v196
    v_exp_f32 v197, v197
    v_exp_f32 v198, v198
    v_exp_f32 v199, v199
    v_pk_add_f32 v[184:185], v[184:185], 1.0 op_sel_hi:[1,0]
    v_pk_add_f32 v[186:187], v[186:187], 1.0 op_sel_hi:[1,0]
    v_pk_add_f32 v[188:189], v[188:189], 1.0 op_sel_hi:[1,0]
    v_pk_add_f32 v[190:191], v[190:191], 1.0 op_sel_hi:[1,0]
    v_pk_add_f32 v[192:193], v[192:193], 1.0 op_sel_hi:[1,0]
    v_pk_add_f32 v[194:195], v[194:195], 1.0 op_sel_hi:[1,0]
    v_pk_add_f32 v[196:197], v[196:197], 1.0 op_sel_hi:[1,0]
    v_pk_add_f32 v[198:199], v[198:199], 1.0 op_sel_hi:[1,0]
    v_rcp_f32 v184, v184
    v_rcp_f32 v185, v185
    v_rcp_f32 v186, v186
    v_rcp_f32 v187, v187
    v_rcp_f32 v188, v188
    v_rcp_f32 v189, v189
    v_rcp_f32 v190, v190
    v_rcp_f32 v191, v191
    v_rcp_f32 v192, v192
    v_rcp_f32 v193, v193
    v_rcp_f32 v194, v194
    v_rcp_f32 v195, v195
    v_rcp_f32 v196, v196
    v_rcp_f32 v197, v197
    v_rcp_f32 v198, v198
    v_rcp_f32 v199, v199
    v_pk_mul_f32 v[76:77], v[76:77], v[184:185]
    v_pk_mul_f32 v[78:79], v[78:79], v[186:187]
    v_pk_mul_f32 v[80:81], v[80:81], v[188:189]
    v_pk_mul_f32 v[82:83], v[82:83], v[190:191]
    v_pk_mul_f32 v[84:85], v[84:85], v[192:193]
    v_pk_mul_f32 v[86:87], v[86:87], v[194:195]
    v_pk_mul_f32 v[88:89], v[88:89], v[196:197]
    v_pk_mul_f32 v[90:91], v[90:91], v[198:199]
    v_cvt_pk_bf16_f32 v176, v76, v77
    v_cvt_pk_bf16_f32 v177, v78, v79
    v_cvt_pk_bf16_f32 v178, v80, v81
    v_cvt_pk_bf16_f32 v179, v82, v83
    v_cvt_pk_bf16_f32 v180, v84, v85
    v_cvt_pk_bf16_f32 v181, v86, v87
    v_cvt_pk_bf16_f32 v182, v88, v89
    v_cvt_pk_bf16_f32 v183, v90, v91
    ds_write_b64 v151, v[176:177] offset:2048
    ds_write_b64 v151, v[178:179] offset:2560
    ds_write_b64 v151, v[180:181] offset:3072
    ds_write_b64 v151, v[182:183] offset:3584
    s_mov_b32 s40, s22
    s_mov_b32 s41, s23
    s_mov_b32 s42, 4096
    s_mov_b32 s43, 0x20000
    v_lshlrev_b32 v2, 1, v6
    s_lshl_b32 s60, s58, 7
    s_lshl_b32 s61, s56, 5
    s_add_u32 s60, s60, s61
    buffer_load_ushort v182, v2, s[40:43], s60 offen
    s_add_u32 s60, s56, 1
    s_and_b32 s60, s60, 3
    s_mul_i32 s60, s60, 21504
    s_add_u32 s60, s60, 47104
    v_add_u32 v183, s60, v5
    s_add_u32 s60, s56, 2
    s_and_b32 s60, s60, 3
    s_mul_i32 s60, s60, 21504
    s_add_u32 s60, s60, 54272
    v_add_u32 v184, s60, v5
    s_add_u32 s60, s56, 3
    s_and_b32 s60, s60, 3
    s_mul_i32 s60, s60, 21504
    s_add_u32 s60, s60, 61440
    v_add_u32 v185, s60, v5
    v_and_b32 v181, 31, v1
    v_lshlrev_b32 v181, 6, v181
    s_lshl_b32 s62, s59, 13
    s_lshl_b32 s61, s56, 11
    s_add_u32 s62, s62, s61
    s_add_u32 s62, s62, 196608
    s_mul_i32 s88, s59, 459776
    s_mul_i32 s61, s56, 114688
    s_add_u32 s88, s88, s61
    s_add_u32 s88, s88, 9437184
    s_waitcnt vmcnt(1)
    v_cmp_ne_u32 vcc, s57, v240
    s_cbranch_vccz L_s4ok_41
    s_mov_b32 s78, 0
    buffer_load_dword v180, v181, s[36:39], s62 offen sc1
L_qs4_42:
    s_sleep 3
    buffer_load_dword v186, v181, s[36:39], s62 offen sc1
    s_waitcnt vmcnt(1)
    v_cmp_ne_u32 vcc, s57, v180
    s_cbranch_vccz L_qds4_43
    s_sleep 3
    buffer_load_dword v180, v181, s[36:39], s62 offen sc1
    s_waitcnt vmcnt(1)
    v_cmp_ne_u32 vcc, s57, v186
    s_cbranch_vccz L_qds4_43
    s_add_u32 s78, s78, 1
    s_cmp_gt_u32 s78, 200000
    s_cbranch_scc0 L_qs4_42
L_qds4_43:
L_s4ok_41:
    s_add_u32 s64, s100, 0
    s_and_b32 s64, s64, 7
    s_mul_i32 s64, s64, 14336
    s_add_u32 s64, s64, s88
    s_add_u32 s65, s100, 1
    s_and_b32 s65, s65, 7
    s_mul_i32 s65, s65, 14336
    s_add_u32 s65, s65, s88
    s_add_u32 s66, s100, 2
    s_and_b32 s66, s66, 7
    s_mul_i32 s66, s66, 14336
    s_add_u32 s66, s66, s88
    s_add_u32 s67, s100, 3
    s_and_b32 s67, s67, 7
    s_mul_i32 s67, s67, 14336
    s_add_u32 s67, s67, s88
    s_add_u32 s68, s100, 4
    s_and_b32 s68, s68, 7
    s_mul_i32 s68, s68, 14336
    s_add_u32 s68, s68, s88
    s_add_u32 s69, s100, 5
    s_and_b32 s69, s69, 7
    s_mul_i32 s69, s69, 14336
    s_add_u32 s69, s69, s88
    s_add_u32 s70, s100, 6
    s_and_b32 s70, s70, 7
    s_mul_i32 s70, s70, 14336
    s_add_u32 s70, s70, s88
    s_add_u32 s71, s100, 7
    s_and_b32 s71, s71, 7
    s_mul_i32 s71, s71, 14336
    s_add_u32 s71, s71, s88
    s_add_u32 s60, s64, 0
    buffer_load_dwordx4 v[124:127], v5, s[36:39], s60 offen offset:0 sc1
    s_add_u32 s60, s64, 0
    buffer_load_dwordx4 v[128:131], v5, s[36:39], s60 offen offset:1024 sc1
    s_add_u32 s60, s64, 0
    buffer_load_dwordx4 v[132:135], v5, s[36:39], s60 offen offset:2048 sc1
    s_add_u32 s60, s64, 0
    buffer_load_dwordx4 v[136:139], v5, s[36:39], s60 offen offset:3072 sc1
    s_add_u32 s60, s64, 4096
    buffer_load_dwordx4 v[140:143], v5, s[36:39], s60 offen offset:0 sc1
    s_add_u32 s60, s64, 4096
    buffer_load_dwordx4 v[144:147], v5, s[36:39], s60 offen offset:1024 sc1
    s_add_u32 s60, s64, 4096
    buffer_load_dwordx4 v[148:151], v5, s[36:39], s60 offen offset:2048 sc1
    s_add_u32 s60, s64, 7168
    buffer_load_dwordx4 v[152:155], v5, s[36:39], s60 offen offset:0 sc1
    s_add_u32 s60, s64, 7168
    buffer_load_dwordx4 v[156:159], v5, s[36:39], s60 offen offset:1024 sc1
    s_add_u32 s60, s64, 7168
    buffer_load_dwordx4 v[160:163], v5, s[36:39], s60 offen offset:2048 sc1
    s_add_u32 s60, s64, 7168
    buffer_load_dwordx4 v[164:167], v5, s[36:39], s60 offen offset:3072 sc1
    s_add_u32 s60, s64, 11264
    buffer_load_dwordx4 v[168:171], v5, s[36:39], s60 offen offset:0 sc1
    s_add_u32 s60, s64, 11264
    buffer_load_dwordx4 v[172:175], v5, s[36:39], s60 offen offset:1024 sc1
    s_add_u32 s60, s64, 11264
    buffer_load_dwordx4 v[176:179], v5, s[36:39], s60 offen offset:2048 sc1
    ds_read_b128 a[192:195], v242 offset:0
    ds_read_b128 a[196:199], v242 offset:2048
    ds_read_b128 a[200:203], v242 offset:4096
    ds_read_b128 a[204:207], v242 offset:6144
    ds_read_b128 a[208:211], v243 offset:0
    ds_read_b128 a[212:215], v243 offset:2048
    ds_read_b128 a[216:219], v243 offset:4096
    ds_read_b128 a[220:223], v243 offset:6144
    ds_read_b128 a[224:227], v242 offset:8192
    ds_read_b128 a[228:231], v242 offset:10240
    ds_read_b128 a[232:235], v242 offset:12288
    ds_read_b128 a[236:239], v242 offset:14336
    ds_read_b128 a[240:243], v243 offset:8192
    ds_read_b128 a[244:247], v243 offset:10240
    ds_read_b128 a[248:251], v243 offset:12288
    ds_read_b128 a[252:255], v243 offset:14336
    s_cmp_eq_u32 s2, 0
    s_cbranch_scc0 L_ep_44
    s_cmp_eq_u32 s56, 0
    s_cbranch_scc0 L_ep_44
    s_mov_b32 s72, 0
    v_mov_b32 v2, s57
    s_mov_b64 exec, 1
    buffer_store_dword v2, v4, s[36:39], s72 offen sc1
    s_mov_b64 exec, -1
L_ep_44:
    s_mul_i32 s90, s59, 114688
    s_add_u32 s90, s90, 17825792
    s_lshl_b32 s91, s56, 10
    s_add_u32 s90, s90, s91
    s_mul_i32 s60, s56, 21504
    s_add_u32 s60, s60, 47104
    v_add_u32 v187, s60, v5
    s_lshl_b32 s60, s56, 9
    s_add_u32 s60, s60, 145408
    v_add_u32 v188, s60, v8
    s_mul_i32 s60, s58, 115712
    s_mul_i32 s61, s56, 28672
    s_add_u32 s60, s60, s61
    s_add_u32 s89, s60, 13631488
    s_mul_i32 s92, s59, 3072
    s_add_u32 s92, s92, s89
    s_lshr_b32 s93, s59, 1
    s_lshl_b32 s93, s93, 10
    s_add_u32 s93, s93, s89
    s_add_u32 s93, s93, 24576
    s_and_b32 s63, s59, 1
    s_lshl_b32 s63, s63, 3
    s_add_u32 s93, s93, s63
    s_waitcnt vmcnt(13)
    v_mfma_f32_16x16x32_bf16 v[12:15], v[124:127], a[0:3], 0
    v_mfma_f32_16x16x32_bf16 v[16:19], v[124:127], a[4:7], 0
    v_mfma_f32_16x16x32_bf16 v[20:23], v[124:127], a[8:11], 0
    v_mfma_f32_16x16x32_bf16 v[24:27], v[124:127], a[12:15], 0
    s_add_u32 s60, s65, 0
    buffer_load_dwordx4 v[124:127], v5, s[36:39], s60 offen offset:0 sc1
    s_waitcnt vmcnt(13)
    v_mfma_f32_16x16x32_bf16 v[28:31], v[128:131], a[0:3], 0
    v_mfma_f32_16x16x32_bf16 v[32:35], v[128:131], a[4:7], 0
    v_mfma_f32_16x16x32_bf16 v[36:39], v[128:131], a[8:11], 0
    v_mfma_f32_16x16x32_bf16 v[40:43], v[128:131], a[12:15], 0
    s_add_u32 s60, s65, 0
    buffer_load_dwordx4 v[128:131], v5, s[36:39], s60 offen offset:1024 sc1
    s_waitcnt vmcnt(13)
    v_mfma_f32_16x16x32_bf16 v[44:47], v[132:135], a[0:3], 0
    v_mfma_f32_16x16x32_bf16 v[48:51], v[132:135], a[4:7], 0
    v_mfma_f32_16x16x32_bf16 v[52:55], v[132:135], a[8:11], 0
    v_mfma_f32_16x16x32_bf16 v[56:59], v[132:135], a[12:15], 0
    s_add_u32 s60, s65, 0
    buffer_load_dwordx4 v[132:135], v5, s[36:39], s60 offen offset:2048 sc1
    s_waitcnt vmcnt(13)
    v_mfma_f32_16x16x32_bf16 v[60:63], v[136:139], a[0:3], 0
    v_mfma_f32_16x16x32_bf16 v[64:67], v[136:139], a[4:7], 0
    v_mfma_f32_16x16x32_bf16 v[68:71], v[136:139], a[8:11], 0
    v_mfma_f32_16x16x32_bf16 v[72:75], v[136:139], a[12:15], 0
    s_add_u32 s60, s65, 0
    buffer_load_dwordx4 v[136:139], v5, s[36:39], s60 offen offset:3072 sc1
    s_waitcnt vmcnt(13)
    v_mfma_f32_16x16x32_bf16 v[76:79], v[140:143], a[0:3], 0
    v_mfma_f32_16x16x32_bf16 v[80:83], v[140:143], a[4:7], 0
    v_mfma_f32_16x16x32_bf16 v[84:87], v[140:143], a[8:11], 0
    v_mfma_f32_16x16x32_bf16 v[88:91], v[140:143], a[12:15], 0
    s_add_u32 s60, s65, 4096
    buffer_load_dwordx4 v[140:143], v5, s[36:39], s60 offen offset:0 sc1
    s_waitcnt vmcnt(13)
    v_mfma_f32_16x16x32_bf16 v[92:95], v[144:147], a[0:3], 0
    v_mfma_f32_16x16x32_bf16 v[96:99], v[144:147], a[4:7], 0
    v_mfma_f32_16x16x32_bf16 v[100:103], v[144:147], a[8:11], 0
    v_mfma_f32_16x16x32_bf16 v[104:107], v[144:147], a[12:15], 0
    s_add_u32 s60, s65, 4096
    buffer_load_dwordx4 v[144:147], v5, s[36:39], s60 offen offset:1024 sc1
    s_waitcnt vmcnt(13)
    v_mfma_f32_16x16x32_bf16 v[108:111], v[148:151], a[0:3], 0
    v_mfma_f32_16x16x32_bf16 v[112:115], v[148:151], a[4:7], 0
    v_mfma_f32_16x16x32_bf16 v[116:119], v[148:151], a[8:11], 0
    v_mfma_f32_16x16x32_bf16 v[120:123], v[148:151], a[12:15], 0
    s_add_u32 s60, s65, 4096
    buffer_load_dwordx4 v[148:151], v5, s[36:39], s60 offen offset:2048 sc1
    s_waitcnt vmcnt(13)
    v_mfma_f32_16x16x32_bf16 v[12:15], v[152:155], a[16:19], v[12:15]
    v_mfma_f32_16x16x32_bf16 v[16:19], v[152:155], a[20:23], v[16:19]
    v_mfma_f32_16x16x32_bf16 v[20:23], v[152:155], a[24:27], v[20:23]
    v_mfma_f32_16x16x32_bf16 v[24:27], v[152:155], a[28:31], v[24:27]
    s_add_u32 s60, s65, 7168
    buffer_load_dwordx4 v[152:155], v5, s[36:39], s60 offen offset:0 sc1
    s_waitcnt vmcnt(13)
    v_mfma_f32_16x16x32_bf16 v[28:31], v[156:159], a[16:19], v[28:31]
    v_mfma_f32_16x16x32_bf16 v[32:35], v[156:159], a[20:23], v[32:35]
    v_mfma_f32_16x16x32_bf16 v[36:39], v[156:159], a[24:27], v[36:39]
    v_mfma_f32_16x16x32_bf16 v[40:43], v[156:159], a[28:31], v[40:43]
    s_add_u32 s60, s65, 7168
    buffer_load_dwordx4 v[156:159], v5, s[36:39], s60 offen offset:1024 sc1
    s_waitcnt vmcnt(13)
    v_mfma_f32_16x16x32_bf16 v[44:47], v[160:163], a[16:19], v[44:47]
    v_mfma_f32_16x16x32_bf16 v[48:51], v[160:163], a[20:23], v[48:51]
    v_mfma_f32_16x16x32_bf16 v[52:55], v[160:163], a[24:27], v[52:55]
    v_mfma_f32_16x16x32_bf16 v[56:59], v[160:163], a[28:31], v[56:59]
    s_add_u32 s60, s65, 7168
    buffer_load_dwordx4 v[160:163], v5, s[36:39], s60 offen offset:2048 sc1
    s_waitcnt vmcnt(13)
    v_mfma_f32_16x16x32_bf16 v[60:63], v[164:167], a[16:19], v[60:63]
    v_mfma_f32_16x16x32_bf16 v[64:67], v[164:167], a[20:23], v[64:67]
    v_mfma_f32_16x16x32_bf16 v[68:71], v[164:167], a[24:27], v[68:71]
    v_mfma_f32_16x16x32_bf16 v[72:75], v[164:167], a[28:31], v[72:75]
    s_add_u32 s60, s65, 7168
    buffer_load_dwordx4 v[164:167], v5, s[36:39], s60 offen offset:3072 sc1
    s_waitcnt vmcnt(13)
    v_mfma_f32_16x16x32_bf16 v[76:79], v[168:171], a[16:19], v[76:79]
    v_mfma_f32_16x16x32_bf16 v[80:83], v[168:171], a[20:23], v[80:83]
    v_mfma_f32_16x16x32_bf16 v[84:87], v[168:171], a[24:27], v[84:87]
    v_mfma_f32_16x16x32_bf16 v[88:91], v[168:171], a[28:31], v[88:91]
    s_add_u32 s60, s65, 11264
    buffer_load_dwordx4 v[168:171], v5, s[36:39], s60 offen offset:0 sc1
    s_waitcnt vmcnt(13)
    v_mfma_f32_16x16x32_bf16 v[92:95], v[172:175], a[16:19], v[92:95]
    v_mfma_f32_16x16x32_bf16 v[96:99], v[172:175], a[20:23], v[96:99]
    v_mfma_f32_16x16x32_bf16 v[100:103], v[172:175], a[24:27], v[100:103]
    v_mfma_f32_16x16x32_bf16 v[104:107], v[172:175], a[28:31], v[104:107]
    s_add_u32 s60, s65, 11264
    buffer_load_dwordx4 v[172:175], v5, s[36:39], s60 offen offset:1024 sc1
    s_waitcnt vmcnt(13)
    v_mfma_f32_16x16x32_bf16 v[108:111], v[176:179], a[16:19], v[108:111]
    v_mfma_f32_16x16x32_bf16 v[112:115], v[176:179], a[20:23], v[112:115]
    v_mfma_f32_16x16x32_bf16 v[116:119], v[176:179], a[24:27], v[116:119]
    v_mfma_f32_16x16x32_bf16 v[120:123], v[176:179], a[28:31], v[120:123]
    s_add_u32 s60, s65, 11264
    buffer_load_dwordx4 v[176:179], v5, s[36:39], s60 offen offset:2048 sc1
    s_waitcnt vmcnt(13)
    v_mfma_f32_16x16x32_bf16 v[12:15], v[124:127], a[32:35], v[12:15]
    v_mfma_f32_16x16x32_bf16 v[16:19], v[124:127], a[36:39], v[16:19]
    v_mfma_f32_16x16x32_bf16 v[20:23], v[124:127], a[40:43], v[20:23]
    v_mfma_f32_16x16x32_bf16 v[24:27], v[124:127], a[44:47], v[24:27]
    s_add_u32 s60, s66, 0
    buffer_load_dwordx4 v[124:127], v5, s[36:39], s60 offen offset:0 sc1
    s_waitcnt vmcnt(13)
    v_mfma_f32_16x16x32_bf16 v[28:31], v[128:131], a[32:35], v[28:31]
    v_mfma_f32_16x16x32_bf16 v[32:35], v[128:131], a[36:39], v[32:35]
    v_mfma_f32_16x16x32_bf16 v[36:39], v[128:131], a[40:43], v[36:39]
    v_mfma_f32_16x16x32_bf16 v[40:43], v[128:131], a[44:47], v[40:43]
    s_add_u32 s60, s66, 0
    buffer_load_dwordx4 v[128:131], v5, s[36:39], s60 offen offset:1024 sc1
    s_waitcnt vmcnt(13)
    v_mfma_f32_16x16x32_bf16 v[44:47], v[132:135], a[32:35], v[44:47]
    v_mfma_f32_16x16x32_bf16 v[48:51], v[132:135], a[36:39], v[48:51]
    v_mfma_f32_16x16x32_bf16 v[52:55], v[132:135], a[40:43], v[52:55]
    v_mfma_f32_16x16x32_bf16 v[56:59], v[132:135], a[44:47], v[56:59]
    s_add_u32 s60, s66, 0
    buffer_load_dwordx4 v[132:135], v5, s[36:39], s60 offen offset:2048 sc1
    s_waitcnt vmcnt(13)
    v_mfma_f32_16x16x32_bf16 v[60:63], v[136:139], a[32:35], v[60:63]
    v_mfma_f32_16x16x32_bf16 v[64:67], v[136:139], a[36:39], v[64:67]
    v_mfma_f32_16x16x32_bf16 v[68:71], v[136:139], a[40:43], v[68:71]
    v_mfma_f32_16x16x32_bf16 v[72:75], v[136:139], a[44:47], v[72:75]
    s_add_u32 s60, s66, 0
    buffer_load_dwordx4 v[136:139], v5, s[36:39], s60 offen offset:3072 sc1
    s_waitcnt vmcnt(13)
    v_mfma_f32_16x16x32_bf16 v[76:79], v[140:143], a[32:35], v[76:79]
    v_mfma_f32_16x16x32_bf16 v[80:83], v[140:143], a[36:39], v[80:83]
    v_mfma_f32_16x16x32_bf16 v[84:87], v[140:143], a[40:43], v[84:87]
    v_mfma_f32_16x16x32_bf16 v[88:91], v[140:143], a[44:47], v[88:91]
    s_add_u32 s60, s66, 4096
    buffer_load_dwordx4 v[140:143], v5, s[36:39], s60 offen offset:0 sc1
    s_waitcnt vmcnt(13)
    v_mfma_f32_16x16x32_bf16 v[92:95], v[144:147], a[32:35], v[92:95]
    v_mfma_f32_16x16x32_bf16 v[96:99], v[144:147], a[36:39], v[96:99]
    v_mfma_f32_16x16x32_bf16 v[100:103], v[144:147], a[40:43], v[100:103]
    v_mfma_f32_16x16x32_bf16 v[104:107], v[144:147], a[44:47], v[104:107]
    s_add_u32 s60, s66, 4096
    buffer_load_dwordx4 v[144:147], v5, s[36:39], s60 offen offset:1024 sc1
    s_waitcnt vmcnt(13)
    v_mfma_f32_16x16x32_bf16 v[108:111], v[148:151], a[32:35], v[108:111]
    v_mfma_f32_16x16x32_bf16 v[112:115], v[148:151], a[36:39], v[112:115]
    v_mfma_f32_16x16x32_bf16 v[116:119], v[148:151], a[40:43], v[116:119]
    v_mfma_f32_16x16x32_bf16 v[120:123], v[148:151], a[44:47], v[120:123]
    s_add_u32 s60, s66, 4096
    buffer_load_dwordx4 v[148:151], v5, s[36:39], s60 offen offset:2048 sc1
    s_waitcnt vmcnt(13)
    v_mfma_f32_16x16x32_bf16 v[12:15], v[152:155], a[48:51], v[12:15]
    v_mfma_f32_16x16x32_bf16 v[16:19], v[152:155], a[52:55], v[16:19]
    v_mfma_f32_16x16x32_bf16 v[20:23], v[152:155], a[56:59], v[20:23]
    v_mfma_f32_16x16x32_bf16 v[24:27], v[152:155], a[60:63], v[24:27]
    s_add_u32 s60, s66, 7168
    buffer_load_dwordx4 v[152:155], v5, s[36:39], s60 offen offset:0 sc1
    s_waitcnt vmcnt(13)
    v_mfma_f32_16x16x32_bf16 v[28:31], v[156:159], a[48:51], v[28:31]
    v_mfma_f32_16x16x32_bf16 v[32:35], v[156:159], a[52:55], v[32:35]
    v_mfma_f32_16x16x32_bf16 v[36:39], v[156:159], a[56:59], v[36:39]
    v_mfma_f32_16x16x32_bf16 v[40:43], v[156:159], a[60:63], v[40:43]
    s_add_u32 s60, s66, 7168
    buffer_load_dwordx4 v[156:159], v5, s[36:39], s60 offen offset:1024 sc1
    s_waitcnt vmcnt(13)
    v_mfma_f32_16x16x32_bf16 v[44:47], v[160:163], a[48:51], v[44:47]
    v_mfma_f32_16x16x32_bf16 v[48:51], v[160:163], a[52:55], v[48:51]
    v_mfma_f32_16x16x32_bf16 v[52:55], v[160:163], a[56:59], v[52:55]
    v_mfma_f32_16x16x32_bf16 v[56:59], v[160:163], a[60:63], v[56:59]
    s_add_u32 s60, s66, 7168
    buffer_load_dwordx4 v[160:163], v5, s[36:39], s60 offen offset:2048 sc1
    s_waitcnt vmcnt(13)
    v_mfma_f32_16x16x32_bf16 v[60:63], v[164:167], a[48:51], v[60:63]
    v_mfma_f32_16x16x32_bf16 v[64:67], v[164:167], a[52:55], v[64:67]
    v_mfma_f32_16x16x32_bf16 v[68:71], v[164:167], a[56:59], v[68:71]
    v_mfma_f32_16x16x32_bf16 v[72:75], v[164:167], a[60:63], v[72:75]
    s_add_u32 s60, s66, 7168
    buffer_load_dwordx4 v[164:167], v5, s[36:39], s60 offen offset:3072 sc1
    s_waitcnt vmcnt(13)
    v_mfma_f32_16x16x32_bf16 v[76:79], v[168:171], a[48:51], v[76:79]
    v_mfma_f32_16x16x32_bf16 v[80:83], v[168:171], a[52:55], v[80:83]
    v_mfma_f32_16x16x32_bf16 v[84:87], v[168:171], a[56:59], v[84:87]
    v_mfma_f32_16x16x32_bf16 v[88:91], v[168:171], a[60:63], v[88:91]
    s_add_u32 s60, s66, 11264
    buffer_load_dwordx4 v[168:171], v5, s[36:39], s60 offen offset:0 sc1
    s_waitcnt vmcnt(13)
    v_mfma_f32_16x16x32_bf16 v[92:95], v[172:175], a[48:51], v[92:95]
    v_mfma_f32_16x16x32_bf16 v[96:99], v[172:175], a[52:55], v[96:99]
    v_mfma_f32_16x16x32_bf16 v[100:103], v[172:175], a[56:59], v[100:103]
    v_mfma_f32_16x16x32_bf16 v[104:107], v[172:175], a[60:63], v[104:107]
    s_add_u32 s60, s66, 11264
    buffer_load_dwordx4 v[172:175], v5, s[36:39], s60 offen offset:1024 sc1
    s_waitcnt vmcnt(13)
    v_mfma_f32_16x16x32_bf16 v[108:111], v[176:179], a[48:51], v[108:111]
    v_mfma_f32_16x16x32_bf16 v[112:115], v[176:179], a[52:55], v[112:115]
    v_mfma_f32_16x16x32_bf16 v[116:119], v[176:179], a[56:59], v[116:119]
    v_mfma_f32_16x16x32_bf16 v[120:123], v[176:179], a[60:63], v[120:123]
    s_add_u32 s60, s66, 11264
    buffer_load_dwordx4 v[176:179], v5, s[36:39], s60 offen offset:2048 sc1
    s_waitcnt vmcnt(13)
    v_mfma_f32_16x16x32_bf16 v[12:15], v[124:127], a[64:67], v[12:15]
    v_mfma_f32_16x16x32_bf16 v[16:19], v[124:127], a[68:71], v[16:19]
    v_mfma_f32_16x16x32_bf16 v[20:23], v[124:127], a[72:75], v[20:23]
    v_mfma_f32_16x16x32_bf16 v[24:27], v[124:127], a[76:79], v[24:27]
    s_add_u32 s60, s67, 0
    buffer_load_dwordx4 v[124:127], v5, s[36:39], s60 offen offset:0 sc1
    s_waitcnt vmcnt(13)
    v_mfma_f32_16x16x32_bf16 v[28:31], v[128:131], a[64:67], v[28:31]
    v_mfma_f32_16x16x32_bf16 v[32:35], v[128:131], a[68:71], v[32:35]
    v_mfma_f32_16x16x32_bf16 v[36:39], v[128:131], a[72:75], v[36:39]
    v_mfma_f32_16x16x32_bf16 v[40:43], v[128:131], a[76:79], v[40:43]
    s_add_u32 s60, s67, 0
    buffer_load_dwordx4 v[128:131], v5, s[36:39], s60 offen offset:1024 sc1
    s_waitcnt vmcnt(13)
    v_mfma_f32_16x16x32_bf16 v[44:47], v[132:135], a[64:67], v[44:47]
    v_mfma_f32_16x16x32_bf16 v[48:51], v[132:135], a[68:71], v[48:51]
    v_mfma_f32_16x16x32_bf16 v[52:55], v[132:135], a[72:75], v[52:55]
    v_mfma_f32_16x16x32_bf16 v[56:59], v[132:135], a[76:79], v[56:59]
    s_add_u32 s60, s67, 0
    buffer_load_dwordx4 v[132:135], v5, s[36:39], s60 offen offset:2048 sc1
    s_waitcnt vmcnt(13)
    v_mfma_f32_16x16x32_bf16 v[60:63], v[136:139], a[64:67], v[60:63]
    v_mfma_f32_16x16x32_bf16 v[64:67], v[136:139], a[68:71], v[64:67]
    v_mfma_f32_16x16x32_bf16 v[68:71], v[136:139], a[72:75], v[68:71]
    v_mfma_f32_16x16x32_bf16 v[72:75], v[136:139], a[76:79], v[72:75]
    s_add_u32 s60, s67, 0
    buffer_load_dwordx4 v[136:139], v5, s[36:39], s60 offen offset:3072 sc1
    s_waitcnt vmcnt(13)
    v_mfma_f32_16x16x32_bf16 v[76:79], v[140:143], a[64:67], v[76:79]
    v_mfma_f32_16x16x32_bf16 v[80:83], v[140:143], a[68:71], v[80:83]
    v_mfma_f32_16x16x32_bf16 v[84:87], v[140:143], a[72:75], v[84:87]
    v_mfma_f32_16x16x32_bf16 v[88:91], v[140:143], a[76:79], v[88:91]
    s_add_u32 s60, s67, 4096
    buffer_load_dwordx4 v[140:143], v5, s[36:39], s60 offen offset:0 sc1
    s_waitcnt vmcnt(13)
    v_mfma_f32_16x16x32_bf16 v[92:95], v[144:147], a[64:67], v[92:95]
    v_mfma_f32_16x16x32_bf16 v[96:99], v[144:147], a[68:71], v[96:99]
    v_mfma_f32_16x16x32_bf16 v[100:103], v[144:147], a[72:75], v[100:103]
    v_mfma_f32_16x16x32_bf16 v[104:107], v[144:147], a[76:79], v[104:107]
    s_add_u32 s60, s67, 4096
    buffer_load_dwordx4 v[144:147], v5, s[36:39], s60 offen offset:1024 sc1
    s_waitcnt vmcnt(13)
    v_mfma_f32_16x16x32_bf16 v[108:111], v[148:151], a[64:67], v[108:111]
    v_mfma_f32_16x16x32_bf16 v[112:115], v[148:151], a[68:71], v[112:115]
    v_mfma_f32_16x16x32_bf16 v[116:119], v[148:151], a[72:75], v[116:119]
    v_mfma_f32_16x16x32_bf16 v[120:123], v[148:151], a[76:79], v[120:123]
    s_add_u32 s60, s67, 4096
    buffer_load_dwordx4 v[148:151], v5, s[36:39], s60 offen offset:2048 sc1
    s_waitcnt vmcnt(13)
    v_mfma_f32_16x16x32_bf16 v[12:15], v[152:155], a[80:83], v[12:15]
    v_mfma_f32_16x16x32_bf16 v[16:19], v[152:155], a[84:87], v[16:19]
    v_mfma_f32_16x16x32_bf16 v[20:23], v[152:155], a[88:91], v[20:23]
    v_mfma_f32_16x16x32_bf16 v[24:27], v[152:155], a[92:95], v[24:27]
    s_add_u32 s60, s67, 7168
    buffer_load_dwordx4 v[152:155], v5, s[36:39], s60 offen offset:0 sc1
    s_waitcnt vmcnt(13)
    v_mfma_f32_16x16x32_bf16 v[28:31], v[156:159], a[80:83], v[28:31]
    v_mfma_f32_16x16x32_bf16 v[32:35], v[156:159], a[84:87], v[32:35]
    v_mfma_f32_16x16x32_bf16 v[36:39], v[156:159], a[88:91], v[36:39]
    v_mfma_f32_16x16x32_bf16 v[40:43], v[156:159], a[92:95], v[40:43]
    s_add_u32 s60, s67, 7168
    buffer_load_dwordx4 v[156:159], v5, s[36:39], s60 offen offset:1024 sc1
    s_waitcnt vmcnt(13)
    v_mfma_f32_16x16x32_bf16 v[44:47], v[160:163], a[80:83], v[44:47]
    v_mfma_f32_16x16x32_bf16 v[48:51], v[160:163], a[84:87], v[48:51]
    v_mfma_f32_16x16x32_bf16 v[52:55], v[160:163], a[88:91], v[52:55]
    v_mfma_f32_16x16x32_bf16 v[56:59], v[160:163], a[92:95], v[56:59]
    s_add_u32 s60, s67, 7168
    buffer_load_dwordx4 v[160:163], v5, s[36:39], s60 offen offset:2048 sc1
    s_waitcnt vmcnt(13)
    v_mfma_f32_16x16x32_bf16 v[60:63], v[164:167], a[80:83], v[60:63]
    v_mfma_f32_16x16x32_bf16 v[64:67], v[164:167], a[84:87], v[64:67]
    v_mfma_f32_16x16x32_bf16 v[68:71], v[164:167], a[88:91], v[68:71]
    v_mfma_f32_16x16x32_bf16 v[72:75], v[164:167], a[92:95], v[72:75]
    s_add_u32 s60, s67, 7168
    buffer_load_dwordx4 v[164:167], v5, s[36:39], s60 offen offset:3072 sc1
    s_waitcnt vmcnt(13)
    v_mfma_f32_16x16x32_bf16 v[76:79], v[168:171], a[80:83], v[76:79]
    v_mfma_f32_16x16x32_bf16 v[80:83], v[168:171], a[84:87], v[80:83]
    v_mfma_f32_16x16x32_bf16 v[84:87], v[168:171], a[88:91], v[84:87]
    v_mfma_f32_16x16x32_bf16 v[88:91], v[168:171], a[92:95], v[88:91]
    s_add_u32 s60, s67, 11264
    buffer_load_dwordx4 v[168:171], v5, s[36:39], s60 offen offset:0 sc1
    s_waitcnt vmcnt(13)
    v_mfma_f32_16x16x32_bf16 v[92:95], v[172:175], a[80:83], v[92:95]
    v_mfma_f32_16x16x32_bf16 v[96:99], v[172:175], a[84:87], v[96:99]
    v_mfma_f32_16x16x32_bf16 v[100:103], v[172:175], a[88:91], v[100:103]
    v_mfma_f32_16x16x32_bf16 v[104:107], v[172:175], a[92:95], v[104:107]
    s_add_u32 s60, s67, 11264
    buffer_load_dwordx4 v[172:175], v5, s[36:39], s60 offen offset:1024 sc1
    s_waitcnt vmcnt(13)
    v_mfma_f32_16x16x32_bf16 v[108:111], v[176:179], a[80:83], v[108:111]
    v_mfma_f32_16x16x32_bf16 v[112:115], v[176:179], a[84:87], v[112:115]
    v_mfma_f32_16x16x32_bf16 v[116:119], v[176:179], a[88:91], v[116:119]
    v_mfma_f32_16x16x32_bf16 v[120:123], v[176:179], a[92:95], v[120:123]
    s_add_u32 s60, s67, 11264
    buffer_load_dwordx4 v[176:179], v5, s[36:39], s60 offen offset:2048 sc1
    v_lshlrev_b32 v182, 16, v182
    s_waitcnt lgkmcnt(0)
    s_barrier
    s_waitcnt vmcnt(13)
    v_mfma_f32_16x16x32_bf16 v[12:15], v[124:127], a[96:99], v[12:15]
    v_mfma_f32_16x16x32_bf16 v[16:19], v[124:127], a[100:103], v[16:19]
    v_mfma_f32_16x16x32_bf16 v[20:23], v[124:127], a[104:107], v[20:23]
    v_mfma_f32_16x16x32_bf16 v[24:27], v[124:127], a[108:111], v[24:27]
    s_add_u32 s60, s68, 0
    buffer_load_dwordx4 v[124:127], v5, s[36:39], s60 offen offset:0 sc1
    s_waitcnt vmcnt(13)
    v_mfma_f32_16x16x32_bf16 v[28:31], v[128:131], a[96:99], v[28:31]
    v_mfma_f32_16x16x32_bf16 v[32:35], v[128:131], a[100:103], v[32:35]
    v_mfma_f32_16x16x32_bf16 v[36:39], v[128:131], a[104:107], v[36:39]
    v_mfma_f32_16x16x32_bf16 v[40:43], v[128:131], a[108:111], v[40:43]
    s_add_u32 s60, s68, 0
    buffer_load_dwordx4 v[128:131], v5, s[36:39], s60 offen offset:1024 sc1
    s_waitcnt vmcnt(13)
    v_mfma_f32_16x16x32_bf16 v[44:47], v[132:135], a[96:99], v[44:47]
    v_mfma_f32_16x16x32_bf16 v[48:51], v[132:135], a[100:103], v[48:51]
    v_mfma_f32_16x16x32_bf16 v[52:55], v[132:135], a[104:107], v[52:55]
    v_mfma_f32_16x16x32_bf16 v[56:59], v[132:135], a[108:111], v[56:59]
    s_add_u32 s60, s68, 0
    buffer_load_dwordx4 v[132:135], v5, s[36:39], s60 offen offset:2048 sc1
    s_waitcnt vmcnt(13)
    v_mfma_f32_16x16x32_bf16 v[60:63], v[136:139], a[96:99], v[60:63]
    v_mfma_f32_16x16x32_bf16 v[64:67], v[136:139], a[100:103], v[64:67]
    v_mfma_f32_16x16x32_bf16 v[68:71], v[136:139], a[104:107], v[68:71]
    v_mfma_f32_16x16x32_bf16 v[72:75], v[136:139], a[108:111], v[72:75]
    s_add_u32 s60, s68, 0
    buffer_load_dwordx4 v[136:139], v5, s[36:39], s60 offen offset:3072 sc1
    s_waitcnt vmcnt(13)
    v_mfma_f32_16x16x32_bf16 v[76:79], v[140:143], a[96:99], v[76:79]
    v_mfma_f32_16x16x32_bf16 v[80:83], v[140:143], a[100:103], v[80:83]
    v_mfma_f32_16x16x32_bf16 v[84:87], v[140:143], a[104:107], v[84:87]
    v_mfma_f32_16x16x32_bf16 v[88:91], v[140:143], a[108:111], v[88:91]
    s_add_u32 s60, s68, 4096
    buffer_load_dwordx4 v[140:143], v5, s[36:39], s60 offen offset:0 sc1
    s_waitcnt vmcnt(13)
    v_mfma_f32_16x16x32_bf16 v[92:95], v[144:147], a[96:99], v[92:95]
    v_mfma_f32_16x16x32_bf16 v[96:99], v[144:147], a[100:103], v[96:99]
    v_mfma_f32_16x16x32_bf16 v[100:103], v[144:147], a[104:107], v[100:103]
    v_mfma_f32_16x16x32_bf16 v[104:107], v[144:147], a[108:111], v[104:107]
    s_add_u32 s60, s68, 4096
    buffer_load_dwordx4 v[144:147], v5, s[36:39], s60 offen offset:1024 sc1
    s_waitcnt vmcnt(13)
    v_mfma_f32_16x16x32_bf16 v[108:111], v[148:151], a[96:99], v[108:111]
    v_mfma_f32_16x16x32_bf16 v[112:115], v[148:151], a[100:103], v[112:115]
    v_mfma_f32_16x16x32_bf16 v[116:119], v[148:151], a[104:107], v[116:119]
    v_mfma_f32_16x16x32_bf16 v[120:123], v[148:151], a[108:111], v[120:123]
    s_add_u32 s60, s68, 4096
    buffer_load_dwordx4 v[148:151], v5, s[36:39], s60 offen offset:2048 sc1
    s_waitcnt vmcnt(13)
    v_mfma_f32_16x16x32_bf16 v[12:15], v[152:155], a[112:115], v[12:15]
    v_mfma_f32_16x16x32_bf16 v[16:19], v[152:155], a[116:119], v[16:19]
    v_mfma_f32_16x16x32_bf16 v[20:23], v[152:155], a[120:123], v[20:23]
    v_mfma_f32_16x16x32_bf16 v[24:27], v[152:155], a[124:127], v[24:27]
    s_add_u32 s60, s68, 7168
    buffer_load_dwordx4 v[152:155], v5, s[36:39], s60 offen offset:0 sc1
    s_waitcnt vmcnt(13)
    v_mfma_f32_16x16x32_bf16 v[28:31], v[156:159], a[112:115], v[28:31]
    v_mfma_f32_16x16x32_bf16 v[32:35], v[156:159], a[116:119], v[32:35]
    v_mfma_f32_16x16x32_bf16 v[36:39], v[156:159], a[120:123], v[36:39]
    v_mfma_f32_16x16x32_bf16 v[40:43], v[156:159], a[124:127], v[40:43]
    s_add_u32 s60, s68, 7168
    buffer_load_dwordx4 v[156:159], v5, s[36:39], s60 offen offset:1024 sc1
    s_waitcnt vmcnt(13)
    v_mfma_f32_16x16x32_bf16 v[44:47], v[160:163], a[112:115], v[44:47]
    v_mfma_f32_16x16x32_bf16 v[48:51], v[160:163], a[116:119], v[48:51]
    v_mfma_f32_16x16x32_bf16 v[52:55], v[160:163], a[120:123], v[52:55]
    v_mfma_f32_16x16x32_bf16 v[56:59], v[160:163], a[124:127], v[56:59]
    s_add_u32 s60, s68, 7168
    buffer_load_dwordx4 v[160:163], v5, s[36:39], s60 offen offset:2048 sc1
    s_waitcnt vmcnt(13)
    v_mfma_f32_16x16x32_bf16 v[60:63], v[164:167], a[112:115], v[60:63]
    v_mfma_f32_16x16x32_bf16 v[64:67], v[164:167], a[116:119], v[64:67]
    v_mfma_f32_16x16x32_bf16 v[68:71], v[164:167], a[120:123], v[68:71]
    v_mfma_f32_16x16x32_bf16 v[72:75], v[164:167], a[124:127], v[72:75]
    s_add_u32 s60, s68, 7168
    buffer_load_dwordx4 v[164:167], v5, s[36:39], s60 offen offset:3072 sc1
    s_waitcnt vmcnt(13)
    v_mfma_f32_16x16x32_bf16 v[76:79], v[168:171], a[112:115], v[76:79]
    v_mfma_f32_16x16x32_bf16 v[80:83], v[168:171], a[116:119], v[80:83]
    v_mfma_f32_16x16x32_bf16 v[84:87], v[168:171], a[120:123], v[84:87]
    v_mfma_f32_16x16x32_bf16 v[88:91], v[168:171], a[124:127], v[88:91]
    s_add_u32 s60, s68, 11264
    buffer_load_dwordx4 v[168:171], v5, s[36:39], s60 offen offset:0 sc1
    s_waitcnt vmcnt(13)
    v_mfma_f32_16x16x32_bf16 v[92:95], v[172:175], a[112:115], v[92:95]
    v_mfma_f32_16x16x32_bf16 v[96:99], v[172:175], a[116:119], v[96:99]
    v_mfma_f32_16x16x32_bf16 v[100:103], v[172:175], a[120:123], v[100:103]
    v_mfma_f32_16x16x32_bf16 v[104:107], v[172:175], a[124:127], v[104:107]
    s_add_u32 s60, s68, 11264
    buffer_load_dwordx4 v[172:175], v5, s[36:39], s60 offen offset:1024 sc1
    s_waitcnt vmcnt(13)
    v_mfma_f32_16x16x32_bf16 v[108:111], v[176:179], a[112:115], v[108:111]
    v_mfma_f32_16x16x32_bf16 v[112:115], v[176:179], a[116:119], v[112:115]
    v_mfma_f32_16x16x32_bf16 v[116:119], v[176:179], a[120:123], v[116:119]
    v_mfma_f32_16x16x32_bf16 v[120:123], v[176:179], a[124:127], v[120:123]
    s_add_u32 s60, s68, 11264
    buffer_load_dwordx4 v[176:179], v5, s[36:39], s60 offen offset:2048 sc1
    s_waitcnt vmcnt(13)
    v_mfma_f32_16x16x32_bf16 v[12:15], v[124:127], a[128:131], v[12:15]
    v_mfma_f32_16x16x32_bf16 v[16:19], v[124:127], a[132:135], v[16:19]
    v_mfma_f32_16x16x32_bf16 v[20:23], v[124:127], a[136:139], v[20:23]
    v_mfma_f32_16x16x32_bf16 v[24:27], v[124:127], a[140:143], v[24:27]
    s_add_u32 s60, s69, 0
    buffer_load_dwordx4 v[124:127], v5, s[36:39], s60 offen offset:0 sc1
    s_waitcnt vmcnt(13)
    v_mfma_f32_16x16x32_bf16 v[28:31], v[128:131], a[128:131], v[28:31]
    v_mfma_f32_16x16x32_bf16 v[32:35], v[128:131], a[132:135], v[32:35]
    v_mfma_f32_16x16x32_bf16 v[36:39], v[128:131], a[136:139], v[36:39]
    v_mfma_f32_16x16x32_bf16 v[40:43], v[128:131], a[140:143], v[40:43]
    s_add_u32 s60, s69, 0
    buffer_load_dwordx4 v[128:131], v5, s[36:39], s60 offen offset:1024 sc1
    s_waitcnt vmcnt(13)
    v_mfma_f32_16x16x32_bf16 v[44:47], v[132:135], a[128:131], v[44:47]
    v_mfma_f32_16x16x32_bf16 v[48:51], v[132:135], a[132:135], v[48:51]
    v_mfma_f32_16x16x32_bf16 v[52:55], v[132:135], a[136:139], v[52:55]
    v_mfma_f32_16x16x32_bf16 v[56:59], v[132:135], a[140:143], v[56:59]
    s_add_u32 s60, s69, 0
    buffer_load_dwordx4 v[132:135], v5, s[36:39], s60 offen offset:2048 sc1
    s_waitcnt vmcnt(13)
    v_mfma_f32_16x16x32_bf16 v[60:63], v[136:139], a[128:131], v[60:63]
    v_mfma_f32_16x16x32_bf16 v[64:67], v[136:139], a[132:135], v[64:67]
    v_mfma_f32_16x16x32_bf16 v[68:71], v[136:139], a[136:139], v[68:71]
    v_mfma_f32_16x16x32_bf16 v[72:75], v[136:139], a[140:143], v[72:75]
    s_add_u32 s60, s69, 0
    buffer_load_dwordx4 v[136:139], v5, s[36:39], s60 offen offset:3072 sc1
    s_waitcnt vmcnt(13)
    v_mfma_f32_16x16x32_bf16 v[76:79], v[140:143], a[128:131], v[76:79]
    v_mfma_f32_16x16x32_bf16 v[80:83], v[140:143], a[132:135], v[80:83]
    v_mfma_f32_16x16x32_bf16 v[84:87], v[140:143], a[136:139], v[84:87]
    v_mfma_f32_16x16x32_bf16 v[88:91], v[140:143], a[140:143], v[88:91]
    s_add_u32 s60, s69, 4096
    buffer_load_dwordx4 v[140:143], v5, s[36:39], s60 offen offset:0 sc1
    s_waitcnt vmcnt(13)
    v_mfma_f32_16x16x32_bf16 v[92:95], v[144:147], a[128:131], v[92:95]
    v_mfma_f32_16x16x32_bf16 v[96:99], v[144:147], a[132:135], v[96:99]
    v_mfma_f32_16x16x32_bf16 v[100:103], v[144:147], a[136:139], v[100:103]
    v_mfma_f32_16x16x32_bf16 v[104:107], v[144:147], a[140:143], v[104:107]
    s_add_u32 s60, s69, 4096
    buffer_load_dwordx4 v[144:147], v5, s[36:39], s60 offen offset:1024 sc1
    s_waitcnt vmcnt(13)
    v_mfma_f32_16x16x32_bf16 v[108:111], v[148:151], a[128:131], v[108:111]
    v_mfma_f32_16x16x32_bf16 v[112:115], v[148:151], a[132:135], v[112:115]
    v_mfma_f32_16x16x32_bf16 v[116:119], v[148:151], a[136:139], v[116:119]
    v_mfma_f32_16x16x32_bf16 v[120:123], v[148:151], a[140:143], v[120:123]
    s_add_u32 s60, s69, 4096
    buffer_load_dwordx4 v[148:151], v5, s[36:39], s60 offen offset:2048 sc1
    s_waitcnt vmcnt(13)
    v_mfma_f32_16x16x32_bf16 v[12:15], v[152:155], a[144:147], v[12:15]
    v_mfma_f32_16x16x32_bf16 v[16:19], v[152:155], a[148:151], v[16:19]
    v_mfma_f32_16x16x32_bf16 v[20:23], v[152:155], a[152:155], v[20:23]
    v_mfma_f32_16x16x32_bf16 v[24:27], v[152:155], a[156:159], v[24:27]
    s_add_u32 s60, s69, 7168
    buffer_load_dwordx4 v[152:155], v5, s[36:39], s60 offen offset:0 sc1
    s_waitcnt vmcnt(13)
    v_mfma_f32_16x16x32_bf16 v[28:31], v[156:159], a[144:147], v[28:31]
    v_mfma_f32_16x16x32_bf16 v[32:35], v[156:159], a[148:151], v[32:35]
    v_mfma_f32_16x16x32_bf16 v[36:39], v[156:159], a[152:155], v[36:39]
    v_mfma_f32_16x16x32_bf16 v[40:43], v[156:159], a[156:159], v[40:43]
    s_add_u32 s60, s69, 7168
    buffer_load_dwordx4 v[156:159], v5, s[36:39], s60 offen offset:1024 sc1
    s_waitcnt vmcnt(13)
    v_mfma_f32_16x16x32_bf16 v[44:47], v[160:163], a[144:147], v[44:47]
    v_mfma_f32_16x16x32_bf16 v[48:51], v[160:163], a[148:151], v[48:51]
    v_mfma_f32_16x16x32_bf16 v[52:55], v[160:163], a[152:155], v[52:55]
    v_mfma_f32_16x16x32_bf16 v[56:59], v[160:163], a[156:159], v[56:59]
    s_add_u32 s60, s69, 7168
    buffer_load_dwordx4 v[160:163], v5, s[36:39], s60 offen offset:2048 sc1
    s_waitcnt vmcnt(13)
    v_mfma_f32_16x16x32_bf16 v[60:63], v[164:167], a[144:147], v[60:63]
    v_mfma_f32_16x16x32_bf16 v[64:67], v[164:167], a[148:151], v[64:67]
    v_mfma_f32_16x16x32_bf16 v[68:71], v[164:167], a[152:155], v[68:71]
    v_mfma_f32_16x16x32_bf16 v[72:75], v[164:167], a[156:159], v[72:75]
    s_add_u32 s60, s69, 7168
    buffer_load_dwordx4 v[164:167], v5, s[36:39], s60 offen offset:3072 sc1
    s_waitcnt vmcnt(13)
    v_mfma_f32_16x16x32_bf16 v[76:79], v[168:171], a[144:147], v[76:79]
    v_mfma_f32_16x16x32_bf16 v[80:83], v[168:171], a[148:151], v[80:83]
    v_mfma_f32_16x16x32_bf16 v[84:87], v[168:171], a[152:155], v[84:87]
    v_mfma_f32_16x16x32_bf16 v[88:91], v[168:171], a[156:159], v[88:91]
    s_add_u32 s60, s69, 11264
    buffer_load_dwordx4 v[168:171], v5, s[36:39], s60 offen offset:0 sc1
    s_waitcnt vmcnt(13)
    v_mfma_f32_16x16x32_bf16 v[92:95], v[172:175], a[144:147], v[92:95]
    v_mfma_f32_16x16x32_bf16 v[96:99], v[172:175], a[148:151], v[96:99]
    v_mfma_f32_16x16x32_bf16 v[100:103], v[172:175], a[152:155], v[100:103]
    v_mfma_f32_16x16x32_bf16 v[104:107], v[172:175], a[156:159], v[104:107]
    s_add_u32 s60, s69, 11264
    buffer_load_dwordx4 v[172:175], v5, s[36:39], s60 offen offset:1024 sc1
    s_waitcnt vmcnt(13)
    v_mfma_f32_16x16x32_bf16 v[108:111], v[176:179], a[144:147], v[108:111]
    v_mfma_f32_16x16x32_bf16 v[112:115], v[176:179], a[148:151], v[112:115]
    v_mfma_f32_16x16x32_bf16 v[116:119], v[176:179], a[152:155], v[116:119]
    v_mfma_f32_16x16x32_bf16 v[120:123], v[176:179], a[156:159], v[120:123]
    s_add_u32 s60, s69, 11264
    buffer_load_dwordx4 v[176:179], v5, s[36:39], s60 offen offset:2048 sc1
    s_waitcnt vmcnt(13)
    v_mfma_f32_16x16x32_bf16 v[12:15], v[124:127], a[160:163], v[12:15]
    v_mfma_f32_16x16x32_bf16 v[16:19], v[124:127], a[164:167], v[16:19]
    v_mfma_f32_16x16x32_bf16 v[20:23], v[124:127], a[168:171], v[20:23]
    v_mfma_f32_16x16x32_bf16 v[24:27], v[124:127], a[172:175], v[24:27]
    s_add_u32 s60, s70, 0
    buffer_load_dwordx4 v[124:127], v5, s[36:39], s60 offen offset:0 sc1
    s_waitcnt vmcnt(13)
    v_mfma_f32_16x16x32_bf16 v[28:31], v[128:131], a[160:163], v[28:31]
    v_mfma_f32_16x16x32_bf16 v[32:35], v[128:131], a[164:167], v[32:35]
    v_mfma_f32_16x16x32_bf16 v[36:39], v[128:131], a[168:171], v[36:39]
    v_mfma_f32_16x16x32_bf16 v[40:43], v[128:131], a[172:175], v[40:43]
    s_add_u32 s60, s70, 0
    buffer_load_dwordx4 v[128:131], v5, s[36:39], s60 offen offset:1024 sc1
    s_waitcnt vmcnt(13)
    v_mfma_f32_16x16x32_bf16 v[44:47], v[132:135], a[160:163], v[44:47]
    v_mfma_f32_16x16x32_bf16 v[48:51], v[132:135], a[164:167], v[48:51]
    v_mfma_f32_16x16x32_bf16 v[52:55], v[132:135], a[168:171], v[52:55]
    v_mfma_f32_16x16x32_bf16 v[56:59], v[132:135], a[172:175], v[56:59]
    s_add_u32 s60, s70, 0
    buffer_load_dwordx4 v[132:135], v5, s[36:39], s60 offen offset:2048 sc1
    s_waitcnt vmcnt(13)
    v_mfma_f32_16x16x32_bf16 v[60:63], v[136:139], a[160:163], v[60:63]
    v_mfma_f32_16x16x32_bf16 v[64:67], v[136:139], a[164:167], v[64:67]
    v_mfma_f32_16x16x32_bf16 v[68:71], v[136:139], a[168:171], v[68:71]
    v_mfma_f32_16x16x32_bf16 v[72:75], v[136:139], a[172:175], v[72:75]
    s_add_u32 s60, s70, 0
    buffer_load_dwordx4 v[136:139], v5, s[36:39], s60 offen offset:3072 sc1
    s_waitcnt vmcnt(13)
    v_mfma_f32_16x16x32_bf16 v[76:79], v[140:143], a[160:163], v[76:79]
    v_mfma_f32_16x16x32_bf16 v[80:83], v[140:143], a[164:167], v[80:83]
    v_mfma_f32_16x16x32_bf16 v[84:87], v[140:143], a[168:171], v[84:87]
    v_mfma_f32_16x16x32_bf16 v[88:91], v[140:143], a[172:175], v[88:91]
    s_add_u32 s60, s70, 4096
    buffer_load_dwordx4 v[140:143], v5, s[36:39], s60 offen offset:0 sc1
    s_waitcnt vmcnt(13)
    v_mfma_f32_16x16x32_bf16 v[92:95], v[144:147], a[160:163], v[92:95]
    v_mfma_f32_16x16x32_bf16 v[96:99], v[144:147], a[164:167], v[96:99]
    v_mfma_f32_16x16x32_bf16 v[100:103], v[144:147], a[168:171], v[100:103]
    v_mfma_f32_16x16x32_bf16 v[104:107], v[144:147], a[172:175], v[104:107]
    s_add_u32 s60, s70, 4096
    buffer_load_dwordx4 v[144:147], v5, s[36:39], s60 offen offset:1024 sc1
    s_waitcnt vmcnt(13)
    v_mfma_f32_16x16x32_bf16 v[108:111], v[148:151], a[160:163], v[108:111]
    v_mfma_f32_16x16x32_bf16 v[112:115], v[148:151], a[164:167], v[112:115]
    v_mfma_f32_16x16x32_bf16 v[116:119], v[148:151], a[168:171], v[116:119]
    v_mfma_f32_16x16x32_bf16 v[120:123], v[148:151], a[172:175], v[120:123]
    s_add_u32 s60, s70, 4096
    buffer_load_dwordx4 v[148:151], v5, s[36:39], s60 offen offset:2048 sc1
    s_waitcnt vmcnt(13)
    v_mfma_f32_16x16x32_bf16 v[12:15], v[152:155], a[176:179], v[12:15]
    v_mfma_f32_16x16x32_bf16 v[16:19], v[152:155], a[180:183], v[16:19]
    v_mfma_f32_16x16x32_bf16 v[20:23], v[152:155], a[184:187], v[20:23]
    v_mfma_f32_16x16x32_bf16 v[24:27], v[152:155], a[188:191], v[24:27]
    s_add_u32 s60, s70, 7168
    buffer_load_dwordx4 v[152:155], v5, s[36:39], s60 offen offset:0 sc1
    s_waitcnt vmcnt(13)
    v_mfma_f32_16x16x32_bf16 v[28:31], v[156:159], a[176:179], v[28:31]
    v_mfma_f32_16x16x32_bf16 v[32:35], v[156:159], a[180:183], v[32:35]
    v_mfma_f32_16x16x32_bf16 v[36:39], v[156:159], a[184:187], v[36:39]
    v_mfma_f32_16x16x32_bf16 v[40:43], v[156:159], a[188:191], v[40:43]
    s_add_u32 s60, s70, 7168
    buffer_load_dwordx4 v[156:159], v5, s[36:39], s60 offen offset:1024 sc1
    s_waitcnt vmcnt(13)
    v_mfma_f32_16x16x32_bf16 v[44:47], v[160:163], a[176:179], v[44:47]
    v_mfma_f32_16x16x32_bf16 v[48:51], v[160:163], a[180:183], v[48:51]
    v_mfma_f32_16x16x32_bf16 v[52:55], v[160:163], a[184:187], v[52:55]
    v_mfma_f32_16x16x32_bf16 v[56:59], v[160:163], a[188:191], v[56:59]
    s_add_u32 s60, s70, 7168
    buffer_load_dwordx4 v[160:163], v5, s[36:39], s60 offen offset:2048 sc1
    s_waitcnt vmcnt(13)
    v_mfma_f32_16x16x32_bf16 v[60:63], v[164:167], a[176:179], v[60:63]
    v_mfma_f32_16x16x32_bf16 v[64:67], v[164:167], a[180:183], v[64:67]
    v_mfma_f32_16x16x32_bf16 v[68:71], v[164:167], a[184:187], v[68:71]
    v_mfma_f32_16x16x32_bf16 v[72:75], v[164:167], a[188:191], v[72:75]
    s_add_u32 s60, s70, 7168
    buffer_load_dwordx4 v[164:167], v5, s[36:39], s60 offen offset:3072 sc1
    s_waitcnt vmcnt(13)
    v_mfma_f32_16x16x32_bf16 v[76:79], v[168:171], a[176:179], v[76:79]
    v_mfma_f32_16x16x32_bf16 v[80:83], v[168:171], a[180:183], v[80:83]
    v_mfma_f32_16x16x32_bf16 v[84:87], v[168:171], a[184:187], v[84:87]
    v_mfma_f32_16x16x32_bf16 v[88:91], v[168:171], a[188:191], v[88:91]
    s_add_u32 s60, s70, 11264
    buffer_load_dwordx4 v[168:171], v5, s[36:39], s60 offen offset:0 sc1
    s_waitcnt vmcnt(13)
    v_mfma_f32_16x16x32_bf16 v[92:95], v[172:175], a[176:179], v[92:95]
    v_mfma_f32_16x16x32_bf16 v[96:99], v[172:175], a[180:183], v[96:99]
    v_mfma_f32_16x16x32_bf16 v[100:103], v[172:175], a[184:187], v[100:103]
    v_mfma_f32_16x16x32_bf16 v[104:107], v[172:175], a[188:191], v[104:107]
    s_add_u32 s60, s70, 11264
    buffer_load_dwordx4 v[172:175], v5, s[36:39], s60 offen offset:1024 sc1
    s_waitcnt vmcnt(13)
    v_mfma_f32_16x16x32_bf16 v[108:111], v[176:179], a[176:179], v[108:111]
    v_mfma_f32_16x16x32_bf16 v[112:115], v[176:179], a[180:183], v[112:115]
    v_mfma_f32_16x16x32_bf16 v[116:119], v[176:179], a[184:187], v[116:119]
    v_mfma_f32_16x16x32_bf16 v[120:123], v[176:179], a[188:191], v[120:123]
    s_add_u32 s60, s70, 11264
    buffer_load_dwordx4 v[176:179], v5, s[36:39], s60 offen offset:2048 sc1
    s_waitcnt vmcnt(13)
    v_mfma_f32_16x16x32_bf16 v[12:15], v[124:127], a[192:195], v[12:15]
    v_mfma_f32_16x16x32_bf16 v[16:19], v[124:127], a[196:199], v[16:19]
    v_mfma_f32_16x16x32_bf16 v[20:23], v[124:127], a[200:203], v[20:23]
    v_mfma_f32_16x16x32_bf16 v[24:27], v[124:127], a[204:207], v[24:27]
    s_add_u32 s60, s71, 0
    buffer_load_dwordx4 v[124:127], v5, s[36:39], s60 offen offset:0 sc1
    s_waitcnt vmcnt(13)
    v_mfma_f32_16x16x32_bf16 v[28:31], v[128:131], a[192:195], v[28:31]
    v_mfma_f32_16x16x32_bf16 v[32:35], v[128:131], a[196:199], v[32:35]
    v_mfma_f32_16x16x32_bf16 v[36:39], v[128:131], a[200:203], v[36:39]
    v_mfma_f32_16x16x32_bf16 v[40:43], v[128:131], a[204:207], v[40:43]
    s_waitcnt vmcnt(12)
    v_mfma_f32_16x16x32_bf16 v[44:47], v[132:135], a[192:195], v[44:47]
    v_mfma_f32_16x16x32_bf16 v[48:51], v[132:135], a[196:199], v[48:51]
    v_mfma_f32_16x16x32_bf16 v[52:55], v[132:135], a[200:203], v[52:55]
    v_mfma_f32_16x16x32_bf16 v[56:59], v[132:135], a[204:207], v[56:59]
    s_waitcnt vmcnt(11)
    v_mfma_f32_16x16x32_bf16 v[60:63], v[136:139], a[192:195], v[60:63]
    v_mfma_f32_16x16x32_bf16 v[64:67], v[136:139], a[196:199], v[64:67]
    v_mfma_f32_16x16x32_bf16 v[68:71], v[136:139], a[200:203], v[68:71]
    v_mfma_f32_16x16x32_bf16 v[72:75], v[136:139], a[204:207], v[72:75]
    s_waitcnt vmcnt(10)
    v_mfma_f32_16x16x32_bf16 v[76:79], v[140:143], a[192:195], v[76:79]
    v_mfma_f32_16x16x32_bf16 v[80:83], v[140:143], a[196:199], v[80:83]
    v_mfma_f32_16x16x32_bf16 v[84:87], v[140:143], a[200:203], v[84:87]
    v_mfma_f32_16x16x32_bf16 v[88:91], v[140:143], a[204:207], v[88:91]
    s_waitcnt vmcnt(9)
    v_mfma_f32_16x16x32_bf16 v[92:95], v[144:147], a[192:195], v[92:95]
    v_mfma_f32_16x16x32_bf16 v[96:99], v[144:147], a[196:199], v[96:99]
    v_mfma_f32_16x16x32_bf16 v[100:103], v[144:147], a[200:203], v[100:103]
    v_mfma_f32_16x16x32_bf16 v[104:107], v[144:147], a[204:207], v[104:107]
    s_waitcnt vmcnt(8)
    v_mfma_f32_16x16x32_bf16 v[108:111], v[148:151], a[192:195], v[108:111]
    v_mfma_f32_16x16x32_bf16 v[112:115], v[148:151], a[196:199], v[112:115]
    v_mfma_f32_16x16x32_bf16 v[116:119], v[148:151], a[200:203], v[116:119]
    v_mfma_f32_16x16x32_bf16 v[120:123], v[148:151], a[204:207], v[120:123]
    s_waitcnt vmcnt(7)
    v_mfma_f32_16x16x32_bf16 v[12:15], v[152:155], a[208:211], v[12:15]
    v_mfma_f32_16x16x32_bf16 v[16:19], v[152:155], a[212:215], v[16:19]
    v_mfma_f32_16x16x32_bf16 v[20:23], v[152:155], a[216:219], v[20:23]
    v_mfma_f32_16x16x32_bf16 v[24:27], v[152:155], a[220:223], v[24:27]
    s_add_u32 s60, s71, 7168
    buffer_load_dwordx4 v[152:155], v5, s[36:39], s60 offen offset:0 sc1
    s_add_u32 s60, s71, 0
    buffer_load_dwordx4 v[128:131], v5, s[36:39], s60 offen offset:1024 sc1
    s_waitcnt vmcnt(8)
    v_mfma_f32_16x16x32_bf16 v[28:31], v[156:159], a[208:211], v[28:31]
    v_mfma_f32_16x16x32_bf16 v[32:35], v[156:159], a[212:215], v[32:35]
    v_mfma_f32_16x16x32_bf16 v[36:39], v[156:159], a[216:219], v[36:39]
    v_mfma_f32_16x16x32_bf16 v[40:43], v[156:159], a[220:223], v[40:43]
    s_add_u32 s60, s71, 7168
    buffer_load_dwordx4 v[156:159], v5, s[36:39], s60 offen offset:1024 sc1
    s_add_u32 s60, s71, 0
    buffer_load_dwordx4 v[132:135], v5, s[36:39], s60 offen offset:2048 sc1
    s_waitcnt vmcnt(9)
    v_mfma_f32_16x16x32_bf16 v[44:47], v[160:163], a[208:211], v[44:47]
    v_mfma_f32_16x16x32_bf16 v[48:51], v[160:163], a[212:215], v[48:51]
    v_mfma_f32_16x16x32_bf16 v[52:55], v[160:163], a[216:219], v[52:55]
    v_mfma_f32_16x16x32_bf16 v[56:59], v[160:163], a[220:223], v[56:59]
    s_add_u32 s60, s71, 7168
    buffer_load_dwordx4 v[160:163], v5, s[36:39], s60 offen offset:2048 sc1
    s_add_u32 s60, s71, 0
    buffer_load_dwordx4 v[136:139], v5, s[36:39], s60 offen offset:3072 sc1
    s_waitcnt vmcnt(10)
    v_mfma_f32_16x16x32_bf16 v[60:63], v[164:167], a[208:211], v[60:63]
    v_mfma_f32_16x16x32_bf16 v[64:67], v[164:167], a[212:215], v[64:67]
    v_mfma_f32_16x16x32_bf16 v[68:71], v[164:167], a[216:219], v[68:71]
    v_mfma_f32_16x16x32_bf16 v[72:75], v[164:167], a[220:223], v[72:75]
    s_add_u32 s60, s71, 7168
    buffer_load_dwordx4 v[164:167], v5, s[36:39], s60 offen offset:3072 sc1
    s_add_u32 s60, s71, 4096
    buffer_load_dwordx4 v[140:143], v5, s[36:39], s60 offen offset:0 sc1
    s_waitcnt vmcnt(11)
    v_mfma_f32_16x16x32_bf16 v[76:79], v[168:171], a[208:211], v[76:79]
    v_mfma_f32_16x16x32_bf16 v[80:83], v[168:171], a[212:215], v[80:83]
    v_mfma_f32_16x16x32_bf16 v[84:87], v[168:171], a[216:219], v[84:87]
    v_mfma_f32_16x16x32_bf16 v[88:91], v[168:171], a[220:223], v[88:91]
    s_add_u32 s60, s71, 11264
    buffer_load_dwordx4 v[168:171], v5, s[36:39], s60 offen offset:0 sc1
    s_add_u32 s60, s71, 4096
    buffer_load_dwordx4 v[144:147], v5, s[36:39], s60 offen offset:1024 sc1
    s_waitcnt vmcnt(12)
    v_mfma_f32_16x16x32_bf16 v[92:95], v[172:175], a[208:211], v[92:95]
    v_mfma_f32_16x16x32_bf16 v[96:99], v[172:175], a[212:215], v[96:99]
    v_mfma_f32_16x16x32_bf16 v[100:103], v[172:175], a[216:219], v[100:103]
    v_mfma_f32_16x16x32_bf16 v[104:107], v[172:175], a[220:223], v[104:107]
    s_add_u32 s60, s71, 11264
    buffer_load_dwordx4 v[172:175], v5, s[36:39], s60 offen offset:1024 sc1
    s_add_u32 s60, s71, 4096
    buffer_load_dwordx4 v[148:151], v5, s[36:39], s60 offen offset:2048 sc1
    s_waitcnt vmcnt(13)
    v_mfma_f32_16x16x32_bf16 v[108:111], v[176:179], a[208:211], v[108:111]
    v_mfma_f32_16x16x32_bf16 v[112:115], v[176:179], a[212:215], v[112:115]
    v_mfma_f32_16x16x32_bf16 v[116:119], v[176:179], a[216:219], v[116:119]
    v_mfma_f32_16x16x32_bf16 v[120:123], v[176:179], a[220:223], v[120:123]
    s_add_u32 s60, s71, 11264
    buffer_load_dwordx4 v[176:179], v5, s[36:39], s60 offen offset:2048 sc1
    s_waitcnt vmcnt(13)
    v_mfma_f32_16x16x32_bf16 v[12:15], v[124:127], a[224:227], v[12:15]
    v_mfma_f32_16x16x32_bf16 v[16:19], v[124:127], a[228:231], v[16:19]
    v_mfma_f32_16x16x32_bf16 v[20:23], v[124:127], a[232:235], v[20:23]
    v_mfma_f32_16x16x32_bf16 v[24:27], v[124:127], a[236:239], v[24:27]
    s_add_u32 s73, s90, 0
    s_add_u32 m0, s91, 0
    s_nop 0
    buffer_load_dwordx4 v5, s[36:39], s73 offen sc1 lds
    s_waitcnt vmcnt(13)
    v_mfma_f32_16x16x32_bf16 v[12:15], v[152:155], a[240:243], v[12:15]
    v_mfma_f32_16x16x32_bf16 v[16:19], v[152:155], a[244:247], v[16:19]
    v_mfma_f32_16x16x32_bf16 v[20:23], v[152:155], a[248:251], v[20:23]
    v_mfma_f32_16x16x32_bf16 v[24:27], v[152:155], a[252:255], v[24:27]
    s_add_u32 s73, s90, 4096
    s_add_u32 m0, s91, 4096
    s_nop 0
    buffer_load_dwordx4 v5, s[36:39], s73 offen sc1 lds
    s_waitcnt vmcnt(13)
    v_mfma_f32_16x16x32_bf16 v[28:31], v[128:131], a[224:227], v[28:31]
    v_mfma_f32_16x16x32_bf16 v[32:35], v[128:131], a[228:231], v[32:35]
    v_mfma_f32_16x16x32_bf16 v[36:39], v[128:131], a[232:235], v[36:39]
    v_mfma_f32_16x16x32_bf16 v[40:43], v[128:131], a[236:239], v[40:43]
    s_add_u32 s73, s90, 8192
    s_add_u32 m0, s91, 8192
    s_nop 0
    buffer_load_dwordx4 v5, s[36:39], s73 offen sc1 lds
    s_waitcnt vmcnt(13)
    v_mfma_f32_16x16x32_bf16 v[28:31], v[156:159], a[240:243], v[28:31]
    v_mfma_f32_16x16x32_bf16 v[32:35], v[156:159], a[244:247], v[32:35]
    ds_write_b128 v183, v[16:19] offset:0
    v_mfma_f32_16x16x32_bf16 v[36:39], v[156:159], a[248:251], v[36:39]
    ds_write_b128 v184, v[20:23] offset:0
    v_mfma_f32_16x16x32_bf16 v[40:43], v[156:159], a[252:255], v[40:43]
    ds_write_b128 v185, v[24:27] offset:0
    s_add_u32 s73, s90, 12288
    s_add_u32 m0, s91, 12288
    s_nop 0
    buffer_load_dwordx4 v5, s[36:39], s73 offen sc1 lds
    s_waitcnt vmcnt(13)
    v_mfma_f32_16x16x32_bf16 v[44:47], v[132:135], a[224:227], v[44:47]
    v_mfma_f32_16x16x32_bf16 v[48:51], v[132:135], a[228:231], v[48:51]
    v_mfma_f32_16x16x32_bf16 v[52:55], v[132:135], a[232:235], v[52:55]
    v_mfma_f32_16x16x32_bf16 v[56:59], v[132:135], a[236:239], v[56:59]
    s_add_u32 s73, s90, 16384
    s_add_u32 m0, s91, 16384
    s_nop 0
    buffer_load_dwordx4 v5, s[36:39], s73 offen sc1 lds
    s_waitcnt vmcnt(13)
    v_mfma_f32_16x16x32_bf16 v[44:47], v[160:163], a[240:243], v[44:47]
    v_mfma_f32_16x16x32_bf16 v[48:51], v[160:163], a[244:247], v[48:51]
    ds_write_b128 v183, v[32:35] offset:1024
    v_mfma_f32_16x16x32_bf16 v[52:55], v[160:163], a[248:251], v[52:55]
    ds_write_b128 v184, v[36:39] offset:1024
    v_mfma_f32_16x16x32_bf16 v[56:59], v[160:163], a[252:255], v[56:59]
    ds_write_b128 v185, v[40:43] offset:1024
    s_add_u32 s73, s90, 20480
    s_add_u32 m0, s91, 20480
    s_nop 0
    buffer_load_dwordx4 v5, s[36:39], s73 offen sc1 lds
    s_waitcnt vmcnt(13)
    v_mfma_f32_16x16x32_bf16 v[60:63], v[136:139], a[224:227], v[60:63]
    v_mfma_f32_16x16x32_bf16 v[64:67], v[136:139], a[228:231], v[64:67]
    v_mfma_f32_16x16x32_bf16 v[68:71], v[136:139], a[232:235], v[68:71]
    v_mfma_f32_16x16x32_bf16 v[72:75], v[136:139], a[236:239], v[72:75]
    s_add_u32 s73, s90, 24576
    s_add_u32 m0, s91, 24576
    s_nop 0
    buffer_load_dwordx4 v5, s[36:39], s73 offen sc1 lds
    s_waitcnt vmcnt(13)
    v_mfma_f32_16x16x32_bf16 v[60:63], v[164:167], a[240:243], v[60:63]
    v_mfma_f32_16x16x32_bf16 v[64:67], v[164:167], a[244:247], v[64:67]
    ds_write_b128 v183, v[48:51] offset:2048
    v_mfma_f32_16x16x32_bf16 v[68:71], v[164:167], a[248:251], v[68:71]
    ds_write_b128 v184, v[52:55] offset:2048
    v_mfma_f32_16x16x32_bf16 v[72:75], v[164:167], a[252:255], v[72:75]
    ds_write_b128 v185, v[56:59] offset:2048
    s_add_u32 s73, s90, 28672
    s_add_u32 m0, s91, 28672
    s_nop 0
    buffer_load_dwordx4 v5, s[36:39], s73 offen sc1 lds
    s_waitcnt vmcnt(13)
    v_mfma_f32_16x16x32_bf16 v[76:79], v[140:143], a[224:227], v[76:79]
    v_mfma_f32_16x16x32_bf16 v[80:83], v[140:143], a[228:231], v[80:83]
    v_mfma_f32_16x16x32_bf16 v[84:87], v[140:143], a[232:235], v[84:87]
    v_mfma_f32_16x16x32_bf16 v[88:91], v[140:143], a[236:239], v[88:91]
    s_add_u32 s73, s90, 32768
    s_add_u32 m0, s91, 32768
    s_nop 0
    buffer_load_dwordx4 v5, s[36:39], s73 offen sc1 lds
    s_waitcnt vmcnt(13)
    v_mfma_f32_16x16x32_bf16 v[76:79], v[168:171], a[240:243], v[76:79]
    v_mfma_f32_16x16x32_bf16 v[80:83], v[168:171], a[244:247], v[80:83]
    ds_write_b128 v183, v[64:67] offset:3072
    v_mfma_f32_16x16x32_bf16 v[84:87], v[168:171], a[248:251], v[84:87]
    ds_write_b128 v184, v[68:71] offset:3072
    v_mfma_f32_16x16x32_bf16 v[88:91], v[168:171], a[252:255], v[88:91]
    ds_write_b128 v185, v[72:75] offset:3072
    s_add_u32 s73, s90, 36864
    s_add_u32 m0, s91, 36864
    s_nop 0
    buffer_load_dwordx4 v5, s[36:39], s73 offen sc1 lds
    s_waitcnt lgkmcnt(0)
    s_barrier
    s_waitcnt vmcnt(13)
    v_mfma_f32_16x16x32_bf16 v[92:95], v[144:147], a[224:227], v[92:95]
    ds_read_b128 v[16:19], v187 offset:0
    ds_read_b128 v[20:23], v187 offset:7168
    ds_read_b128 v[24:27], v187 offset:14336
    ds_read_b64 v[124:125], v188 offset:0
    v_mfma_f32_16x16x32_bf16 v[96:99], v[144:147], a[228:231], v[96:99]
    ds_read_b128 v[32:35], v187 offset:1024
    ds_read_b128 v[36:39], v187 offset:8192
    ds_read_b128 v[40:43], v187 offset:15360
    ds_read_b64 v[126:127], v188 offset:2048
    v_mfma_f32_16x16x32_bf16 v[100:103], v[144:147], a[232:235], v[100:103]
    ds_read_b128 v[48:51], v187 offset:2048
    ds_read_b128 v[52:55], v187 offset:9216
    ds_read_b128 v[56:59], v187 offset:16384
    ds_read_b64 v[128:129], v188 offset:4096
    v_mfma_f32_16x16x32_bf16 v[104:107], v[144:147], a[236:239], v[104:107]
    ds_read_b128 v[64:67], v187 offset:3072
    ds_read_b128 v[68:71], v187 offset:10240
    ds_read_b128 v[72:75], v187 offset:17408
    ds_read_b64 v[130:131], v188 offset:6144
    s_add_u32 s73, s90, 40960
    s_add_u32 m0, s91, 40960
    s_nop 0
    buffer_load_dwordx4 v5, s[36:39], s73 offen sc1 lds
    s_waitcnt vmcnt(13)
    v_mfma_f32_16x16x32_bf16 v[92:95], v[172:175], a[240:243], v[92:95]
    s_waitcnt lgkmcnt(12)
    v_pk_add_f32 v[12:13], v[12:13], v[16:17]
    v_pk_add_f32 v[14:15], v[14:15], v[18:19]
    v_pk_add_f32 v[20:21], v[20:21], v[24:25]
    v_mfma_f32_16x16x32_bf16 v[96:99], v[172:175], a[244:247], v[96:99]
    ds_write_b128 v183, v[80:83] offset:4096
    v_pk_add_f32 v[22:23], v[22:23], v[26:27]
    v_lshlrev_b32 v152, 16, v124
    v_and_b32 v153, 0xffff0000, v124
    v_lshlrev_b32 v154, 16, v125
    v_mfma_f32_16x16x32_bf16 v[100:103], v[172:175], a[248:251], v[100:103]
    ds_write_b128 v184, v[84:87] offset:4096
    v_and_b32 v155, 0xffff0000, v125
    v_pk_add_f32 v[12:13], v[12:13], v[182:183] op_sel:[0,0] op_sel_hi:[1,0]
    v_pk_add_f32 v[14:15], v[14:15], v[182:183] op_sel:[0,0] op_sel_hi:[1,0]
    v_pk_add_f32 v[12:13], v[12:13], v[20:21]
    v_mfma_f32_16x16x32_bf16 v[104:107], v[172:175], a[252:255], v[104:107]
    ds_write_b128 v185, v[88:91] offset:4096
    v_pk_add_f32 v[14:15], v[14:15], v[22:23]
    v_pk_mul_f32 v[12:13], v[12:13], v[152:153]
    v_pk_mul_f32 v[14:15], v[14:15], v[154:155]
    v_cvt_pk_bf16_f32 v192, v12, v13
    s_waitcnt vmcnt(12)
    v_mfma_f32_16x16x32_bf16 v[108:111], v[148:151], a[224:227], v[108:111]
    v_cvt_pk_bf16_f32 v193, v14, v15
    s_waitcnt lgkmcnt(11)
    v_pk_add_f32 v[28:29], v[28:29], v[32:33]
    v_pk_add_f32 v[30:31], v[30:31], v[34:35]
    v_mfma_f32_16x16x32_bf16 v[112:115], v[148:151], a[228:231], v[112:115]
    v_pk_add_f32 v[36:37], v[36:37], v[40:41]
    v_pk_add_f32 v[38:39], v[38:39], v[42:43]
    v_lshlrev_b32 v156, 16, v126
    v_and_b32 v157, 0xffff0000, v126
    v_mfma_f32_16x16x32_bf16 v[116:119], v[148:151], a[232:235], v[116:119]
    v_lshlrev_b32 v158, 16, v127
    v_and_b32 v159, 0xffff0000, v127
    v_pk_add_f32 v[28:29], v[28:29], v[182:183] op_sel:[0,0] op_sel_hi:[1,0]
    v_pk_add_f32 v[30:31], v[30:31], v[182:183] op_sel:[0,0] op_sel_hi:[1,0]
    v_mfma_f32_16x16x32_bf16 v[120:123], v[148:151], a[236:239], v[120:123]
    v_pk_add_f32 v[28:29], v[28:29], v[36:37]
    v_pk_add_f32 v[30:31], v[30:31], v[38:39]
    v_pk_mul_f32 v[28:29], v[28:29], v[156:157]
    v_pk_mul_f32 v[30:31], v[30:31], v[158:159]
    s_waitcnt vmcnt(11)
    v_mfma_f32_16x16x32_bf16 v[108:111], v[176:179], a[240:243], v[108:111]
    v_cvt_pk_bf16_f32 v194, v28, v29
    v_cvt_pk_bf16_f32 v195, v30, v31
    buffer_store_dwordx4 v[192:195], v5, s[36:39], s92 offen offset:0 sc1
    s_waitcnt lgkmcnt(7)
    v_mfma_f32_16x16x32_bf16 v[112:115], v[176:179], a[244:247], v[112:115]
    ds_write_b128 v183, v[96:99] offset:5120
    v_pk_add_f32 v[44:45], v[44:45], v[48:49]
    v_pk_add_f32 v[46:47], v[46:47], v[50:51]
    v_pk_add_f32 v[52:53], v[52:53], v[56:57]
    v_pk_add_f32 v[54:55], v[54:55], v[58:59]
    v_mfma_f32_16x16x32_bf16 v[116:119], v[176:179], a[248:251], v[116:119]
    ds_write_b128 v184, v[100:103] offset:5120
    v_lshlrev_b32 v152, 16, v128
    v_and_b32 v153, 0xffff0000, v128
    v_lshlrev_b32 v154, 16, v129
    v_and_b32 v155, 0xffff0000, v129
    v_mfma_f32_16x16x32_bf16 v[120:123], v[176:179], a[252:255], v[120:123]
    ds_write_b128 v185, v[104:107] offset:5120
    v_pk_add_f32 v[44:45], v[44:45], v[182:183] op_sel:[0,0] op_sel_hi:[1,0]
    v_pk_add_f32 v[46:47], v[46:47], v[182:183] op_sel:[0,0] op_sel_hi:[1,0]
    v_pk_add_f32 v[44:45], v[44:45], v[52:53]
    v_pk_add_f32 v[46:47], v[46:47], v[54:55]
    ds_write_b128 v183, v[112:115] offset:6144
    ds_write_b128 v184, v[116:119] offset:6144
    s_nop 0
    ds_write_b128 v185, v[120:123] offset:6144
    v_pk_mul_f32 v[44:45], v[44:45], v[152:153]
    v_pk_mul_f32 v[46:47], v[46:47], v[154:155]
    v_cvt_pk_bf16_f32 v196, v44, v45
    v_cvt_pk_bf16_f32 v197, v46, v47
    s_waitcnt lgkmcnt(9)
    v_pk_add_f32 v[60:61], v[60:61], v[64:65]
    v_pk_add_f32 v[62:63], v[62:63], v[66:67]
    v_pk_add_f32 v[68:69], v[68:69], v[72:73]
    v_pk_add_f32 v[70:71], v[70:71], v[74:75]
    v_lshlrev_b32 v156, 16, v130
    v_and_b32 v157, 0xffff0000, v130
    v_lshlrev_b32 v158, 16, v131
    v_and_b32 v159, 0xffff0000, v131
    v_pk_add_f32 v[60:61], v[60:61], v[182:183] op_sel:[0,0] op_sel_hi:[1,0]
    v_pk_add_f32 v[62:63], v[62:63], v[182:183] op_sel:[0,0] op_sel_hi:[1,0]
    v_pk_add_f32 v[60:61], v[60:61], v[68:69]
    v_pk_add_f32 v[62:63], v[62:63], v[70:71]
    v_pk_mul_f32 v[60:61], v[60:61], v[156:157]
    v_pk_mul_f32 v[62:63], v[62:63], v[158:159]
    v_cvt_pk_bf16_f32 v198, v60, v61
    v_cvt_pk_bf16_f32 v199, v62, v63
    buffer_store_dwordx4 v[196:199], v5, s[36:39], s92 offen offset:1024 sc1
    s_waitcnt lgkmcnt(0)
    s_barrier
    ds_read_b128 v[80:83], v187 offset:4096
    ds_read_b128 v[84:87], v187 offset:11264
    ds_read_b128 v[88:91], v187 offset:18432
    ds_read_b64 v[132:133], v188 offset:8192
    ds_read_b128 v[96:99], v187 offset:5120
    ds_read_b128 v[100:103], v187 offset:12288
    ds_read_b128 v[104:107], v187 offset:19456
    ds_read_b64 v[134:135], v188 offset:10240
    ds_read_b128 v[112:115], v187 offset:6144
    ds_read_b128 v[116:119], v187 offset:13312
    ds_read_b128 v[120:123], v187 offset:20480
    ds_read_b64 v[136:137], v188 offset:12288
    s_waitcnt lgkmcnt(8)
    v_pk_add_f32 v[76:77], v[76:77], v[80:81]
    v_pk_add_f32 v[78:79], v[78:79], v[82:83]
    v_pk_add_f32 v[84:85], v[84:85], v[88:89]
    v_pk_add_f32 v[86:87], v[86:87], v[90:91]
    v_lshlrev_b32 v152, 16, v132
    v_and_b32 v153, 0xffff0000, v132
    v_lshlrev_b32 v154, 16, v133
    v_and_b32 v155, 0xffff0000, v133
    v_pk_add_f32 v[76:77], v[76:77], v[182:183] op_sel:[0,0] op_sel_hi:[1,0]
    v_pk_add_f32 v[78:79], v[78:79], v[182:183] op_sel:[0,0] op_sel_hi:[1,0]
    v_pk_add_f32 v[76:77], v[76:77], v[84:85]
    v_pk_add_f32 v[78:79], v[78:79], v[86:87]
    v_pk_mul_f32 v[76:77], v[76:77], v[152:153]
    v_pk_mul_f32 v[78:79], v[78:79], v[154:155]
    v_cvt_pk_bf16_f32 v200, v76, v77
    v_cvt_pk_bf16_f32 v201, v78, v79
    s_waitcnt lgkmcnt(4)
    v_pk_add_f32 v[92:93], v[92:93], v[96:97]
    v_pk_add_f32 v[94:95], v[94:95], v[98:99]
    v_pk_add_f32 v[100:101], v[100:101], v[104:105]
    v_pk_add_f32 v[102:103], v[102:103], v[106:107]
    v_lshlrev_b32 v156, 16, v134
    v_and_b32 v157, 0xffff0000, v134
    v_lshlrev_b32 v158, 16, v135
    v_and_b32 v159, 0xffff0000, v135
    v_pk_add_f32 v[92:93], v[92:93], v[182:183] op_sel:[0,0] op_sel_hi:[1,0]
    v_pk_add_f32 v[94:95], v[94:95], v[182:183] op_sel:[0,0] op_sel_hi:[1,0]
    v_pk_add_f32 v[92:93], v[92:93], v[100:101]
    v_pk_add_f32 v[94:95], v[94:95], v[102:103]
    v_pk_mul_f32 v[92:93], v[92:93], v[156:157]
    v_pk_mul_f32 v[94:95], v[94:95], v[158:159]
    v_cvt_pk_bf16_f32 v202, v92, v93
    v_cvt_pk_bf16_f32 v203, v94, v95
    buffer_store_dwordx4 v[200:203], v5, s[36:39], s92 offen offset:2048 sc1
    s_waitcnt lgkmcnt(0)
    v_pk_add_f32 v[108:109], v[108:109], v[112:113]
    v_pk_add_f32 v[110:111], v[110:111], v[114:115]
    v_pk_add_f32 v[116:117], v[116:117], v[120:121]
    v_pk_add_f32 v[118:119], v[118:119], v[122:123]
    v_lshlrev_b32 v152, 16, v136
    v_and_b32 v153, 0xffff0000, v136
    v_lshlrev_b32 v154, 16, v137
    v_and_b32 v155, 0xffff0000, v137
    v_pk_add_f32 v[108:109], v[108:109], v[182:183] op_sel:[0,0] op_sel_hi:[1,0]
    v_pk_add_f32 v[110:111], v[110:111], v[182:183] op_sel:[0,0] op_sel_hi:[1,0]
    v_pk_add_f32 v[108:109], v[108:109], v[116:117]
    v_pk_add_f32 v[110:111], v[110:111], v[118:119]
    v_pk_mul_f32 v[108:109], v[108:109], v[152:153]
    v_pk_mul_f32 v[110:111], v[110:111], v[154:155]
    v_cvt_pk_bf16_f32 v204, v108, v109
    v_cvt_pk_bf16_f32 v205, v110, v111
    buffer_store_dwordx2 v[204:205], v5, s[36:39], s93 offen sc1
    s_mov_b32 s48, s30
    s_mov_b32 s49, s31
    s_mov_b32 s50, 2097152
    s_mov_b32 s51, 0x20000
    s_lshl_b32 s60, s58, 2
    s_add_u32 s60, s60, s56
    s_lshl_b32 s60, s60, 3
    s_lshl_b32 s66, s60, 6
    s_add_u32 s66, s66, 65536
    s_add_u32 s60, s60, s59
    s_lshl_b32 s60, s60, 6
    s_add_u32 s60, s60, 65536
    s_lshl_b32 s65, s59, 8
    s_add_u32 s65, s65, 288768
    s_waitcnt vmcnt(0)
    v_mov_b32 v2, s57
    s_mov_b64 exec, 1
    buffer_store_dword v2, v4, s[36:39], s60 offen sc1
    s_mov_b64 exec, -1
    v_min_u32 v13, 7, v1
    v_lshlrev_b32 v13, 6, v13
    s_waitcnt lgkmcnt(0)
    s_barrier
    s_add_u32 s73, s90, 45056
    s_add_u32 m0, s91, 45056
    s_nop 0
    buffer_load_dwordx4 v5, s[36:39], s73 offen sc1 lds
    s_add_u32 s73, s90, 49152
    s_add_u32 m0, s91, 49152
    s_nop 0
    buffer_load_dwordx4 v5, s[36:39], s73 offen sc1 lds
    s_add_u32 s73, s90, 53248
    s_add_u32 m0, s91, 53248
    s_nop 0
    buffer_load_dwordx4 v5, s[36:39], s73 offen sc1 lds
    s_add_u32 s73, s90, 57344
    s_add_u32 m0, s91, 57344
    s_nop 0
    buffer_load_dwordx4 v5, s[36:39], s73 offen sc1 lds
    s_add_u32 s73, s90, 61440
    s_add_u32 m0, s91, 61440
    s_nop 0
    buffer_load_dwordx4 v5, s[36:39], s73 offen sc1 lds
    s_add_u32 s73, s90, 65536
    s_add_u32 m0, s91, 65536
    s_nop 0
    buffer_load_dwordx4 v5, s[36:39], s73 offen sc1 lds
    s_add_u32 s73, s90, 69632
    s_add_u32 m0, s91, 69632
    s_nop 0
    buffer_load_dwordx4 v5, s[36:39], s73 offen sc1 lds
    s_add_u32 s73, s90, 73728
    s_add_u32 m0, s91, 73728
    s_nop 0
    buffer_load_dwordx4 v5, s[36:39], s73 offen sc1 lds
    s_add_u32 s73, s90, 77824
    s_add_u32 m0, s91, 77824
    s_nop 0
    buffer_load_dwordx4 v5, s[36:39], s73 offen sc1 lds
    buffer_load_dword v12, v13, s[36:39], s66 offen sc1
    s_add_u32 s73, s90, 81920
    s_add_u32 m0, s91, 81920
    s_nop 0
    buffer_load_dwordx4 v5, s[36:39], s73 offen sc1 lds
    s_add_u32 s73, s90, 86016
    s_add_u32 m0, s91, 86016
    s_nop 0
    buffer_load_dwordx4 v5, s[36:39], s73 offen sc1 lds
    s_add_u32 s73, s90, 90112
    s_add_u32 m0, s91, 90112
    s_nop 0
    buffer_load_dwordx4 v5, s[36:39], s73 offen sc1 lds
    s_add_u32 s73, s90, 94208
    s_add_u32 m0, s91, 94208
    s_nop 0
    buffer_load_dwordx4 v5, s[36:39], s73 offen sc1 lds
    s_add_u32 s73, s90, 98304
    s_add_u32 m0, s91, 98304
    s_nop 0
    buffer_load_dwordx4 v5, s[36:39], s73 offen sc1 lds
    s_add_u32 s73, s90, 102400
    s_add_u32 m0, s91, 102400
    s_nop 0
    buffer_load_dwordx4 v5, s[36:39], s73 offen sc1 lds
    s_add_u32 s73, s90, 106496
    s_add_u32 m0, s91, 106496
    s_nop 0
    buffer_load_dwordx4 v5, s[36:39], s73 offen sc1 lds
    s_add_u32 s73, s90, 110592
    s_add_u32 m0, s91, 110592
    s_nop 0
    buffer_load_dwordx4 v5, s[36:39], s73 offen sc1 lds
    buffer_load_dword v192, v9, s[36:39], s65 offen sc1
    s_add_u32 s65, s65, 12288
    buffer_load_dword v193, v9, s[36:39], s65 offen sc1
    s_add_u32 s65, s65, 12288
    buffer_load_dword v194, v9, s[36:39], s65 offen sc1
    s_add_u32 s65, s65, 12288
    buffer_load_dword v195, v9, s[36:39], s65 offen sc1
    s_add_u32 s65, s65, 12288
    buffer_load_dword v196, v9, s[36:39], s65 offen sc1
    s_add_u32 s65, s65, 12288
    buffer_load_dword v197, v9, s[36:39], s65 offen sc1
    s_add_u32 s65, s65, 12288
    buffer_load_dword v198, v9, s[36:39], s65 offen sc1
    s_add_u32 s65, s65, 12288
    buffer_load_dword v199, v9, s[36:39], s65 offen sc1
    v_add_u32 v14, 65536, v5
    v_lshlrev_b32 v10, 10, v6
    v_and_b32 v2, 1, v7
    v_lshl_add_u32 v10, v2, 5, v10
    v_lshrrev_b32 v2, 1, v7
    v_lshl_add_u32 v10, v2, 4, v10
    s_waitcnt vmcnt(16)
    v_cmp_ne_u32 vcc, s57, v12
    s_cbranch_vccz L_s5ok_45
    s_mov_b32 s78, 0
    buffer_load_dword v12, v13, s[36:39], s66 offen sc1
L_qs5_46:
    s_sleep 3
    buffer_load_dword v208, v13, s[36:39], s66 offen sc1
    s_waitcnt vmcnt(1)
    v_cmp_ne_u32 vcc, s57, v12
    s_cbranch_vccz L_qds5_47
    s_sleep 3
    buffer_load_dword v12, v13, s[36:39], s66 offen sc1
    s_waitcnt vmcnt(1)
    v_cmp_ne_u32 vcc, s57, v208
    s_cbranch_vccz L_qds5_47
    s_add_u32 s78, s78, 1
    s_cmp_gt_u32 s78, 200000
    s_cbranch_scc0 L_qs5_46
L_qds5_47:
L_s5ok_45:
    buffer_load_dwordx4 v[16:19], v5, s[36:39], s89 offen offset:0 sc1
    buffer_load_dwordx4 v[20:23], v5, s[36:39], s89 offen offset:1024 sc1
    buffer_load_dwordx4 v[24:27], v5, s[36:39], s89 offen offset:2048 sc1
    buffer_load_dwordx4 v[28:31], v5, s[36:39], s89 offen offset:3072 sc1
    s_add_u32 s89, s89, 4096
    buffer_load_dwordx4 v[32:35], v5, s[36:39], s89 offen offset:0 sc1
    buffer_load_dwordx4 v[36:39], v5, s[36:39], s89 offen offset:1024 sc1
    buffer_load_dwordx4 v[40:43], v5, s[36:39], s89 offen offset:2048 sc1
    buffer_load_dwordx4 v[44:47], v5, s[36:39], s89 offen offset:3072 sc1
    s_add_u32 s89, s89, 4096
    buffer_load_dwordx4 v[48:51], v5, s[36:39], s89 offen offset:0 sc1
    buffer_load_dwordx4 v[52:55], v5, s[36:39], s89 offen offset:1024 sc1
    s_waitcnt vmcnt(10)
    v_add_f32 v192, v192, v196
    v_add_f32 v193, v193, v197
    v_add_f32 v194, v194, v198
    v_add_f32 v195, v195, v199
    v_add_f32 v192, v192, v194
    v_add_f32 v193, v193, v195
    v_add_f32 v192, v192, v193
    v_cvt_pk_bf16_f32 v192, v192, v192
    v_lshlrev_b32 v192, 16, v192
    s_lshl_b32 s61, s56, 8
    s_add_u32 s61, s61, 161792
    v_add_u32 v2, s61, v9
    ds_write_b32 v2, v192
    v_lshlrev_b32 v2, 4, v7
    v_add_u32 v2, s61, v2
    s_waitcnt lgkmcnt(0)
    ds_read_b128 v[144:147], v2 offset:0
    ds_read_b128 v[148:151], v2 offset:64
    ds_read_b128 v[152:155], v2 offset:128
    ds_read_b128 v[156:159], v2 offset:192
    s_barrier
    ds_read_b128 v[160:163], v5 offset:0
    ds_read_b128 v[164:167], v5 offset:1024
    ds_read_b128 v[168:171], v5 offset:2048
    ds_read_b128 v[172:175], v5 offset:3072
    ds_read_b128 v[176:179], v5 offset:4096
    ds_read_b128 v[180:183], v5 offset:5120
    ds_read_b128 v[184:187], v5 offset:6144
    ds_read_b128 v[188:191], v5 offset:7168
    s_waitcnt vmcnt(9)
    s_waitcnt lgkmcnt(7)
    v_mfma_f32_16x16x32_bf16 v[128:131], v[160:163], v[16:19], 0
    ds_read_b128 v[192:195], v5 offset:8192
    s_waitcnt lgkmcnt(7)
    v_mfma_f32_16x16x32_bf16 v[132:135], v[164:167], v[16:19], 0
    ds_read_b128 v[196:199], v5 offset:9216
    s_waitcnt lgkmcnt(7)
    v_mfma_f32_16x16x32_bf16 v[136:139], v[168:171], v[16:19], 0
    ds_read_b128 v[200:203], v5 offset:10240
    s_waitcnt lgkmcnt(7)
    v_mfma_f32_16x16x32_bf16 v[140:143], v[172:175], v[16:19], 0
    ds_read_b128 v[204:207], v5 offset:11264
    buffer_load_dwordx4 v[56:59], v5, s[36:39], s89 offen offset:2048 sc1
    s_waitcnt vmcnt(9)
    s_waitcnt lgkmcnt(7)
    v_mfma_f32_16x16x32_bf16 v[128:131], v[176:179], v[20:23], v[128:131]
    ds_read_b128 v[160:163], v5 offset:12288
    s_waitcnt lgkmcnt(7)
    v_mfma_f32_16x16x32_bf16 v[132:135], v[180:183], v[20:23], v[132:135]
    ds_read_b128 v[164:167], v5 offset:13312
    s_waitcnt lgkmcnt(7)
    v_mfma_f32_16x16x32_bf16 v[136:139], v[184:187], v[20:23], v[136:139]
    ds_read_b128 v[168:171], v5 offset:14336
    s_waitcnt lgkmcnt(7)
    v_mfma_f32_16x16x32_bf16 v[140:143], v[188:191], v[20:23], v[140:143]
    ds_read_b128 v[172:175], v5 offset:15360
    buffer_load_dwordx4 v[60:63], v5, s[36:39], s89 offen offset:3072 sc1
    s_add_u32 s89, s89, 4096
    s_waitcnt vmcnt(9)
    s_waitcnt lgkmcnt(7)
    v_mfma_f32_16x16x32_bf16 v[128:131], v[192:195], v[24:27], v[128:131]
    ds_read_b128 v[176:179], v5 offset:16384
    s_waitcnt lgkmcnt(7)
    v_mfma_f32_16x16x32_bf16 v[132:135], v[196:199], v[24:27], v[132:135]
    ds_read_b128 v[180:183], v5 offset:17408
    s_waitcnt lgkmcnt(7)
    v_mfma_f32_16x16x32_bf16 v[136:139], v[200:203], v[24:27], v[136:139]
    ds_read_b128 v[184:187], v5 offset:18432
    s_waitcnt lgkmcnt(7)
    v_mfma_f32_16x16x32_bf16 v[140:143], v[204:207], v[24:27], v[140:143]
    ds_read_b128 v[188:191], v5 offset:19456
    buffer_load_dwordx4 v[64:67], v5, s[36:39], s89 offen offset:0 sc1
    s_waitcnt vmcnt(9)
    s_waitcnt lgkmcnt(7)
    v_mfma_f32_16x16x32_bf16 v[128:131], v[160:163], v[28:31], v[128:131]
    ds_read_b128 v[192:195], v5 offset:20480
    s_waitcnt lgkmcnt(7)
    v_mfma_f32_16x16x32_bf16 v[132:135], v[164:167], v[28:31], v[132:135]
    ds_read_b128 v[196:199], v5 offset:21504
    s_waitcnt lgkmcnt(7)
    v_mfma_f32_16x16x32_bf16 v[136:139], v[168:171], v[28:31], v[136:139]
    ds_read_b128 v[200:203], v5 offset:22528
    s_waitcnt lgkmcnt(7)
    v_mfma_f32_16x16x32_bf16 v[140:143], v[172:175], v[28:31], v[140:143]
    ds_read_b128 v[204:207], v5 offset:23552
    buffer_load_dwordx4 v[68:71], v5, s[36:39], s89 offen offset:1024 sc1
    s_waitcnt vmcnt(9)
    s_waitcnt lgkmcnt(7)
    v_mfma_f32_16x16x32_bf16 v[128:131], v[176:179], v[32:35], v[128:131]
    ds_read_b128 v[160:163], v5 offset:24576
    s_waitcnt lgkmcnt(7)
    v_mfma_f32_16x16x32_bf16 v[132:135], v[180:183], v[32:35], v[132:135]
    ds_read_b128 v[164:167], v5 offset:25600
    s_waitcnt lgkmcnt(7)
    v_mfma_f32_16x16x32_bf16 v[136:139], v[184:187], v[32:35], v[136:139]
    ds_read_b128 v[168:171], v5 offset:26624
    s_waitcnt lgkmcnt(7)
    v_mfma_f32_16x16x32_bf16 v[140:143], v[188:191], v[32:35], v[140:143]
    ds_read_b128 v[172:175], v5 offset:27648
    buffer_load_dwordx4 v[72:75], v5, s[36:39], s89 offen offset:2048 sc1
    s_waitcnt vmcnt(9)
    s_waitcnt lgkmcnt(7)
    v_mfma_f32_16x16x32_bf16 v[128:131], v[192:195], v[36:39], v[128:131]
    ds_read_b128 v[176:179], v5 offset:28672
    s_waitcnt lgkmcnt(7)
    v_mfma_f32_16x16x32_bf16 v[132:135], v[196:199], v[36:39], v[132:135]
    ds_read_b128 v[180:183], v5 offset:29696
    s_waitcnt lgkmcnt(7)
    v_mfma_f32_16x16x32_bf16 v[136:139], v[200:203], v[36:39], v[136:139]
    ds_read_b128 v[184:187], v5 offset:30720
    s_waitcnt lgkmcnt(7)
    v_mfma_f32_16x16x32_bf16 v[140:143], v[204:207], v[36:39], v[140:143]
    ds_read_b128 v[188:191], v5 offset:31744
    buffer_load_dwordx4 v[76:79], v5, s[36:39], s89 offen offset:3072 sc1
    s_add_u32 s89, s89, 4096
    s_waitcnt vmcnt(9)
    s_waitcnt lgkmcnt(7)
    v_mfma_f32_16x16x32_bf16 v[128:131], v[160:163], v[40:43], v[128:131]
    ds_read_b128 v[192:195], v5 offset:32768
    s_waitcnt lgkmcnt(7)
    v_mfma_f32_16x16x32_bf16 v[132:135], v[164:167], v[40:43], v[132:135]
    ds_read_b128 v[196:199], v5 offset:33792
    s_waitcnt lgkmcnt(7)
    v_mfma_f32_16x16x32_bf16 v[136:139], v[168:171], v[40:43], v[136:139]
    ds_read_b128 v[200:203], v5 offset:34816
    s_waitcnt lgkmcnt(7)
    v_mfma_f32_16x16x32_bf16 v[140:143], v[172:175], v[40:43], v[140:143]
    ds_read_b128 v[204:207], v5 offset:35840
    buffer_load_dwordx4 v[80:83], v5, s[36:39], s89 offen offset:0 sc1
    s_waitcnt vmcnt(9)
    s_waitcnt lgkmcnt(7)
    v_mfma_f32_16x16x32_bf16 v[128:131], v[176:179], v[44:47], v[128:131]
    ds_read_b128 v[160:163], v5 offset:36864
    s_waitcnt lgkmcnt(7)
    v_mfma_f32_16x16x32_bf16 v[132:135], v[180:183], v[44:47], v[132:135]
    ds_read_b128 v[164:167], v5 offset:37888
    s_waitcnt lgkmcnt(7)
    v_mfma_f32_16x16x32_bf16 v[136:139], v[184:187], v[44:47], v[136:139]
    ds_read_b128 v[168:171], v5 offset:38912
    s_waitcnt lgkmcnt(7)
    v_mfma_f32_16x16x32_bf16 v[140:143], v[188:191], v[44:47], v[140:143]
    ds_read_b128 v[172:175], v5 offset:39936
    buffer_load_dwordx4 v[84:87], v5, s[36:39], s89 offen offset:1024 sc1
    s_waitcnt vmcnt(9)
    s_waitcnt lgkmcnt(7)
    v_mfma_f32_16x16x32_bf16 v[128:131], v[192:195], v[48:51], v[128:131]
    ds_read_b128 v[176:179], v5 offset:40960
    s_waitcnt lgkmcnt(7)
    v_mfma_f32_16x16x32_bf16 v[132:135], v[196:199], v[48:51], v[132:135]
    ds_read_b128 v[180:183], v5 offset:41984
    s_waitcnt lgkmcnt(7)
    v_mfma_f32_16x16x32_bf16 v[136:139], v[200:203], v[48:51], v[136:139]
    ds_read_b128 v[184:187], v5 offset:43008
    s_waitcnt lgkmcnt(7)
    v_mfma_f32_16x16x32_bf16 v[140:143], v[204:207], v[48:51], v[140:143]
    ds_read_b128 v[188:191], v5 offset:44032
    buffer_load_dwordx4 v[88:91], v5, s[36:39], s89 offen offset:2048 sc1
    s_waitcnt vmcnt(9)
    s_waitcnt lgkmcnt(7)
    v_mfma_f32_16x16x32_bf16 v[128:131], v[160:163], v[52:55], v[128:131]
    ds_read_b128 v[192:195], v5 offset:45056
    s_waitcnt lgkmcnt(7)
    v_mfma_f32_16x16x32_bf16 v[132:135], v[164:167], v[52:55], v[132:135]
    ds_read_b128 v[196:199], v5 offset:46080
    s_waitcnt lgkmcnt(7)
    v_mfma_f32_16x16x32_bf16 v[136:139], v[168:171], v[52:55], v[136:139]
    ds_read_b128 v[200:203], v5 offset:47104
    s_waitcnt lgkmcnt(7)
    v_mfma_f32_16x16x32_bf16 v[140:143], v[172:175], v[52:55], v[140:143]
    ds_read_b128 v[204:207], v5 offset:48128
    buffer_load_dwordx4 v[92:95], v5, s[36:39], s89 offen offset:3072 sc1
    s_add_u32 s89, s89, 4096
    s_waitcnt vmcnt(9)
    s_waitcnt lgkmcnt(7)
    v_mfma_f32_16x16x32_bf16 v[128:131], v[176:179], v[56:59], v[128:131]
    ds_read_b128 v[160:163], v5 offset:49152
    s_waitcnt lgkmcnt(7)
    v_mfma_f32_16x16x32_bf16 v[132:135], v[180:183], v[56:59], v[132:135]
    ds_read_b128 v[164:167], v5 offset:50176
    s_waitcnt lgkmcnt(7)
    v_mfma_f32_16x16x32_bf16 v[136:139], v[184:187], v[56:59], v[136:139]
    ds_read_b128 v[168:171], v5 offset:51200
    s_waitcnt lgkmcnt(7)
    v_mfma_f32_16x16x32_bf16 v[140:143], v[188:191], v[56:59], v[140:143]
    ds_read_b128 v[172:175], v5 offset:52224
    buffer_load_dwordx4 v[96:99], v5, s[36:39], s89 offen offset:0 sc1
    s_waitcnt vmcnt(9)
    s_waitcnt lgkmcnt(7)
    v_mfma_f32_16x16x32_bf16 v[128:131], v[192:195], v[60:63], v[128:131]
    ds_read_b128 v[176:179], v5 offset:53248
    s_waitcnt lgkmcnt(7)
    v_mfma_f32_16x16x32_bf16 v[132:135], v[196:199], v[60:63], v[132:135]
    ds_read_b128 v[180:183], v5 offset:54272
    s_waitcnt lgkmcnt(7)
    v_mfma_f32_16x16x32_bf16 v[136:139], v[200:203], v[60:63], v[136:139]
    ds_read_b128 v[184:187], v5 offset:55296
    s_waitcnt lgkmcnt(7)
    v_mfma_f32_16x16x32_bf16 v[140:143], v[204:207], v[60:63], v[140:143]
    ds_read_b128 v[188:191], v5 offset:56320
    buffer_load_dwordx4 v[100:103], v5, s[36:39], s89 offen offset:1024 sc1
    s_waitcnt vmcnt(9)
    s_waitcnt lgkmcnt(7)
    v_mfma_f32_16x16x32_bf16 v[128:131], v[160:163], v[64:67], v[128:131]
    ds_read_b128 v[192:195], v5 offset:57344
    s_waitcnt lgkmcnt(7)
    v_mfma_f32_16x16x32_bf16 v[132:135], v[164:167], v[64:67], v[132:135]
    ds_read_b128 v[196:199], v5 offset:58368
    s_waitcnt lgkmcnt(7)
    v_mfma_f32_16x16x32_bf16 v[136:139], v[168:171], v[64:67], v[136:139]
    ds_read_b128 v[200:203], v5 offset:59392
    s_waitcnt lgkmcnt(7)
    v_mfma_f32_16x16x32_bf16 v[140:143], v[172:175], v[64:67], v[140:143]
    ds_read_b128 v[204:207], v5 offset:60416
    buffer_load_dwordx4 v[104:107], v5, s[36:39], s89 offen offset:2048 sc1
    s_waitcnt vmcnt(9)
    s_waitcnt lgkmcnt(7)
    v_mfma_f32_16x16x32_bf16 v[128:131], v[176:179], v[68:71], v[128:131]
    ds_read_b128 v[160:163], v5 offset:61440
    s_waitcnt lgkmcnt(7)
    v_mfma_f32_16x16x32_bf16 v[132:135], v[180:183], v[68:71], v[132:135]
    ds_read_b128 v[164:167], v5 offset:62464
    s_waitcnt lgkmcnt(7)
    v_mfma_f32_16x16x32_bf16 v[136:139], v[184:187], v[68:71], v[136:139]
    ds_read_b128 v[168:171], v5 offset:63488
    s_waitcnt lgkmcnt(7)
    v_mfma_f32_16x16x32_bf16 v[140:143], v[188:191], v[68:71], v[140:143]
    ds_read_b128 v[172:175], v5 offset:64512
    buffer_load_dwordx4 v[108:111], v5, s[36:39], s89 offen offset:3072 sc1
    s_add_u32 s89, s89, 4096
    s_waitcnt vmcnt(9)
    s_waitcnt lgkmcnt(7)
    v_mfma_f32_16x16x32_bf16 v[128:131], v[192:195], v[72:75], v[128:131]
    ds_read_b128 v[176:179], v14 offset:0
    s_waitcnt lgkmcnt(7)
    v_mfma_f32_16x16x32_bf16 v[132:135], v[196:199], v[72:75], v[132:135]
    ds_read_b128 v[180:183], v14 offset:1024
    s_waitcnt lgkmcnt(7)
    v_mfma_f32_16x16x32_bf16 v[136:139], v[200:203], v[72:75], v[136:139]
    ds_read_b128 v[184:187], v14 offset:2048
    s_waitcnt lgkmcnt(7)
    v_mfma_f32_16x16x32_bf16 v[140:143], v[204:207], v[72:75], v[140:143]
    ds_read_b128 v[188:191], v14 offset:3072
    buffer_load_dwordx4 v[112:115], v5, s[36:39], s89 offen offset:0 sc1
    s_waitcnt vmcnt(9)
    s_waitcnt lgkmcnt(7)
    v_mfma_f32_16x16x32_bf16 v[128:131], v[160:163], v[76:79], v[128:131]
    ds_read_b128 v[192:195], v14 offset:4096
    s_waitcnt lgkmcnt(7)
    v_mfma_f32_16x16x32_bf16 v[132:135], v[164:167], v[76:79], v[132:135]
    ds_read_b128 v[196:199], v14 offset:5120
    s_waitcnt lgkmcnt(7)
    v_mfma_f32_16x16x32_bf16 v[136:139], v[168:171], v[76:79], v[136:139]
    ds_read_b128 v[200:203], v14 offset:6144
    s_waitcnt lgkmcnt(7)
    v_mfma_f32_16x16x32_bf16 v[140:143], v[172:175], v[76:79], v[140:143]
    ds_read_b128 v[204:207], v14 offset:7168
    buffer_load_dwordx4 v[116:119], v5, s[36:39], s89 offen offset:1024 sc1
    s_waitcnt vmcnt(9)
    s_waitcnt lgkmcnt(7)
    v_mfma_f32_16x16x32_bf16 v[128:131], v[176:179], v[80:83], v[128:131]
    ds_read_b128 v[160:163], v14 offset:8192
    s_waitcnt lgkmcnt(7)
    v_mfma_f32_16x16x32_bf16 v[132:135], v[180:183], v[80:83], v[132:135]
    ds_read_b128 v[164:167], v14 offset:9216
    s_waitcnt lgkmcnt(7)
    v_mfma_f32_16x16x32_bf16 v[136:139], v[184:187], v[80:83], v[136:139]
    ds_read_b128 v[168:171], v14 offset:10240
    s_waitcnt lgkmcnt(7)
    v_mfma_f32_16x16x32_bf16 v[140:143], v[188:191], v[80:83], v[140:143]
    ds_read_b128 v[172:175], v14 offset:11264
    buffer_load_dwordx4 v[120:123], v5, s[36:39], s89 offen offset:2048 sc1
    s_waitcnt vmcnt(9)
    s_waitcnt lgkmcnt(7)
    v_mfma_f32_16x16x32_bf16 v[128:131], v[192:195], v[84:87], v[128:131]
    ds_read_b128 v[176:179], v14 offset:12288
    s_waitcnt lgkmcnt(7)
    v_mfma_f32_16x16x32_bf16 v[132:135], v[196:199], v[84:87], v[132:135]
    ds_read_b128 v[180:183], v14 offset:13312
    s_waitcnt lgkmcnt(7)
    v_mfma_f32_16x16x32_bf16 v[136:139], v[200:203], v[84:87], v[136:139]
    ds_read_b128 v[184:187], v14 offset:14336
    s_waitcnt lgkmcnt(7)
    v_mfma_f32_16x16x32_bf16 v[140:143], v[204:207], v[84:87], v[140:143]
    ds_read_b128 v[188:191], v14 offset:15360
    buffer_load_dwordx4 v[124:127], v5, s[36:39], s89 offen offset:3072 sc1
    s_waitcnt vmcnt(9)
    s_waitcnt lgkmcnt(7)
    v_mfma_f32_16x16x32_bf16 v[128:131], v[160:163], v[88:91], v[128:131]
    ds_read_b128 v[192:195], v14 offset:16384
    s_waitcnt lgkmcnt(7)
    v_mfma_f32_16x16x32_bf16 v[132:135], v[164:167], v[88:91], v[132:135]
    ds_read_b128 v[196:199], v14 offset:17408
    s_waitcnt lgkmcnt(7)
    v_mfma_f32_16x16x32_bf16 v[136:139], v[168:171], v[88:91], v[136:139]
    ds_read_b128 v[200:203], v14 offset:18432
    s_waitcnt lgkmcnt(7)
    v_mfma_f32_16x16x32_bf16 v[140:143], v[172:175], v[88:91], v[140:143]
    ds_read_b128 v[204:207], v14 offset:19456
    s_waitcnt vmcnt(8)
    s_waitcnt lgkmcnt(7)
    v_mfma_f32_16x16x32_bf16 v[128:131], v[176:179], v[92:95], v[128:131]
    ds_read_b128 v[160:163], v14 offset:20480
    s_waitcnt lgkmcnt(7)
    v_mfma_f32_16x16x32_bf16 v[132:135], v[180:183], v[92:95], v[132:135]
    ds_read_b128 v[164:167], v14 offset:21504
    s_waitcnt lgkmcnt(7)
    v_mfma_f32_16x16x32_bf16 v[136:139], v[184:187], v[92:95], v[136:139]
    ds_read_b128 v[168:171], v14 offset:22528
    s_waitcnt lgkmcnt(7)
    v_mfma_f32_16x16x32_bf16 v[140:143], v[188:191], v[92:95], v[140:143]
    ds_read_b128 v[172:175], v14 offset:23552
    s_waitcnt vmcnt(7)
    s_waitcnt lgkmcnt(7)
    v_mfma_f32_16x16x32_bf16 v[128:131], v[192:195], v[96:99], v[128:131]
    ds_read_b128 v[176:179], v14 offset:24576
    s_waitcnt lgkmcnt(7)
    v_mfma_f32_16x16x32_bf16 v[132:135], v[196:199], v[96:99], v[132:135]
    ds_read_b128 v[180:183], v14 offset:25600
    s_waitcnt lgkmcnt(7)
    v_mfma_f32_16x16x32_bf16 v[136:139], v[200:203], v[96:99], v[136:139]
    ds_read_b128 v[184:187], v14 offset:26624
    s_waitcnt lgkmcnt(7)
    v_mfma_f32_16x16x32_bf16 v[140:143], v[204:207], v[96:99], v[140:143]
    ds_read_b128 v[188:191], v14 offset:27648
    s_waitcnt vmcnt(6)
    s_waitcnt lgkmcnt(7)
    v_mfma_f32_16x16x32_bf16 v[128:131], v[160:163], v[100:103], v[128:131]
    ds_read_b128 v[192:195], v14 offset:28672
    s_waitcnt lgkmcnt(7)
    v_mfma_f32_16x16x32_bf16 v[132:135], v[164:167], v[100:103], v[132:135]
    ds_read_b128 v[196:199], v14 offset:29696
    s_waitcnt lgkmcnt(7)
    v_mfma_f32_16x16x32_bf16 v[136:139], v[168:171], v[100:103], v[136:139]
    ds_read_b128 v[200:203], v14 offset:30720
    s_waitcnt lgkmcnt(7)
    v_mfma_f32_16x16x32_bf16 v[140:143], v[172:175], v[100:103], v[140:143]
    ds_read_b128 v[204:207], v14 offset:31744
    s_waitcnt vmcnt(5)
    s_waitcnt lgkmcnt(7)
    v_mfma_f32_16x16x32_bf16 v[128:131], v[176:179], v[104:107], v[128:131]
    ds_read_b128 v[160:163], v14 offset:32768
    s_waitcnt lgkmcnt(7)
    v_mfma_f32_16x16x32_bf16 v[132:135], v[180:183], v[104:107], v[132:135]
    ds_read_b128 v[164:167], v14 offset:33792
    s_waitcnt lgkmcnt(7)
    v_mfma_f32_16x16x32_bf16 v[136:139], v[184:187], v[104:107], v[136:139]
    ds_read_b128 v[168:171], v14 offset:34816
    s_waitcnt lgkmcnt(7)
    v_mfma_f32_16x16x32_bf16 v[140:143], v[188:191], v[104:107], v[140:143]
    ds_read_b128 v[172:175], v14 offset:35840
    s_waitcnt vmcnt(4)
    s_waitcnt lgkmcnt(7)
    v_mfma_f32_16x16x32_bf16 v[128:131], v[192:195], v[108:111], v[128:131]
    ds_read_b128 v[176:179], v14 offset:36864
    s_waitcnt lgkmcnt(7)
    v_mfma_f32_16x16x32_bf16 v[132:135], v[196:199], v[108:111], v[132:135]
    ds_read_b128 v[180:183], v14 offset:37888
    s_waitcnt lgkmcnt(7)
    v_mfma_f32_16x16x32_bf16 v[136:139], v[200:203], v[108:111], v[136:139]
    ds_read_b128 v[184:187], v14 offset:38912
    s_waitcnt lgkmcnt(7)
    v_mfma_f32_16x16x32_bf16 v[140:143], v[204:207], v[108:111], v[140:143]
    ds_read_b128 v[188:191], v14 offset:39936
    s_waitcnt vmcnt(3)
    s_waitcnt lgkmcnt(7)
    v_mfma_f32_16x16x32_bf16 v[128:131], v[160:163], v[112:115], v[128:131]
    ds_read_b128 v[192:195], v14 offset:40960
    s_waitcnt lgkmcnt(7)
    v_mfma_f32_16x16x32_bf16 v[132:135], v[164:167], v[112:115], v[132:135]
    ds_read_b128 v[196:199], v14 offset:41984
    s_waitcnt lgkmcnt(7)
    v_mfma_f32_16x16x32_bf16 v[136:139], v[168:171], v[112:115], v[136:139]
    ds_read_b128 v[200:203], v14 offset:43008
    s_waitcnt lgkmcnt(7)
    v_mfma_f32_16x16x32_bf16 v[140:143], v[172:175], v[112:115], v[140:143]
    ds_read_b128 v[204:207], v14 offset:44032
    s_waitcnt vmcnt(2)
    s_waitcnt lgkmcnt(7)
    v_mfma_f32_16x16x32_bf16 v[128:131], v[176:179], v[116:119], v[128:131]
    ds_read_b128 v[160:163], v14 offset:45056
    s_waitcnt lgkmcnt(7)
    v_mfma_f32_16x16x32_bf16 v[132:135], v[180:183], v[116:119], v[132:135]
    ds_read_b128 v[164:167], v14 offset:46080
    s_waitcnt lgkmcnt(7)
    v_mfma_f32_16x16x32_bf16 v[136:139], v[184:187], v[116:119], v[136:139]
    ds_read_b128 v[168:171], v14 offset:47104
    s_waitcnt lgkmcnt(7)
    v_mfma_f32_16x16x32_bf16 v[140:143], v[188:191], v[116:119], v[140:143]
    ds_read_b128 v[172:175], v14 offset:48128
    s_waitcnt vmcnt(1)
    s_waitcnt lgkmcnt(7)
    v_mfma_f32_16x16x32_bf16 v[128:131], v[192:195], v[120:123], v[128:131]
    s_waitcnt lgkmcnt(6)
    v_mfma_f32_16x16x32_bf16 v[132:135], v[196:199], v[120:123], v[132:135]
    s_waitcnt lgkmcnt(5)
    v_mfma_f32_16x16x32_bf16 v[136:139], v[200:203], v[120:123], v[136:139]
    s_waitcnt lgkmcnt(4)
    v_mfma_f32_16x16x32_bf16 v[140:143], v[204:207], v[120:123], v[140:143]
    s_waitcnt vmcnt(0)
    s_waitcnt lgkmcnt(3)
    v_mfma_f32_16x16x32_bf16 v[128:131], v[160:163], v[124:127], v[128:131]
    s_waitcnt lgkmcnt(2)
    v_mfma_f32_16x16x32_bf16 v[132:135], v[164:167], v[124:127], v[132:135]
    s_waitcnt lgkmcnt(1)
    v_mfma_f32_16x16x32_bf16 v[136:139], v[168:171], v[124:127], v[136:139]
    s_waitcnt lgkmcnt(0)
    v_mfma_f32_16x16x32_bf16 v[140:143], v[172:175], v[124:127], v[140:143]
    v_lshlrev_b32 v160, 16, v246
    v_and_b32 v161, 0xffff0000, v246
    v_lshlrev_b32 v162, 16, v247
    v_and_b32 v163, 0xffff0000, v247
    v_lshlrev_b32 v164, 16, v248
    v_and_b32 v165, 0xffff0000, v248
    v_lshlrev_b32 v166, 16, v249
    v_and_b32 v167, 0xffff0000, v249
    v_lshlrev_b32 v168, 16, v250
    v_and_b32 v169, 0xffff0000, v250
    v_lshlrev_b32 v170, 16, v251
    v_and_b32 v171, 0xffff0000, v251
    v_lshlrev_b32 v172, 16, v252
    v_and_b32 v173, 0xffff0000, v252
    v_lshlrev_b32 v174, 16, v253
    v_and_b32 v175, 0xffff0000, v253
    s_lshl_b32 s60, s58, 16
    s_lshl_b32 s61, s56, 14
    s_add_u32 s60, s60, s61
    s_lshl_b32 s61, s59, 7
    s_add_u32 s60, s60, s61
    v_pk_fma_f32 v[160:161], v[128:129], v[144:145], v[160:161]
    v_pk_fma_f32 v[162:163], v[130:131], v[146:147], v[162:163]
    v_pk_fma_f32 v[164:165], v[132:133], v[148:149], v[164:165]
    v_pk_fma_f32 v[166:167], v[134:135], v[150:151], v[166:167]
    v_pk_fma_f32 v[168:169], v[136:137], v[152:153], v[168:169]
    v_pk_fma_f32 v[170:171], v[138:139], v[154:155], v[170:171]
    v_pk_fma_f32 v[172:173], v[140:141], v[156:157], v[172:173]
    v_pk_fma_f32 v[174:175], v[142:143], v[158:159], v[174:175]
    v_cvt_pk_bf16_f32 v176, v160, v161
    v_cvt_pk_bf16_f32 v177, v162, v163
    v_cvt_pk_bf16_f32 v178, v164, v165
    v_cvt_pk_bf16_f32 v179, v166, v167
    v_cvt_pk_bf16_f32 v180, v168, v169
    v_cvt_pk_bf16_f32 v181, v170, v171
    v_cvt_pk_bf16_f32 v182, v172, v173
    v_cvt_pk_bf16_f32 v183, v174, v175
    s_mul_i32 s61, s56, 2304
    s_add_u32 s61, s61, 145408
    v_mul_u32_u24 v2, 144, v6
    v_lshl_add_u32 v2, v7, 3, v2
    v_add_u32 v2, s61, v2
    ds_write_b64 v2, v[176:177] offset:0
    ds_write_b64 v2, v[178:179] offset:32
    ds_write_b64 v2, v[180:181] offset:64
    ds_write_b64 v2, v[182:183] offset:96
    v_lshrrev_b32 v3, 3, v1
    v_and_b32 v14, 7, v1
    v_lshlrev_b32 v10, 10, v3
    v_lshl_add_u32 v10, v14, 4, v10
    v_mul_u32_u24 v3, 144, v3
    v_lshl_add_u32 v3, v14, 4, v3
    v_add_u32 v3, s61, v3
    s_add_u32 s62, s60, 8192
    s_waitcnt lgkmcnt(0)
    ds_read_b128 v[160:163], v3 offset:0
    ds_read_b128 v[164:167], v3 offset:1152
    s_waitcnt lgkmcnt(1)
    buffer_store_dwordx4 v[160:163], v10, s[48:51], s60 offen sc1
    s_waitcnt lgkmcnt(0)
    buffer_store_dwordx4 v[164:167], v10, s[48:51], s62 offen sc1
L_end:
    s_endpgm
.section .rodata,"a"
.p2align 6
.amdhsa_kernel adaLN_cond__ssm_conv_h3__mixer_gmlp__prompt_kernel
  .amdhsa_next_free_vgpr 512
  .amdhsa_next_free_sgpr 102
  .amdhsa_accum_offset 256
  .amdhsa_group_segment_fixed_size 0
  .amdhsa_kernarg_size 128
  .amdhsa_user_sgpr_count 2
  .amdhsa_user_sgpr_kernarg_segment_ptr 1
  .amdhsa_system_sgpr_workgroup_id_x 1
.end_amdhsa_kernel
```
